```python
import torch

def _softmax(x, axis=-1):
    return torch.softmax(x, dim=axis)
def _gelu(x):
    return torch.nn.functional.gelu(x, approximate="tanh")
def _silu(x):
    return torch.nn.functional.silu(x)
def _sigmoid(x):
    return torch.sigmoid(x)
def _layernorm(x, axis=-1, eps=1e-5):
    m = x.mean(dim=axis, keepdim=True)
    v = x.var(dim=axis, keepdim=True, unbiased=False)
    return (x - m) / torch.sqrt(v + eps)
def _scatter_add(tgt, idx, src, axis=0):
    return tgt.clone().index_add_(axis, idx, src)
def _segment_sum(src, seg, n):
    out = torch.zeros((n,) + src.shape[1:], dtype=src.dtype)
    return out.index_add_(0, seg, src)
def _pad(x, pw):
    flat = tuple(v for pair in reversed(pw) for v in pair)
    return torch.nn.functional.pad(x, flat)

kernel_name = 'interleave_layers__ssm_conv_h3__glu_gated_geglu__prompt'

def setup_inputs():

    _w = (lambda a: (lambda t: t.to(torch.bfloat16) if t.is_floating_point() else t)(torch.as_tensor(a)))
    def _A_setup():
        B, S, D = 1, 2048, 1024
        ks = 4
        return {
            "q": _w((lambda *s: torch.randn(*s, dtype=torch.bfloat16) * 0.05)(B, S, D)),
            "k": _w((lambda *s: torch.randn(*s, dtype=torch.bfloat16) * 0.2)(B, S, D)),
            "v": _w((lambda *s: torch.randn(*s, dtype=torch.bfloat16) * 0.2)(B, S, D)),
            "shift_k": _w((lambda *s: torch.randn(*s, dtype=torch.bfloat16) * 0.2)(D, ks) * 0.5),
            "ssm_k": _w((lambda *s: torch.randn(*s, dtype=torch.bfloat16) * 0.4)(D, S) * (1.0 / S ** 0.5)),
            "ssm_D": _w((lambda *s: torch.randn(*s, dtype=torch.bfloat16) * 0.2)(D)),
        }
    _A_in = _A_setup()

    def _B_setup():
        B, S, Dm, Df = 1, 2048, 1024, 3584
        return {
            "x": _w((lambda *s: torch.randn(*s, dtype=torch.bfloat16) * 0.05)(B, S, Dm)),
            "w_gate": _w((lambda *s: torch.randn(*s, dtype=torch.bfloat16) * 0.4)(Dm, Df) * (Dm ** -0.5)),
            "w_up": _w((lambda *s: torch.randn(*s, dtype=torch.bfloat16) * 0.4)(Dm, Df) * (Dm ** -0.5)),
            "w_down": _w((lambda *s: torch.randn(*s, dtype=torch.bfloat16) * 0.4)(Df, Dm) * (Df ** -0.5)),
        }
    _B_in = _B_setup()

    return {
        "A_q": _A_in["q"],
        "A_k": _A_in["k"],
        "A_v": _A_in["v"],
        "A_shift_k": _A_in["shift_k"],
        "A_ssm_k": _A_in["ssm_k"],
        "A_ssm_D": _A_in["ssm_D"],
        "B_x": _B_in["x"],
        "B_w_gate": _B_in["w_gate"],
        "B_w_up": _B_in["w_up"],
        "B_w_down": _B_in["w_down"],
    }

def reference(A_q, A_k, A_v, A_shift_k, A_ssm_k, A_ssm_D, B_x, B_w_gate, B_w_up, B_w_down):
    def _A_ref(q, k, v, shift_k, ssm_k, ssm_D):
        B, S, D = q.shape
        ks = shift_k.shape[-1]
        k_pad = _pad(k, ((0, 0), (ks - 1, 0), (0, 0)))
        k_shift = torch.zeros_like(k)
        for t in range(ks):
            k_shift = k_shift + k_pad[:, t:t + S, :] * shift_k[:, ks - 1 - t][None, None, :]
        kv = k_shift * v
        L = 2 * S
        kv_pad = _pad(kv, ((0, 0), (0, S), (0, 0)))
        kf_pad = _pad(ssm_k, ((0, 0), (0, S)))
        kv_f = (lambda x, axes=(-2,-1): torch.fft.rfft2(x.float(), dim=axes))(kv_pad[:, None, :, :], axes=(1, 2))
        kf_f = (lambda x, axes=(-2,-1): torch.fft.rfft2(x.float(), dim=axes))(kf_pad[:, None, :], axes=(1, 2))
        kf_f = (lambda x, *d: x.permute(*d))(kf_f, 1, 2, 0)
        y_f = kv_f * kf_f[None, :, :, :]
        y = (lambda x, s, axes=(-2,-1): torch.fft.irfft2(x, s=s, dim=axes).to(torch.bfloat16))(y_f, (1, L), axes=(1, 2))[:, 0, :S, :]
        y = y + kv * ssm_D[None, None, :]
        return q * y

    def _B_ref(x, w_gate, w_up, w_down):
        g = torch.einsum("bsd,df->bsf", x, w_gate)
        u = torch.einsum("bsd,df->bsf", x, w_up)
        h = _gelu(g) * u
        return torch.einsum("bsf,fd->bsd", h, w_down)

    x = A_q
    x = x + _A_ref(_layernorm(x, axis=-1), A_k, A_v, A_shift_k, A_ssm_k, A_ssm_D)
    x = x + _B_ref(_layernorm(x, axis=-1), B_w_gate, B_w_up, B_w_down)
    x = x + _A_ref(_layernorm(x, axis=-1), A_k, A_v, A_shift_k, A_ssm_k, A_ssm_D)
    x = x + _B_ref(_layernorm(x, axis=-1), B_w_gate, B_w_up, B_w_down)
    return x
```

```asm
; @launch grid=(256,1,1) block=(256,1,1) lds=163840
.amdgcn_target "amdgcn-amd-amdhsa--gfx950"
.text
.globl interleave_layers__ssm_conv_h3__glu_gated_geglu__prompt_kernel
.p2align 8
.type interleave_layers__ssm_conv_h3__glu_gated_geglu__prompt_kernel,@function
interleave_layers__ssm_conv_h3__glu_gated_geglu__prompt_kernel:
s_cmp_ge_u32 s2, 256
s_cbranch_scc1 L_end
s_load_dwordx4 s[72:75], s[0:1], 8
s_load_dwordx2 s[8:9], s[0:1], 96
s_load_dwordx2 s[76:77], s[0:1], 24
s_load_dwordx4 s[4:7], s[0:1], 32
s_load_dwordx4 s[96:99], s[0:1], 56
s_load_dwordx2 s[100:101], s[0:1], 0
s_and_b32 s59, s2, 7
s_lshr_b32 s60, s2, 3
s_lshl_b32 s16, s60, 4
v_and_b32 v3, 15, v0
v_add_u32 v3, s16, v3
s_getpc_b64 s[80:81]
L_interleave_layers__ssm_conv_h3__glu_gated_geglu__prompt_kernel_pc1:
s_add_u32 s80, s80, L_body-L_interleave_layers__ssm_conv_h3__glu_gated_geglu__prompt_kernel_pc1
s_addc_u32 s81, s81, 0
s_mov_b32 s82, L_end-L_body
s_mov_b32 s83, 0x20000
v_lshlrev_b32 v4, 7, v3
buffer_load_dword v51, v4, s[80:83], 0 offen
L_body:
v_lshrrev_b32 v1, 6, v0
v_and_b32 v2, 63, v0
v_readfirstlane_b32 s17, v1
s_lshl_b32 s61, s59, 5
s_add_u32 s61, s61, s60
s_and_b32 s16, s61, 15
s_lshl_b32 s16, s16, 18
s_lshr_b32 s18, s61, 4
s_lshl_b32 s18, s18, 7
s_add_u32 s16, s16, s18
v_lshrrev_b32 v3, 3, v2
v_lshlrev_b32 v3, 11, v3
v_and_b32 v7, 7, v2
v_lshl_add_u32 v3, v7, 4, v3
v_add_u32 v3, s16, v3
v_subrev_u32 v8, 0x4000, v3
s_lshl_b32 s84, s17, 16
s_mul_i32 s85, s17, 4224
s_and_b32 s16, s61, 0xf0
v_bfe_u32 v49, v0, 3, 3
v_lshrrev_b32 v9, 7, v0
v_lshl_add_u32 v49, v9, 3, v49
v_add_u32 v9, s16, v49
v_lshlrev_b32 v7, 5, v9
s_waitcnt lgkmcnt(0)
s_mov_b32 s24, s72
s_mov_b32 s25, s73
s_mov_b32 s26, 0x400000
s_mov_b32 s27, 0x20000
s_mov_b32 s28, s74
s_mov_b32 s29, s75
s_mov_b32 s30, 0x400000
s_mov_b32 s31, 0x20000
s_mov_b32 s32, s76
s_mov_b32 s33, s77
s_mov_b32 s34, 0x2000
s_mov_b32 s35, 0x20000
s_mov_b32 m0, 103680
s_nop 0
buffer_load_dwordx4 v8, s[24:27], 0 offen  lds
s_add_u32 m0, s85, 104736
s_add_u32 s16, s84, 0
buffer_load_dwordx4 v3, s[24:27], s16 offen  lds
s_add_u32 m0, s85, 105792
s_add_u32 s16, s84, 16384
buffer_load_dwordx4 v3, s[24:27], s16 offen  lds
s_add_u32 m0, s85, 106848
s_add_u32 s16, s84, 32768
buffer_load_dwordx4 v3, s[24:27], s16 offen  lds
s_add_u32 m0, s85, 107904
s_add_u32 s16, s84, 49152
buffer_load_dwordx4 v3, s[24:27], s16 offen  lds
s_add_u32 m0, s85, 121632
s_add_u32 s16, s84, 0
buffer_load_dwordx4 v3, s[28:31], s16 offen  lds
s_add_u32 m0, s85, 122688
s_add_u32 s16, s84, 16384
buffer_load_dwordx4 v3, s[28:31], s16 offen  lds
s_add_u32 m0, s85, 123744
s_add_u32 s16, s84, 32768
buffer_load_dwordx4 v3, s[28:31], s16 offen  lds
s_add_u32 m0, s85, 124800
s_add_u32 s16, s84, 49152
buffer_load_dwordx4 v3, s[28:31], s16 offen  lds
buffer_load_dwordx4 v[108:111], v7, s[32:35], 0 offen
buffer_load_dwordx4 v[112:115], v7, s[32:35], 0 offen offset:16
s_add_u32 s70, s8, 86056960
s_addc_u32 s71, s9, 0
s_load_dword s87, s[70:71], 0
s_mov_b32 s20, s8
s_mov_b32 s21, s9
s_mov_b32 s22, 0x10000000
s_mov_b32 s23, 0x20000
s_mov_b32 s28, s8
s_mov_b32 s29, s9
s_mov_b32 s30, 0x10000000
s_mov_b32 s31, 0x20000
s_mov_b32 s3, 0
v_mov_b32 v230, v0
v_lshlrev_b32 v224, 4, v2
s_lshl_b32 s18, s61, 2
s_add_u32 s18, s18, s17
s_mul_i32 s62, s17, 25920
s_lshl_b32 s16, s18, 12
s_add_u32 s64, s4, s16
s_addc_u32 s65, s5, 0
s_add_u32 s16, s16, 4194304
s_add_u32 s72, s8, s16
s_addc_u32 s73, s9, 0
s_mov_b32 s74, 4096
s_mov_b32 s75, 0x20000
s_and_b32 s16, s18, 0xfffffffe
s_lshl_b32 s16, s16, 1
s_add_u32 s6, s6, s16
s_addc_u32 s7, s7, 0
s_mov_b32 s24, s64
s_mov_b32 s25, s65
s_mov_b32 s26, 4096
s_load_dword s63, s[6:7], 0
s_load_dwordx4 s[4:7], s[0:1], 72
s_mov_b32 s84, 4096
s_mov_b32 s85, 8192
s_mov_b32 s86, 12288
v_and_b32 v48, 7, v0
v_bfe_u32 v10, v0, 6, 1
v_lshl_add_u32 v48, v10, 3, v48
v_mul_u32_u24 v52, 1056, v48
v_lshl_add_u32 v52, v49, 3, v52
v_add_u32 v52, 103680, v52
s_and_b32 s16, s61, 15
s_lshl_b32 s16, s16, 4
v_add_u32 v48, s16, v48
v_sub_u32 v50, 255, v48
v_lshlrev_b32 v50, 4, v50
v_lshl_add_u32 v50, v9, 14, v50
v_add_u32 v50, 4194304, v50
s_lshr_b32 s32, s59, 1
s_lshl_b32 s32, s32, 2
s_and_b32 s33, s60, 3
s_add_u32 s32, s32, s33
s_and_b32 s33, s59, 1
s_lshr_b32 s34, s60, 2
s_lshl_b32 s35, s33, 3
s_add_u32 s35, s35, s34
s_lshl_b32 s19, s32, 4
s_add_u32 s19, s19, s35
s_lshl_b32 s44, s19, 14
s_lshr_b32 s45, s19, 1
s_lshl_b32 s45, s45, 15
s_and_b32 s16, s19, 1
s_lshl_b32 s16, s16, 7
s_add_u32 s45, s45, s16
s_and_b32 s16, s17, 1
s_lshl_b32 s16, s16, 11
s_add_u32 s45, s45, s16
s_lshr_b32 s16, s17, 1
s_lshl_b32 s16, s16, 22
s_add_u32 s45, s45, s16
s_add_u32 s45, s45, 9437184
v_and_b32 v8, 7, v0
v_lshrrev_b32 v9, 3, v2
v_lshlrev_b32 v15, 4, v8
v_lshl_add_u32 v15, v9, 8, v15
v_lshrrev_b32 v9, 3, v0
v_and_b32 v13, 3, v9
v_lshrrev_b32 v9, 2, v9
v_lshl_add_u32 v9, v9, 4, v13
v_lshlrev_b32 v53, 11, v8
v_lshl_add_u32 v53, v9, 4, v53
v_lshlrev_b32 v233, 4, v8
v_lshl_add_u32 v233, v9, 8, v233
v_mov_b32 v16, -1
v_mov_b32 v17, -1
v_mov_b32 v18, -1
v_mov_b32 v19, -1
v_lshlrev_b32 v14, 4, v0
v_and_b32 v61, 15, v2
v_lshrrev_b32 v62, 4, v2
v_lshlrev_b32 v63, 2, v61
v_lshl_add_u32 v63, v62, 4, v63
v_mul_u32_u24 v54, 7168, v62
v_lshlrev_b32 v13, 1, v62
v_and_b32 v13, 15, v13
v_xor_b32 v13, v13, v61
v_lshl_add_u32 v20, v13, 4, v54
v_xor_b32 v13, 8, v13
v_lshl_add_u32 v58, v13, 4, v54
v_mov_b32 v54, v20
s_lshl_b32 s11, s17, 13
s_add_u32 s11, s11, 103680
v_subrev_u32 v4, 60, v63
v_subrev_u32 v5, 56, v63
v_subrev_u32 v6, 52, v63
v_subrev_u32 v7, 48, v63
s_waitcnt lgkmcnt(0)
v_and_b32 v8, 3, v61
v_mul_u32_u24 v8, 4160, v8
v_lshrrev_b32 v9, 2, v61
v_add_u32 v9, v9, v62
v_lshl_add_u32 v56, v9, 4, v8
v_add_u32 v56, s62, v56
v_lshrrev_b32 v8, 3, v61
v_mul_u32_u24 v9, 4640, v8
v_and_b32 v10, 7, v61
v_lshlrev_b32 v13, 6, v10
v_sub_u32 v9, v9, v13
v_lshl_add_u32 v9, v62, 4, v9
v_add_u32 v9, 17088, v9
v_add_u32 v57, s62, v9
v_lshrrev_b32 v13, 1, v10
v_xor_b32 v13, v13, v62
v_lshl_add_u32 v13, v10, 2, v13
v_lshlrev_b32 v13, 4, v13
v_lshl_add_u32 v13, v8, 12, v13
v_add_u32 v59, s62, v13
v_lshrrev_b32 v8, 5, v2
v_mul_u32_u24 v8, 4640, v8
v_and_b32 v9, 31, v2
v_lshl_add_u32 v8, v9, 4, v8
v_add_u32 v8, s62, v8
v_mov_b32 v44, 0
v_mov_b32 v45, 0
v_mov_b32 v46, 0
v_mov_b32 v47, 0
ds_write_b128 v8, v[44:47] offset:20736
v_lshlrev_b32 v55, 3, v62
v_bfe_u32 v9, v2, 2, 2
v_add_u32 v55, v55, v9
v_lshlrev_b32 v55, 8, v55
v_and_b32 v9, 3, v2
v_lshl_add_u32 v55, v9, 3, v55
v_bfe_u32 v9, v2, 2, 3
v_lshl_add_u32 v55, v9, 5, v55
v_add_u32 v55, s11, v55
v_add_u32 v60, s62, v224
s_and_b32 s16, s18, 1
s_lshl_b32 s16, s16, 4
s_lshr_b32 s63, s63, s16
s_and_b32 s63, s63, 0xffff
v_mov_b32 v9, s63
s_lshr_b32 s69, s61, 4
s_lshl_b32 s69, s69, 11
s_add_u32 s69, s69, 87031808
s_lshl_b32 s78, s61, 7
s_add_u32 s78, s78, 87031808
v_lshlrev_b32 v249, 7, v61
v_and_b32 v235, 31, v2
v_lshlrev_b32 v235, 2, v235
s_mul_i32 s68, s87, 0x9e3779b1
s_add_u32 s68, s68, 0x7f4a7c15
s_add_u32 s16, s68, 1
v_mov_b32 v253, s16
v_cmp_eq_u32 vcc, 0, v4
s_nop 1
v_cndmask_b32 v40, 0, v9, vcc
v_cmp_eq_u32 vcc, 0, v5
s_nop 1
v_cndmask_b32 v41, 0, v9, vcc
v_cmp_eq_u32 vcc, 0, v6
s_nop 1
v_cndmask_b32 v42, 0, v9, vcc
v_cmp_eq_u32 vcc, 0, v7
s_nop 1
v_cndmask_b32 v43, 0, v9, vcc
buffer_load_dwordx4 v[192:195], v224, s[24:27], 0 offen offset:0
buffer_load_dwordx4 v[196:199], v224, s[24:27], 0 offen offset:16
buffer_load_dwordx4 v[200:203], v224, s[24:27], 0 offen offset:1024
buffer_load_dwordx4 v[204:207], v224, s[24:27], 0 offen offset:1040
buffer_load_dwordx4 v[208:211], v224, s[24:27], 0 offen offset:2048
buffer_load_dwordx4 v[212:215], v224, s[24:27], 0 offen offset:2064
buffer_load_dwordx4 v[216:219], v224, s[24:27], 0 offen offset:3072
buffer_load_dwordx4 v[220:223], v224, s[24:27], 0 offen offset:3088
buffer_load_dword v64, v4, s[24:27], 0 offen
buffer_load_dword v65, v5, s[24:27], 0 offen
buffer_load_dword v66, v6, s[24:27], 0 offen
buffer_load_dword v67, v7, s[24:27], 0 offen
s_add_u32 s16, s44, 0
buffer_store_dwordx4 v[16:19], v14, s[20:23], s16 offen sc1
s_add_u32 s16, s44, 4096
buffer_store_dwordx4 v[16:19], v14, s[20:23], s16 offen sc1
s_add_u32 s16, s44, 8192
buffer_store_dwordx4 v[16:19], v14, s[20:23], s16 offen sc1
s_add_u32 s16, s44, 12288
buffer_store_dwordx4 v[16:19], v14, s[20:23], s16 offen sc1
buffer_store_dwordx4 v[16:19], v15, s[20:23], s45 offen sc1
s_waitcnt vmcnt(17)
s_barrier
ds_read_b64 v[68:69], v52 offset:640
ds_read_b64 v[70:71], v52 offset:768
ds_read_b64 v[72:73], v52 offset:896
ds_read_b64 v[74:75], v52 offset:1056
ds_read_b64 v[76:77], v52 offset:1184
ds_read_b64 v[78:79], v52 offset:1312
ds_read_b64 v[80:81], v52 offset:1440
ds_read_b64 v[82:83], v52 offset:1568
ds_read_b64 v[84:85], v52 offset:1696
ds_read_b64 v[86:87], v52 offset:1824
ds_read_b64 v[88:89], v52 offset:1952
ds_read_b64 v[90:91], v52 offset:17952
ds_read_b64 v[92:93], v52 offset:18080
ds_read_b64 v[94:95], v52 offset:18208
ds_read_b64 v[96:97], v52 offset:18336
ds_read_b64 v[98:99], v52 offset:18464
ds_read_b64 v[100:101], v52 offset:18592
ds_read_b64 v[102:103], v52 offset:18720
ds_read_b64 v[104:105], v52 offset:18848
v_lshlrev_b32 v116, 16, v108
v_and_b32 v117, 0xffff0000, v108
v_lshlrev_b32 v118, 16, v109
v_and_b32 v119, 0xffff0000, v109
v_lshlrev_b32 v120, 16, v110
v_and_b32 v121, 0xffff0000, v110
v_lshlrev_b32 v122, 16, v111
v_and_b32 v123, 0xffff0000, v111
v_lshlrev_b32 v124, 16, v112
v_and_b32 v125, 0xffff0000, v112
v_lshlrev_b32 v126, 16, v113
v_and_b32 v127, 0xffff0000, v113
v_lshlrev_b32 v128, 16, v114
v_and_b32 v129, 0xffff0000, v114
v_lshlrev_b32 v130, 16, v115
v_and_b32 v131, 0xffff0000, v115
s_waitcnt lgkmcnt(8)
v_lshlrev_b32 v164, 16, v68
v_lshlrev_b32 v165, 16, v70
v_lshlrev_b32 v166, 16, v72
v_lshlrev_b32 v167, 16, v74
v_lshlrev_b32 v168, 16, v76
v_lshlrev_b32 v169, 16, v78
v_lshlrev_b32 v170, 16, v80
v_lshlrev_b32 v171, 16, v82
v_lshlrev_b32 v172, 16, v84
v_lshlrev_b32 v173, 16, v86
v_lshlrev_b32 v174, 16, v88
v_mul_f32 v132, v119, v164
v_mul_f32 v133, v119, v165
v_mul_f32 v134, v119, v166
v_mul_f32 v135, v119, v167
v_mul_f32 v136, v119, v168
v_mul_f32 v137, v119, v169
v_mul_f32 v138, v119, v170
v_mul_f32 v139, v119, v171
v_fmac_f32 v132, v118, v165
v_fmac_f32 v133, v118, v166
v_fmac_f32 v134, v118, v167
v_fmac_f32 v135, v118, v168
v_fmac_f32 v136, v118, v169
v_fmac_f32 v137, v118, v170
v_fmac_f32 v138, v118, v171
v_fmac_f32 v139, v118, v172
v_fmac_f32 v132, v117, v166
v_fmac_f32 v133, v117, v167
v_fmac_f32 v134, v117, v168
v_fmac_f32 v135, v117, v169
v_fmac_f32 v136, v117, v170
v_fmac_f32 v137, v117, v171
v_fmac_f32 v138, v117, v172
v_fmac_f32 v139, v117, v173
v_fmac_f32 v132, v116, v167
v_fmac_f32 v133, v116, v168
v_fmac_f32 v134, v116, v169
v_fmac_f32 v135, v116, v170
v_fmac_f32 v136, v116, v171
v_fmac_f32 v137, v116, v172
v_fmac_f32 v138, v116, v173
v_fmac_f32 v139, v116, v174
s_waitcnt lgkmcnt(0)
v_lshlrev_b32 v167, 16, v90
v_lshlrev_b32 v168, 16, v92
v_lshlrev_b32 v169, 16, v94
v_lshlrev_b32 v170, 16, v96
v_lshlrev_b32 v171, 16, v98
v_lshlrev_b32 v172, 16, v100
v_lshlrev_b32 v173, 16, v102
v_lshlrev_b32 v174, 16, v104
v_mul_f32 v132, v132, v167
v_mul_f32 v133, v133, v168
v_mul_f32 v134, v134, v169
v_mul_f32 v135, v135, v170
v_mul_f32 v136, v136, v171
v_mul_f32 v137, v137, v172
v_mul_f32 v138, v138, v173
v_mul_f32 v139, v139, v174
v_cvt_pk_bf16_f32 v176, v139, v138
v_cvt_pk_bf16_f32 v177, v137, v136
v_cvt_pk_bf16_f32 v178, v135, v134
v_cvt_pk_bf16_f32 v179, v133, v132
buffer_store_dwordx4 v[176:179], v50, s[20:23], 0 offen sc1
v_and_b32 v164, 0xffff0000, v68
v_and_b32 v165, 0xffff0000, v70
v_and_b32 v166, 0xffff0000, v72
v_and_b32 v167, 0xffff0000, v74
v_and_b32 v168, 0xffff0000, v76
v_and_b32 v169, 0xffff0000, v78
v_and_b32 v170, 0xffff0000, v80
v_and_b32 v171, 0xffff0000, v82
v_and_b32 v172, 0xffff0000, v84
v_and_b32 v173, 0xffff0000, v86
v_and_b32 v174, 0xffff0000, v88
v_mul_f32 v140, v123, v164
v_mul_f32 v141, v123, v165
v_mul_f32 v142, v123, v166
v_mul_f32 v143, v123, v167
v_mul_f32 v144, v123, v168
v_mul_f32 v145, v123, v169
v_mul_f32 v146, v123, v170
v_mul_f32 v147, v123, v171
v_fmac_f32 v140, v122, v165
v_fmac_f32 v141, v122, v166
v_fmac_f32 v142, v122, v167
v_fmac_f32 v143, v122, v168
v_fmac_f32 v144, v122, v169
v_fmac_f32 v145, v122, v170
v_fmac_f32 v146, v122, v171
v_fmac_f32 v147, v122, v172
v_fmac_f32 v140, v121, v166
v_fmac_f32 v141, v121, v167
v_fmac_f32 v142, v121, v168
v_fmac_f32 v143, v121, v169
v_fmac_f32 v144, v121, v170
v_fmac_f32 v145, v121, v171
v_fmac_f32 v146, v121, v172
v_fmac_f32 v147, v121, v173
v_fmac_f32 v140, v120, v167
v_fmac_f32 v141, v120, v168
v_fmac_f32 v142, v120, v169
v_fmac_f32 v143, v120, v170
v_fmac_f32 v144, v120, v171
v_fmac_f32 v145, v120, v172
v_fmac_f32 v146, v120, v173
v_fmac_f32 v147, v120, v174
v_and_b32 v167, 0xffff0000, v90
v_and_b32 v168, 0xffff0000, v92
v_and_b32 v169, 0xffff0000, v94
v_and_b32 v170, 0xffff0000, v96
v_and_b32 v171, 0xffff0000, v98
v_and_b32 v172, 0xffff0000, v100
v_and_b32 v173, 0xffff0000, v102
v_and_b32 v174, 0xffff0000, v104
v_mul_f32 v140, v140, v167
v_mul_f32 v141, v141, v168
v_mul_f32 v142, v142, v169
v_mul_f32 v143, v143, v170
v_mul_f32 v144, v144, v171
v_mul_f32 v145, v145, v172
v_mul_f32 v146, v146, v173
v_mul_f32 v147, v147, v174
v_cvt_pk_bf16_f32 v180, v147, v146
v_cvt_pk_bf16_f32 v181, v145, v144
v_cvt_pk_bf16_f32 v182, v143, v142
v_cvt_pk_bf16_f32 v183, v141, v140
buffer_store_dwordx4 v[180:183], v50, s[20:23], s84 offen sc1
v_lshlrev_b32 v164, 16, v69
v_lshlrev_b32 v165, 16, v71
v_lshlrev_b32 v166, 16, v73
v_lshlrev_b32 v167, 16, v75
v_lshlrev_b32 v168, 16, v77
v_lshlrev_b32 v169, 16, v79
v_lshlrev_b32 v170, 16, v81
v_lshlrev_b32 v171, 16, v83
v_lshlrev_b32 v172, 16, v85
v_lshlrev_b32 v173, 16, v87
v_lshlrev_b32 v174, 16, v89
v_mul_f32 v148, v127, v164
v_mul_f32 v149, v127, v165
v_mul_f32 v150, v127, v166
v_mul_f32 v151, v127, v167
v_mul_f32 v152, v127, v168
v_mul_f32 v153, v127, v169
v_mul_f32 v154, v127, v170
v_mul_f32 v155, v127, v171
v_fmac_f32 v148, v126, v165
v_fmac_f32 v149, v126, v166
v_fmac_f32 v150, v126, v167
v_fmac_f32 v151, v126, v168
v_fmac_f32 v152, v126, v169
v_fmac_f32 v153, v126, v170
v_fmac_f32 v154, v126, v171
v_fmac_f32 v155, v126, v172
v_fmac_f32 v148, v125, v166
v_fmac_f32 v149, v125, v167
v_fmac_f32 v150, v125, v168
v_fmac_f32 v151, v125, v169
v_fmac_f32 v152, v125, v170
v_fmac_f32 v153, v125, v171
v_fmac_f32 v154, v125, v172
v_fmac_f32 v155, v125, v173
v_fmac_f32 v148, v124, v167
v_fmac_f32 v149, v124, v168
v_fmac_f32 v150, v124, v169
v_fmac_f32 v151, v124, v170
v_fmac_f32 v152, v124, v171
v_fmac_f32 v153, v124, v172
v_fmac_f32 v154, v124, v173
v_fmac_f32 v155, v124, v174
v_lshlrev_b32 v167, 16, v91
v_lshlrev_b32 v168, 16, v93
v_lshlrev_b32 v169, 16, v95
v_lshlrev_b32 v170, 16, v97
v_lshlrev_b32 v171, 16, v99
v_lshlrev_b32 v172, 16, v101
v_lshlrev_b32 v173, 16, v103
v_lshlrev_b32 v174, 16, v105
v_mul_f32 v148, v148, v167
v_mul_f32 v149, v149, v168
v_mul_f32 v150, v150, v169
v_mul_f32 v151, v151, v170
v_mul_f32 v152, v152, v171
v_mul_f32 v153, v153, v172
v_mul_f32 v154, v154, v173
v_mul_f32 v155, v155, v174
v_cvt_pk_bf16_f32 v184, v155, v154
v_cvt_pk_bf16_f32 v185, v153, v152
v_cvt_pk_bf16_f32 v186, v151, v150
v_cvt_pk_bf16_f32 v187, v149, v148
buffer_store_dwordx4 v[184:187], v50, s[20:23], s85 offen sc1
v_and_b32 v164, 0xffff0000, v69
v_and_b32 v165, 0xffff0000, v71
v_and_b32 v166, 0xffff0000, v73
v_and_b32 v167, 0xffff0000, v75
v_and_b32 v168, 0xffff0000, v77
v_and_b32 v169, 0xffff0000, v79
v_and_b32 v170, 0xffff0000, v81
v_and_b32 v171, 0xffff0000, v83
v_and_b32 v172, 0xffff0000, v85
v_and_b32 v173, 0xffff0000, v87
v_and_b32 v174, 0xffff0000, v89
v_mul_f32 v156, v131, v164
v_mul_f32 v157, v131, v165
v_mul_f32 v158, v131, v166
v_mul_f32 v159, v131, v167
v_mul_f32 v160, v131, v168
v_mul_f32 v161, v131, v169
v_mul_f32 v162, v131, v170
v_mul_f32 v163, v131, v171
v_fmac_f32 v156, v130, v165
v_fmac_f32 v157, v130, v166
v_fmac_f32 v158, v130, v167
v_fmac_f32 v159, v130, v168
v_fmac_f32 v160, v130, v169
v_fmac_f32 v161, v130, v170
v_fmac_f32 v162, v130, v171
v_fmac_f32 v163, v130, v172
v_fmac_f32 v156, v129, v166
v_fmac_f32 v157, v129, v167
v_fmac_f32 v158, v129, v168
v_fmac_f32 v159, v129, v169
v_fmac_f32 v160, v129, v170
v_fmac_f32 v161, v129, v171
v_fmac_f32 v162, v129, v172
v_fmac_f32 v163, v129, v173
v_fmac_f32 v156, v128, v167
v_fmac_f32 v157, v128, v168
v_fmac_f32 v158, v128, v169
v_fmac_f32 v159, v128, v170
v_fmac_f32 v160, v128, v171
v_fmac_f32 v161, v128, v172
v_fmac_f32 v162, v128, v173
v_fmac_f32 v163, v128, v174
v_and_b32 v167, 0xffff0000, v91
v_and_b32 v168, 0xffff0000, v93
v_and_b32 v169, 0xffff0000, v95
v_and_b32 v170, 0xffff0000, v97
v_and_b32 v171, 0xffff0000, v99
v_and_b32 v172, 0xffff0000, v101
v_and_b32 v173, 0xffff0000, v103
v_and_b32 v174, 0xffff0000, v105
v_mul_f32 v156, v156, v167
v_mul_f32 v157, v157, v168
v_mul_f32 v158, v158, v169
v_mul_f32 v159, v159, v170
v_mul_f32 v160, v160, v171
v_mul_f32 v161, v161, v172
v_mul_f32 v162, v162, v173
v_mul_f32 v163, v163, v174
v_cvt_pk_bf16_f32 v188, v163, v162
v_cvt_pk_bf16_f32 v189, v161, v160
v_cvt_pk_bf16_f32 v190, v159, v158
v_cvt_pk_bf16_f32 v191, v157, v156
buffer_store_dwordx4 v[188:191], v50, s[20:23], s86 offen sc1
s_waitcnt vmcnt(13)
v_mov_b32 v72, v193
v_mov_b32 v73, v194
v_mov_b32 v74, v195
v_mov_b32 v75, v196
v_mov_b32 v76, v197
v_mov_b32 v77, v198
ds_write_b128 v60, v[72:75] offset:0
ds_write_b128 v60, v[194:197] offset:4160
ds_write_b128 v60, v[74:77] offset:8320
ds_write_b128 v60, v[196:199] offset:12480
v_mov_b32 v80, v201
v_mov_b32 v81, v202
v_mov_b32 v82, v203
v_mov_b32 v83, v204
v_mov_b32 v84, v205
v_mov_b32 v85, v206
ds_write_b128 v60, v[80:83] offset:1024
ds_write_b128 v60, v[202:205] offset:5184
ds_write_b128 v60, v[82:85] offset:9344
ds_write_b128 v60, v[204:207] offset:13504
v_mov_b32 v88, v209
v_mov_b32 v89, v210
v_mov_b32 v90, v211
v_mov_b32 v91, v212
v_mov_b32 v92, v213
v_mov_b32 v93, v214
ds_write_b128 v60, v[88:91] offset:2048
ds_write_b128 v60, v[210:213] offset:6208
ds_write_b128 v60, v[90:93] offset:10368
ds_write_b128 v60, v[212:215] offset:14528
v_mov_b32 v96, v217
v_mov_b32 v97, v218
v_mov_b32 v98, v219
v_mov_b32 v99, v220
v_mov_b32 v100, v221
v_mov_b32 v101, v222
ds_write_b128 v60, v[96:99] offset:3072
ds_write_b128 v60, v[218:221] offset:7232
ds_write_b128 v60, v[98:101] offset:11392
ds_write_b128 v60, v[220:223] offset:15552
s_waitcnt vmcnt(0)
s_barrier
s_cmp_lg_u32 s17, 0
s_cbranch_scc1 L_nokvf
s_mov_b32 exec_hi, 0
buffer_store_dword v253, v235, s[20:23], s78 offen sc1
s_mov_b32 exec_hi, -1
L_nokvf:
s_lshl_b32 s16, s2, 2
s_add_u32 s16, s16, 86052864
s_cmp_lg_u32 s17, 1
s_cbranch_scc1 L_noarm
s_mov_b64 exec, 1
buffer_store_dword v253, off, s[20:23], s16 sc1
s_mov_b64 exec, -1
L_noarm:
s_lshl_b32 s36, s17, 12
s_lshr_b32 s13, s59, 1
s_lshl_b32 s12, s13, 3
s_lshr_b32 s15, s60, 2
s_add_u32 s12, s12, s15
s_and_b32 s14, s59, 1
s_lshl_b32 s14, s14, 2
s_and_b32 s15, s60, 3
s_add_u32 s14, s14, s15
s_lshl_b32 s14, s14, 2
s_add_u32 s14, s14, s17
s_lshl_b32 s16, s32, 2
s_add_u32 s16, s16, s17
s_mul_i32 s37, s12, 458752
s_add_u32 s37, s37, 52428800
s_mul_i32 s38, s35, 458752
s_add_u32 s38, s38, 69206016
s_lshl_b32 s39, s14, 17
s_add_u32 s39, s39, 9437184
s_lshl_b32 s42, s16, 14
s_lshl_b32 s15, s34, 10
s_add_u32 s42, s42, s15
s_lshl_b32 s15, s33, 22
s_add_u32 s42, s42, s15
s_add_u32 s42, s42, 88080384
s_lshr_b32 s88, s19, 1
s_lshl_b32 s43, s88, 15
s_lshl_b32 s88, s88, 13
s_and_b32 s15, s19, 1
s_lshl_b32 s15, s15, 7
s_add_u32 s88, s88, s15
s_add_u32 s43, s43, s15
s_lshl_b32 s52, s14, 7
s_lshl_b32 s15, s13, 12
s_add_u32 s52, s52, s15
s_add_u32 s52, s52, 86016000
s_lshr_b32 s51, s19, 3
s_lshl_b32 s51, s51, 7
s_lshl_b32 s15, s34, 2
s_add_u32 s51, s51, s15
s_add_u32 s51, s51, s36
s_add_u32 s51, s51, 86016000
s_lshr_b32 s50, s19, 2
s_lshl_b32 s50, s50, 11
s_add_u32 s50, s50, 86507520
s_lshl_b32 s49, s16, 11
s_lshl_b32 s15, s35, 7
s_add_u32 s49, s49, s15
s_add_u32 s49, s49, 86507520
s_lshl_b32 s45, s14, 8
s_lshr_b32 s15, s12, 4
s_lshl_b32 s15, s15, 7
s_add_u32 s45, s45, s15
s_and_b32 s15, s12, 15
s_lshl_b32 s15, s15, 2
s_add_u32 s45, s45, s15
s_add_u32 s45, s45, 86114304
s_lshr_b32 s46, s16, 1
s_lshl_b32 s46, s46, 8
s_lshl_b32 s15, s33, 7
s_add_u32 s46, s46, s15
s_add_u32 s46, s46, 86114304
s_mul_i32 s40, s16, 229376
s_mul_i32 s15, s33, 57344
s_add_u32 s40, s40, s15
s_add_u32 s40, s40, 18874368
s_mul_i32 s41, s14, 458752
s_lshr_b32 s15, s12, 4
s_mul_i32 s15, s15, 57344
s_add_u32 s41, s41, s15
s_and_b32 s15, s12, 15
s_lshl_b32 s15, s15, 9
s_add_u32 s41, s41, s15
s_add_u32 s41, s41, 18874368
s_lshl_b32 s48, s35, 8
s_add_u32 s48, s48, 85987328
s_mul_i32 s15, s12, 7
s_lshr_b32 s15, s15, 3
s_min_u32 s15, s15, 26
s_lshl_b32 s15, s15, 7
s_add_u32 s19, s15, 85983232
s_add_u32 s15, s32, s34
s_and_b32 s15, s15, 1
s_mul_i32 s86, s15, 4096
s_mul_i32 s15, s15, 32768
s_add_u32 s92, s38, s15
s_sub_u32 s93, s38, s15
s_lshl_b32 s12, s2, 2
s_add_u32 s12, s12, s17
s_lshr_b32 s13, s12, 3
s_and_b32 s12, s12, 7
s_cmp_ge_u32 s13, 56
s_cselect_b32 s14, 1, 0
s_cselect_b32 s15, 56, 0
s_sub_u32 s13, s13, s15
s_lshl_b32 s15, s14, 3
s_add_u32 s15, s15, s12
s_lshl_b32 s47, s15, 8
s_lshl_b32 s16, s13, 2
s_add_u32 s47, s47, s16
s_add_u32 s47, s47, 85987328
s_mul_i32 s55, s15, 458752
s_and_b32 s32, s13, 1
s_sub_u32 s33, s13, s32
s_lshl_b32 s16, s33, 13
s_lshl_b32 s60, s33, 11
s_add_u32 s60, s60, 270336
s_cmp_lt_u32 s13, 44
s_cselect_b32 s16, s16, s60
s_cselect_b32 s60, 2, 12
s_lshl_b32 s60, s60, 11
s_lshl_b32 s32, s32, 10
s_add_u32 s16, s16, s32
s_add_u32 s55, s55, s16
s_add_u32 s55, s55, 69206016
s_and_b32 s15, s13, 7
s_mul_i32 s15, s15, 224
s_lshr_b32 s16, s13, 3
s_lshl_b32 s16, s16, 4
s_add_u32 s15, s15, s16
s_mul_i32 s14, s14, 1792
s_add_u32 s15, s15, s14
s_add_u32 s16, s15, 112
s_lshl_b32 s12, s12, 8
s_lshl_b32 s53, s15, 11
s_add_u32 s53, s53, s12
s_lshl_b32 s54, s16, 11
s_add_u32 s54, s54, s12
v_add_u32 v225, 0x10000, v224
v_add_u32 v226, s36, v224
v_lshrrev_b32 v21, 5, v2
v_and_b32 v22, 31, v2
v_lshlrev_b32 v22, 4, v22
v_mul_u32_u24 v23, 114688, v21
v_add_u32 v227, v23, v22
v_mov_b32 v228, 0xbdd2d3e8
v_lshlrev_b32 v229, 2, v2
v_lshrrev_b32 v24, 4, v2
v_and_b32 v25, 15, v2
v_lshlrev_b32 v25, 4, v25
v_lshl_add_u32 v231, v24, 11, v25
v_bfe_u32 v25, v2, 2, 3
v_lshlrev_b32 v25, 8, v25
v_lshl_add_u32 v25, v21, 14, v25
v_and_b32 v24, 3, v2
v_lshl_add_u32 v25, v24, 4, v25
v_add_u32 v232, s36, v25
buffer_load_dword v234, v249, s[20:23], s69 offen sc1
s_waitcnt vmcnt(0)
v_cmp_ne_u32 vcc, v253, v234
s_nop 0
s_and_b32 s14, vcc_lo, 0xffff
s_cbranch_scc1 L_poll2
L_poll2_ok:
buffer_load_dwordx4 v[128:131], v224, s[72:75], 0 offen offset:0 sc1
buffer_load_dword v132, v224, s[72:75], 0 offen offset:16 sc1
buffer_load_dwordx4 v[136:139], v224, s[72:75], 0 offen offset:1024 sc1
buffer_load_dword v140, v224, s[72:75], 0 offen offset:1040 sc1
buffer_load_dwordx4 v[144:147], v224, s[72:75], 0 offen offset:2048 sc1
buffer_load_dword v148, v224, s[72:75], 0 offen offset:2064 sc1
buffer_load_dwordx4 v[152:155], v224, s[72:75], 0 offen offset:3072 sc1
buffer_load_dword v156, v224, s[72:75], 0 offen offset:3088 sc1
s_mul_i32 s12, s2, 4
s_add_u32 s12, s12, s17
s_add_u32 s12, s12, 0
s_mul_hi_u32 s14, s12, 153391690
s_mul_i32 s16, s14, 28
s_sub_u32 s12, s12, s16
s_and_b32 s15, s14, 1
s_lshr_b32 s14, s14, 1
s_cmp_eq_u32 s15, 0
s_cselect_b32 s24, s96, s98
s_cselect_b32 s25, s97, s99
s_mul_i32 s10, s14, 229376
s_lshl_b32 s16, s12, 8
s_add_u32 s10, s10, s16
s_lshl_b32 s78, s14, 1
s_add_u32 s78, s78, s15
s_lshl_b32 s78, s78, 2
s_lshl_b32 s16, s12, 7
s_add_u32 s78, s78, s16
s_add_u32 s78, s78, 85983088
s_and_b32 s18, s14, 1
s_sub_u32 s57, s14, s18
s_add_u32 s57, s57, s15
s_mul_i32 s58, s57, 14
s_lshl_b32 s59, s57, 1
s_add_u32 s59, s59, 216
s_cmp_lt_u32 s14, 18
s_cselect_b32 s58, s58, s59
s_cselect_b32 s59, 2, 28
s_cmp_lt_u32 s14, 18
s_cselect_b32 s62, 0, s78
s_add_u32 s58, s58, s18
s_add_u32 s58, s58, 51200
s_lshl_b32 s12, s12, 3
s_mul_i32 s16, s12, 9363
s_lshr_b32 s16, s16, 16
s_mul_i32 s78, s16, 7
s_sub_u32 s78, s12, s78
s_mul_i32 s16, s16, 448
s_add_u32 s58, s58, s16
s_mul_i32 s16, s78, s59
s_add_u32 s58, s58, s16
s_lshl_b32 s84, s58, 10
s_lshl_b32 s59, s59, 10
s_mul_i32 s79, s59, 6
s_sub_u32 s79, 458752, s79
s_cmp_eq_u32 s78, 6
s_cselect_b32 s16, s79, s59
s_add_u32 s85, s84, s16
s_cmp_eq_u32 s78, 5
s_cselect_b32 s16, s79, s59
s_add_u32 s89, s85, s16
s_cmp_eq_u32 s78, 4
s_cselect_b32 s16, s79, s59
s_add_u32 s90, s89, s16
s_cmp_eq_u32 s78, 3
s_cselect_b32 s16, s79, s59
s_add_u32 s91, s90, s16
s_cmp_eq_u32 s78, 2
s_cselect_b32 s16, s79, s59
s_add_u32 s94, s91, s16
s_cmp_eq_u32 s78, 1
s_cselect_b32 s16, s79, s59
s_add_u32 s95, s94, s16
s_cmp_eq_u32 s78, 0
s_cselect_b32 s16, s79, s59
s_add_u32 s69, s95, s16
s_mul_i32 s12, s2, 3
s_add_u32 s12, s12, s17
s_add_u32 s12, s12, 1024
s_mul_hi_u32 s14, s12, 153391690
s_mul_i32 s16, s14, 28
s_sub_u32 s12, s12, s16
s_and_b32 s15, s14, 1
s_lshr_b32 s14, s14, 1
s_cmp_eq_u32 s15, 0
s_cselect_b32 s96, s96, s98
s_cselect_b32 s97, s97, s99
s_mul_i32 s13, s14, 229376
s_lshl_b32 s16, s12, 8
s_add_u32 s13, s13, s16
s_lshl_b32 s78, s14, 1
s_add_u32 s78, s78, s15
s_lshl_b32 s78, s78, 2
s_lshl_b32 s16, s12, 7
s_add_u32 s78, s78, s16
s_add_u32 s78, s78, 85983088
s_and_b32 s18, s14, 1
s_sub_u32 s57, s14, s18
s_add_u32 s57, s57, s15
s_mul_i32 s58, s57, 14
s_lshl_b32 s59, s57, 1
s_add_u32 s59, s59, 216
s_cmp_lt_u32 s14, 18
s_cselect_b32 s58, s58, s59
s_cselect_b32 s59, 2, 28
s_cmp_lt_u32 s14, 18
s_cselect_b32 s63, 0, s78
s_add_u32 s58, s58, s18
s_add_u32 s58, s58, 51200
s_lshl_b32 s12, s12, 3
s_mul_i32 s16, s12, 9363
s_lshr_b32 s16, s16, 16
s_mul_i32 s78, s16, 7
s_sub_u32 s78, s12, s78
s_mul_i32 s16, s16, 448
s_add_u32 s58, s58, s16
s_mul_i32 s16, s78, s59
s_add_u32 s58, s58, s16
s_lshl_b32 s70, s58, 10
s_lshl_b32 s59, s59, 10
s_mul_i32 s79, s59, 6
s_sub_u32 s79, 458752, s79
s_cmp_eq_u32 s78, 6
s_cselect_b32 s16, s79, s59
s_add_u32 s71, s70, s16
s_cmp_eq_u32 s78, 5
s_cselect_b32 s16, s79, s59
s_add_u32 s72, s71, s16
s_cmp_eq_u32 s78, 4
s_cselect_b32 s16, s79, s59
s_add_u32 s73, s72, s16
s_cmp_eq_u32 s78, 3
s_cselect_b32 s16, s79, s59
s_add_u32 s74, s73, s16
s_cmp_eq_u32 s78, 2
s_cselect_b32 s16, s79, s59
s_add_u32 s75, s74, s16
s_cmp_eq_u32 s78, 1
s_cselect_b32 s16, s79, s59
s_add_u32 s76, s75, s16
s_cmp_eq_u32 s78, 0
s_cselect_b32 s16, s79, s59
s_add_u32 s77, s76, s16
s_mov_b32 s26, 7340032
s_cmp_eq_u32 s17, 3
s_cselect_b32 s63, 0, s63
s_cselect_b32 s30, 0, s30
s_cselect_b32 s98, 0, 7340032
s_mov_b32 s32, s100
s_mov_b32 s33, s101
s_mov_b32 s34, 0x400000
s_mov_b32 s35, 0x20000
s_waitcnt vmcnt(6)
ds_write_b128 v60, v[128:131] offset:21280
v_alignbit_b32 v160, v129, v128, 16
v_alignbit_b32 v161, v130, v129, 16
v_alignbit_b32 v162, v131, v130, 16
v_alignbit_b32 v163, v132, v131, 16
ds_write_b128 v60, v[160:163] offset:16640
s_waitcnt vmcnt(4)
ds_write_b128 v60, v[136:139] offset:22304
v_alignbit_b32 v164, v137, v136, 16
v_alignbit_b32 v165, v138, v137, 16
v_alignbit_b32 v166, v139, v138, 16
v_alignbit_b32 v167, v140, v139, 16
ds_write_b128 v60, v[164:167] offset:17664
s_waitcnt vmcnt(2)
ds_write_b128 v60, v[144:147] offset:23328
v_alignbit_b32 v168, v145, v144, 16
v_alignbit_b32 v169, v146, v145, 16
v_alignbit_b32 v170, v147, v146, 16
v_alignbit_b32 v171, v148, v147, 16
ds_write_b128 v60, v[168:171] offset:18688
s_waitcnt vmcnt(0)
ds_write_b128 v60, v[152:155] offset:24352
v_alignbit_b32 v172, v153, v152, 16
v_alignbit_b32 v173, v154, v153, 16
v_alignbit_b32 v174, v155, v154, 16
v_alignbit_b32 v175, v156, v155, 16
ds_write_b128 v60, v[172:175] offset:19712
ds_read_b128 v[96:99], v57 offset:3584
ds_read_b128 v[100:103], v57 offset:3072
ds_read_b128 v[68:71], v56 offset:448
ds_read_b128 v[104:107], v57 offset:2560
ds_read_b128 v[72:75], v56 offset:960
ds_read_b128 v[108:111], v57 offset:2048
ds_read_b128 v[76:79], v56 offset:1472
ds_read_b128 v[112:115], v57 offset:1536
ds_read_b128 v[80:83], v56 offset:1984
ds_read_b128 v[116:119], v57 offset:1024
ds_read_b128 v[84:87], v56 offset:2496
ds_read_b128 v[120:123], v57 offset:512
ds_read_b128 v[88:91], v56 offset:3008
ds_read_b128 v[124:127], v57 offset:0
ds_read_b128 v[92:95], v56 offset:3520
s_waitcnt lgkmcnt(14)
v_mfma_f32_16x16x32_bf16 v[8:11], v[40:43], v[96:99], 0
s_waitcnt lgkmcnt(13)
v_mfma_f32_16x16x32_bf16 v[12:15], v[40:43], v[100:103], 0
s_waitcnt lgkmcnt(11)
v_mfma_f32_16x16x32_bf16 v[16:19], v[40:43], v[104:107], 0
s_waitcnt lgkmcnt(9)
v_mfma_f32_16x16x32_bf16 v[20:23], v[40:43], v[108:111], 0
s_waitcnt lgkmcnt(7)
v_mfma_f32_16x16x32_bf16 v[24:27], v[40:43], v[112:115], 0
s_waitcnt lgkmcnt(5)
v_mfma_f32_16x16x32_bf16 v[28:31], v[40:43], v[116:119], 0
s_waitcnt lgkmcnt(3)
v_mfma_f32_16x16x32_bf16 v[32:35], v[40:43], v[120:123], 0
s_waitcnt lgkmcnt(1)
v_mfma_f32_16x16x32_bf16 v[36:39], v[40:43], v[124:127], 0
v_mfma_f32_16x16x32_bf16 v[8:11], v[64:67], v[96:99], v[8:11]
s_add_u32 m0, s11, 0
s_add_u32 s12, s10, 0
buffer_load_dwordx4 v54, s[24:27], s12 offen nt lds
v_mfma_f32_16x16x32_bf16 v[12:15], v[64:67], v[100:103], v[12:15]
ds_read_b128 v[160:163], v57 offset:3648
v_mfma_f32_16x16x32_bf16 v[12:15], v[68:71], v[96:99], v[12:15]
v_mfma_f32_16x16x32_bf16 v[16:19], v[72:75], v[96:99], v[16:19]
ds_read_b128 v[128:131], v56 offset:0
v_mfma_f32_16x16x32_bf16 v[16:19], v[68:71], v[100:103], v[16:19]
s_add_u32 m0, s11, 1024
s_add_u32 s12, s10, 28672
buffer_load_dwordx4 v54, s[24:27], s12 offen nt lds
v_mfma_f32_16x16x32_bf16 v[16:19], v[64:67], v[104:107], v[16:19]
ds_read_b128 v[164:167], v57 offset:3136
v_mfma_f32_16x16x32_bf16 v[20:23], v[64:67], v[108:111], v[20:23]
v_mfma_f32_16x16x32_bf16 v[20:23], v[68:71], v[104:107], v[20:23]
ds_read_b128 v[132:135], v56 offset:512
v_mfma_f32_16x16x32_bf16 v[20:23], v[72:75], v[100:103], v[20:23]
s_add_u32 m0, s11, 2048
s_add_u32 s12, s10, 57344
buffer_load_dwordx4 v58, s[24:27], s12 offen nt lds
v_mfma_f32_16x16x32_bf16 v[20:23], v[76:79], v[96:99], v[20:23]
ds_read_b128 v[168:171], v57 offset:2624
v_mfma_f32_16x16x32_bf16 v[24:27], v[80:83], v[96:99], v[24:27]
v_mfma_f32_16x16x32_bf16 v[24:27], v[76:79], v[100:103], v[24:27]
ds_read_b128 v[136:139], v56 offset:1024
v_mfma_f32_16x16x32_bf16 v[24:27], v[72:75], v[104:107], v[24:27]
s_add_u32 m0, s11, 3072
s_add_u32 s12, s10, 86016
buffer_load_dwordx4 v58, s[24:27], s12 offen nt lds
v_mfma_f32_16x16x32_bf16 v[24:27], v[68:71], v[108:111], v[24:27]
ds_read_b128 v[172:175], v57 offset:2112
v_mfma_f32_16x16x32_bf16 v[24:27], v[64:67], v[112:115], v[24:27]
v_mfma_f32_16x16x32_bf16 v[28:31], v[64:67], v[116:119], v[28:31]
ds_read_b128 v[140:143], v56 offset:1536
v_mfma_f32_16x16x32_bf16 v[28:31], v[68:71], v[112:115], v[28:31]
s_add_u32 m0, s11, 4096
s_add_u32 s12, s10, 114688
buffer_load_dwordx4 v54, s[24:27], s12 offen nt lds
v_mfma_f32_16x16x32_bf16 v[28:31], v[72:75], v[108:111], v[28:31]
ds_read_b128 v[176:179], v57 offset:1600
v_mfma_f32_16x16x32_bf16 v[28:31], v[76:79], v[104:107], v[28:31]
v_mfma_f32_16x16x32_bf16 v[28:31], v[80:83], v[100:103], v[28:31]
ds_read_b128 v[144:147], v56 offset:2048
v_mfma_f32_16x16x32_bf16 v[28:31], v[84:87], v[96:99], v[28:31]
s_add_u32 m0, s11, 5120
s_add_u32 s12, s10, 143360
buffer_load_dwordx4 v54, s[24:27], s12 offen nt lds
v_mfma_f32_16x16x32_bf16 v[32:35], v[88:91], v[96:99], v[32:35]
ds_read_b128 v[180:183], v57 offset:1088
v_mfma_f32_16x16x32_bf16 v[32:35], v[84:87], v[100:103], v[32:35]
v_mfma_f32_16x16x32_bf16 v[32:35], v[80:83], v[104:107], v[32:35]
ds_read_b128 v[148:151], v56 offset:2560
v_mfma_f32_16x16x32_bf16 v[32:35], v[76:79], v[108:111], v[32:35]
s_add_u32 m0, s11, 6144
s_add_u32 s12, s10, 172032
buffer_load_dwordx4 v58, s[24:27], s12 offen nt lds
v_mfma_f32_16x16x32_bf16 v[32:35], v[72:75], v[112:115], v[32:35]
ds_read_b128 v[184:187], v57 offset:576
v_mfma_f32_16x16x32_bf16 v[32:35], v[68:71], v[116:119], v[32:35]
v_mfma_f32_16x16x32_bf16 v[32:35], v[64:67], v[120:123], v[32:35]
ds_read_b128 v[152:155], v56 offset:3072
v_mfma_f32_16x16x32_bf16 v[36:39], v[64:67], v[124:127], v[36:39]
s_add_u32 m0, s11, 7168
s_add_u32 s12, s10, 200704
buffer_load_dwordx4 v58, s[24:27], s12 offen nt lds
v_mfma_f32_16x16x32_bf16 v[36:39], v[68:71], v[120:123], v[36:39]
ds_read_b128 v[188:191], v57 offset:64
v_mfma_f32_16x16x32_bf16 v[36:39], v[72:75], v[116:119], v[36:39]
v_mfma_f32_16x16x32_bf16 v[36:39], v[76:79], v[112:115], v[36:39]
ds_read_b128 v[156:159], v56 offset:3584
v_mfma_f32_16x16x32_bf16 v[36:39], v[80:83], v[108:111], v[36:39]
v_mfma_f32_16x16x32_bf16 v[36:39], v[84:87], v[104:107], v[36:39]
v_mfma_f32_16x16x32_bf16 v[36:39], v[88:91], v[100:103], v[36:39]
s_waitcnt lgkmcnt(14)
v_mfma_f32_16x16x32_bf16 v[36:39], v[92:95], v[96:99], v[36:39]
v_mfma_f32_16x16x32_bf16 v[8:11], v[128:131], v[160:163], v[8:11]
s_mov_b32 s79, 86052864
buffer_load_dwordx4 v[236:239], v224, s[20:23], s79 offen sc1
s_waitcnt lgkmcnt(13)
v_mfma_f32_16x16x32_bf16 v[12:15], v[128:131], v[164:167], v[12:15]
ds_read_b128 v[96:99], v57 offset:3712
s_waitcnt lgkmcnt(13)
v_mfma_f32_16x16x32_bf16 v[12:15], v[132:135], v[160:163], v[12:15]
s_waitcnt lgkmcnt(11)
v_mfma_f32_16x16x32_bf16 v[16:19], v[136:139], v[160:163], v[16:19]
ds_read_b128 v[64:67], v56 offset:64
v_mfma_f32_16x16x32_bf16 v[16:19], v[132:135], v[164:167], v[16:19]
v_mfma_f32_16x16x32_bf16 v[16:19], v[128:131], v[168:171], v[16:19]
ds_read_b128 v[100:103], v57 offset:3200
s_waitcnt lgkmcnt(12)
v_mfma_f32_16x16x32_bf16 v[20:23], v[128:131], v[172:175], v[20:23]
v_mfma_f32_16x16x32_bf16 v[20:23], v[132:135], v[168:171], v[20:23]
ds_read_b128 v[68:71], v56 offset:576
v_mfma_f32_16x16x32_bf16 v[20:23], v[136:139], v[164:167], v[20:23]
s_waitcnt lgkmcnt(12)
v_mfma_f32_16x16x32_bf16 v[20:23], v[140:143], v[160:163], v[20:23]
ds_read_b128 v[104:107], v57 offset:2688
s_waitcnt lgkmcnt(11)
v_mfma_f32_16x16x32_bf16 v[24:27], v[144:147], v[160:163], v[24:27]
v_mfma_f32_16x16x32_bf16 v[24:27], v[140:143], v[164:167], v[24:27]
ds_read_b128 v[72:75], v56 offset:1088
v_mfma_f32_16x16x32_bf16 v[24:27], v[136:139], v[168:171], v[24:27]
v_mfma_f32_16x16x32_bf16 v[24:27], v[132:135], v[172:175], v[24:27]
ds_read_b128 v[108:111], v57 offset:2176
v_mfma_f32_16x16x32_bf16 v[24:27], v[128:131], v[176:179], v[24:27]
s_waitcnt lgkmcnt(12)
v_mfma_f32_16x16x32_bf16 v[28:31], v[128:131], v[180:183], v[28:31]
ds_read_b128 v[76:79], v56 offset:1600
v_mfma_f32_16x16x32_bf16 v[28:31], v[132:135], v[176:179], v[28:31]
v_mfma_f32_16x16x32_bf16 v[28:31], v[136:139], v[172:175], v[28:31]
ds_read_b128 v[112:115], v57 offset:1664
v_mfma_f32_16x16x32_bf16 v[28:31], v[140:143], v[168:171], v[28:31]
v_mfma_f32_16x16x32_bf16 v[28:31], v[144:147], v[164:167], v[28:31]
ds_read_b128 v[80:83], v56 offset:2112
s_waitcnt lgkmcnt(14)
v_mfma_f32_16x16x32_bf16 v[28:31], v[148:151], v[160:163], v[28:31]
s_waitcnt lgkmcnt(12)
v_mfma_f32_16x16x32_bf16 v[32:35], v[152:155], v[160:163], v[32:35]
ds_read_b128 v[116:119], v57 offset:1152
v_mfma_f32_16x16x32_bf16 v[32:35], v[148:151], v[164:167], v[32:35]
v_mfma_f32_16x16x32_bf16 v[32:35], v[144:147], v[168:171], v[32:35]
ds_read_b128 v[84:87], v56 offset:2624
v_mfma_f32_16x16x32_bf16 v[32:35], v[140:143], v[172:175], v[32:35]
v_mfma_f32_16x16x32_bf16 v[32:35], v[136:139], v[176:179], v[32:35]
ds_read_b128 v[120:123], v57 offset:640
v_mfma_f32_16x16x32_bf16 v[32:35], v[132:135], v[180:183], v[32:35]
v_mfma_f32_16x16x32_bf16 v[32:35], v[128:131], v[184:187], v[32:35]
ds_read_b128 v[88:91], v56 offset:3136
s_waitcnt lgkmcnt(14)
v_mfma_f32_16x16x32_bf16 v[36:39], v[128:131], v[188:191], v[36:39]
v_mfma_f32_16x16x32_bf16 v[36:39], v[132:135], v[184:187], v[36:39]
ds_read_b128 v[124:127], v57 offset:128
v_mfma_f32_16x16x32_bf16 v[36:39], v[136:139], v[180:183], v[36:39]
v_mfma_f32_16x16x32_bf16 v[36:39], v[140:143], v[176:179], v[36:39]
ds_read_b128 v[92:95], v56 offset:3648
v_mfma_f32_16x16x32_bf16 v[36:39], v[144:147], v[172:175], v[36:39]
v_mfma_f32_16x16x32_bf16 v[36:39], v[148:151], v[168:171], v[36:39]
v_mfma_f32_16x16x32_bf16 v[36:39], v[152:155], v[164:167], v[36:39]
v_mfma_f32_16x16x32_bf16 v[36:39], v[156:159], v[160:163], v[36:39]
s_waitcnt lgkmcnt(14)
v_mfma_f32_16x16x32_bf16 v[8:11], v[64:67], v[96:99], v[8:11]
s_waitcnt vmcnt(1)
s_waitcnt lgkmcnt(13)
v_mfma_f32_16x16x32_bf16 v[12:15], v[64:67], v[100:103], v[12:15]
ds_read_b128 v[160:163], v57 offset:3776
s_waitcnt lgkmcnt(13)
v_mfma_f32_16x16x32_bf16 v[12:15], v[68:71], v[96:99], v[12:15]
v_xor_b32 v48, 0, v55
ds_read_b64_tr_b16 a[0:1], v48 offset:0
s_waitcnt lgkmcnt(12)
v_mfma_f32_16x16x32_bf16 v[16:19], v[72:75], v[96:99], v[16:19]
ds_read_b128 v[128:131], v56 offset:128
v_mfma_f32_16x16x32_bf16 v[16:19], v[68:71], v[100:103], v[16:19]
ds_read_b64_tr_b16 a[2:3], v48 offset:1024
v_mfma_f32_16x16x32_bf16 v[16:19], v[64:67], v[104:107], v[16:19]
ds_read_b128 v[164:167], v57 offset:3264
s_waitcnt lgkmcnt(14)
v_mfma_f32_16x16x32_bf16 v[20:23], v[64:67], v[108:111], v[20:23]
v_xor_b32 v49, 32, v55
ds_read_b64_tr_b16 a[4:5], v49 offset:0
v_mfma_f32_16x16x32_bf16 v[20:23], v[68:71], v[104:107], v[20:23]
ds_read_b128 v[132:135], v56 offset:640
v_mfma_f32_16x16x32_bf16 v[20:23], v[72:75], v[100:103], v[20:23]
ds_read_b64_tr_b16 a[6:7], v49 offset:1024
s_waitcnt lgkmcnt(14)
v_mfma_f32_16x16x32_bf16 v[20:23], v[76:79], v[96:99], v[20:23]
ds_read_b128 v[168:171], v57 offset:2752
v_mfma_f32_16x16x32_bf16 v[24:27], v[80:83], v[96:99], v[24:27]
v_xor_b32 v48, 64, v55
ds_read_b64_tr_b16 a[8:9], v48 offset:0
v_mfma_f32_16x16x32_bf16 v[24:27], v[76:79], v[100:103], v[24:27]
ds_read_b128 v[136:139], v56 offset:1152
v_mfma_f32_16x16x32_bf16 v[24:27], v[72:75], v[104:107], v[24:27]
ds_read_b64_tr_b16 a[10:11], v48 offset:1024
v_mfma_f32_16x16x32_bf16 v[24:27], v[68:71], v[108:111], v[24:27]
ds_read_b128 v[172:175], v57 offset:2240
v_mfma_f32_16x16x32_bf16 v[24:27], v[64:67], v[112:115], v[24:27]
v_xor_b32 v49, 96, v55
ds_read_b64_tr_b16 a[12:13], v49 offset:0
s_waitcnt lgkmcnt(14)
v_mfma_f32_16x16x32_bf16 v[28:31], v[64:67], v[116:119], v[28:31]
ds_read_b128 v[140:143], v56 offset:1664
v_mfma_f32_16x16x32_bf16 v[28:31], v[68:71], v[112:115], v[28:31]
ds_read_b64_tr_b16 a[14:15], v49 offset:1024
v_mfma_f32_16x16x32_bf16 v[28:31], v[72:75], v[108:111], v[28:31]
ds_read_b128 v[176:179], v57 offset:1728
v_mfma_f32_16x16x32_bf16 v[28:31], v[76:79], v[104:107], v[28:31]
v_xor_b32 v48, 128, v55
ds_read_b64_tr_b16 a[16:17], v48 offset:0
v_mfma_f32_16x16x32_bf16 v[28:31], v[80:83], v[100:103], v[28:31]
ds_read_b128 v[144:147], v56 offset:2176
v_mfma_f32_16x16x32_bf16 v[28:31], v[84:87], v[96:99], v[28:31]
ds_read_b64_tr_b16 a[18:19], v48 offset:1024
v_mfma_f32_16x16x32_bf16 v[32:35], v[88:91], v[96:99], v[32:35]
ds_read_b128 v[180:183], v57 offset:1216
v_mfma_f32_16x16x32_bf16 v[32:35], v[84:87], v[100:103], v[32:35]
v_mfma_f32_16x16x32_bf16 v[32:35], v[80:83], v[104:107], v[32:35]
ds_read_b128 v[148:151], v56 offset:2688
v_mfma_f32_16x16x32_bf16 v[32:35], v[76:79], v[108:111], v[32:35]
v_mfma_f32_16x16x32_bf16 v[32:35], v[72:75], v[112:115], v[32:35]
ds_read_b128 v[184:187], v57 offset:704
v_mfma_f32_16x16x32_bf16 v[32:35], v[68:71], v[116:119], v[32:35]
v_mfma_f32_16x16x32_bf16 v[32:35], v[64:67], v[120:123], v[32:35]
ds_read_b128 v[152:155], v56 offset:3200
v_mfma_f32_16x16x32_bf16 v[36:39], v[64:67], v[124:127], v[36:39]
v_mfma_f32_16x16x32_bf16 v[36:39], v[68:71], v[120:123], v[36:39]
ds_read_b128 v[188:191], v57 offset:192
v_mfma_f32_16x16x32_bf16 v[36:39], v[72:75], v[116:119], v[36:39]
v_mfma_f32_16x16x32_bf16 v[36:39], v[76:79], v[112:115], v[36:39]
ds_read_b128 v[156:159], v56 offset:3712
v_mfma_f32_16x16x32_bf16 v[36:39], v[80:83], v[108:111], v[36:39]
v_mfma_f32_16x16x32_bf16 v[36:39], v[84:87], v[104:107], v[36:39]
v_mfma_f32_16x16x32_bf16 v[36:39], v[88:91], v[100:103], v[36:39]
v_mfma_f32_16x16x32_bf16 v[36:39], v[92:95], v[96:99], v[36:39]
s_waitcnt lgkmcnt(14)
v_mfma_f32_16x16x32_bf16 v[8:11], v[128:131], v[160:163], v[8:11]
v_xor_b32 v49, 160, v55
ds_read_b64_tr_b16 a[20:21], v49 offset:0
v_mfma_f32_16x16x32_bf16 v[12:15], v[128:131], v[164:167], v[12:15]
ds_read_b128 v[96:99], v57 offset:3840
v_mfma_f32_16x16x32_bf16 v[12:15], v[132:135], v[160:163], v[12:15]
ds_read_b64_tr_b16 a[22:23], v49 offset:1024
v_mfma_f32_16x16x32_bf16 v[16:19], v[136:139], v[160:163], v[16:19]
ds_read_b128 v[64:67], v56 offset:192
v_mfma_f32_16x16x32_bf16 v[16:19], v[132:135], v[164:167], v[16:19]
v_xor_b32 v48, 192, v55
ds_read_b64_tr_b16 a[24:25], v48 offset:0
v_mfma_f32_16x16x32_bf16 v[16:19], v[128:131], v[168:171], v[16:19]
ds_read_b128 v[100:103], v57 offset:3328
s_waitcnt lgkmcnt(14)
v_mfma_f32_16x16x32_bf16 v[20:23], v[128:131], v[172:175], v[20:23]
ds_read_b64_tr_b16 a[26:27], v48 offset:1024
v_mfma_f32_16x16x32_bf16 v[20:23], v[132:135], v[168:171], v[20:23]
ds_read_b128 v[68:71], v56 offset:704
v_mfma_f32_16x16x32_bf16 v[20:23], v[136:139], v[164:167], v[20:23]
v_xor_b32 v49, 224, v55
ds_read_b64_tr_b16 a[28:29], v49 offset:0
v_mfma_f32_16x16x32_bf16 v[20:23], v[140:143], v[160:163], v[20:23]
ds_read_b128 v[104:107], v57 offset:2816
s_waitcnt lgkmcnt(14)
v_mfma_f32_16x16x32_bf16 v[24:27], v[144:147], v[160:163], v[24:27]
ds_read_b64_tr_b16 a[30:31], v49 offset:1024
v_mfma_f32_16x16x32_bf16 v[24:27], v[140:143], v[164:167], v[24:27]
ds_read_b128 v[72:75], v56 offset:1216
v_mfma_f32_16x16x32_bf16 v[24:27], v[136:139], v[168:171], v[24:27]
buffer_store_dwordx4 a[0:3], v224, s[20:23], s84 offen sc1
v_mfma_f32_16x16x32_bf16 v[24:27], v[132:135], v[172:175], v[24:27]
ds_read_b128 v[108:111], v57 offset:2304
v_mfma_f32_16x16x32_bf16 v[24:27], v[128:131], v[176:179], v[24:27]
v_mfma_f32_16x16x32_bf16 v[28:31], v[128:131], v[180:183], v[28:31]
ds_read_b128 v[76:79], v56 offset:1728
v_mfma_f32_16x16x32_bf16 v[28:31], v[132:135], v[176:179], v[28:31]
buffer_store_dwordx4 a[4:7], v224, s[20:23], s85 offen sc1
v_mfma_f32_16x16x32_bf16 v[28:31], v[136:139], v[172:175], v[28:31]
ds_read_b128 v[112:115], v57 offset:1792
v_mfma_f32_16x16x32_bf16 v[28:31], v[140:143], v[168:171], v[28:31]
v_mfma_f32_16x16x32_bf16 v[28:31], v[144:147], v[164:167], v[28:31]
ds_read_b128 v[80:83], v56 offset:2240
v_mfma_f32_16x16x32_bf16 v[28:31], v[148:151], v[160:163], v[28:31]
buffer_store_dwordx4 a[8:11], v224, s[20:23], s89 offen sc1
s_waitcnt lgkmcnt(14)
v_mfma_f32_16x16x32_bf16 v[32:35], v[152:155], v[160:163], v[32:35]
ds_read_b128 v[116:119], v57 offset:1280
v_mfma_f32_16x16x32_bf16 v[32:35], v[148:151], v[164:167], v[32:35]
v_mfma_f32_16x16x32_bf16 v[32:35], v[144:147], v[168:171], v[32:35]
ds_read_b128 v[84:87], v56 offset:2752
v_mfma_f32_16x16x32_bf16 v[32:35], v[140:143], v[172:175], v[32:35]
buffer_store_dwordx4 a[12:15], v224, s[20:23], s90 offen sc1
v_mfma_f32_16x16x32_bf16 v[32:35], v[136:139], v[176:179], v[32:35]
ds_read_b128 v[120:123], v57 offset:768
v_mfma_f32_16x16x32_bf16 v[32:35], v[132:135], v[180:183], v[32:35]
v_mfma_f32_16x16x32_bf16 v[32:35], v[128:131], v[184:187], v[32:35]
ds_read_b128 v[88:91], v56 offset:3264
v_mfma_f32_16x16x32_bf16 v[36:39], v[128:131], v[188:191], v[36:39]
v_mfma_f32_16x16x32_bf16 v[36:39], v[132:135], v[184:187], v[36:39]
ds_read_b128 v[124:127], v57 offset:256
v_mfma_f32_16x16x32_bf16 v[36:39], v[136:139], v[180:183], v[36:39]
v_mfma_f32_16x16x32_bf16 v[36:39], v[140:143], v[176:179], v[36:39]
ds_read_b128 v[92:95], v56 offset:3776
v_mfma_f32_16x16x32_bf16 v[36:39], v[144:147], v[172:175], v[36:39]
v_mfma_f32_16x16x32_bf16 v[36:39], v[148:151], v[168:171], v[36:39]
v_mfma_f32_16x16x32_bf16 v[36:39], v[152:155], v[164:167], v[36:39]
v_mfma_f32_16x16x32_bf16 v[36:39], v[156:159], v[160:163], v[36:39]
s_waitcnt lgkmcnt(14)
v_mfma_f32_16x16x32_bf16 v[8:11], v[64:67], v[96:99], v[8:11]
s_mov_b32 s24, s96
s_mov_b32 s25, s97
s_mov_b32 s26, s98
v_mfma_f32_16x16x32_bf16 v[12:15], v[64:67], v[100:103], v[12:15]
ds_read_b128 v[160:163], v57 offset:3904
v_mfma_f32_16x16x32_bf16 v[12:15], v[68:71], v[96:99], v[12:15]
s_waitcnt lgkmcnt(11)
v_mfma_f32_16x16x32_bf16 v[16:19], v[72:75], v[96:99], v[16:19]
ds_read_b128 v[128:131], v56 offset:256
v_mfma_f32_16x16x32_bf16 v[16:19], v[68:71], v[100:103], v[16:19]
s_add_u32 m0, s11, 32768
s_add_u32 s12, s13, 0
buffer_load_dwordx4 v54, s[24:27], s12 offen nt lds
v_mfma_f32_16x16x32_bf16 v[16:19], v[64:67], v[104:107], v[16:19]
ds_read_b128 v[164:167], v57 offset:3392
s_waitcnt lgkmcnt(12)
v_mfma_f32_16x16x32_bf16 v[20:23], v[64:67], v[108:111], v[20:23]
v_mfma_f32_16x16x32_bf16 v[20:23], v[68:71], v[104:107], v[20:23]
ds_read_b128 v[132:135], v56 offset:768
v_mfma_f32_16x16x32_bf16 v[20:23], v[72:75], v[100:103], v[20:23]
s_add_u32 m0, s11, 33792
s_add_u32 s12, s13, 28672
buffer_load_dwordx4 v54, s[24:27], s12 offen nt lds
s_waitcnt lgkmcnt(12)
v_mfma_f32_16x16x32_bf16 v[20:23], v[76:79], v[96:99], v[20:23]
ds_read_b128 v[168:171], v57 offset:2880
s_waitcnt lgkmcnt(11)
v_mfma_f32_16x16x32_bf16 v[24:27], v[80:83], v[96:99], v[24:27]
v_mfma_f32_16x16x32_bf16 v[24:27], v[76:79], v[100:103], v[24:27]
ds_read_b128 v[136:139], v56 offset:1280
v_mfma_f32_16x16x32_bf16 v[24:27], v[72:75], v[104:107], v[24:27]
s_add_u32 m0, s11, 34816
s_add_u32 s12, s13, 57344
buffer_load_dwordx4 v58, s[24:27], s12 offen nt lds
v_mfma_f32_16x16x32_bf16 v[24:27], v[68:71], v[108:111], v[24:27]
ds_read_b128 v[172:175], v57 offset:2368
v_mfma_f32_16x16x32_bf16 v[24:27], v[64:67], v[112:115], v[24:27]
s_waitcnt lgkmcnt(12)
v_mfma_f32_16x16x32_bf16 v[28:31], v[64:67], v[116:119], v[28:31]
ds_read_b128 v[140:143], v56 offset:1792
v_mfma_f32_16x16x32_bf16 v[28:31], v[68:71], v[112:115], v[28:31]
s_add_u32 m0, s11, 35840
s_add_u32 s12, s13, 86016
buffer_load_dwordx4 v58, s[24:27], s12 offen nt lds
v_mfma_f32_16x16x32_bf16 v[28:31], v[72:75], v[108:111], v[28:31]
ds_read_b128 v[176:179], v57 offset:1856
v_mfma_f32_16x16x32_bf16 v[28:31], v[76:79], v[104:107], v[28:31]
v_mfma_f32_16x16x32_bf16 v[28:31], v[80:83], v[100:103], v[28:31]
ds_read_b128 v[144:147], v56 offset:2304
s_waitcnt lgkmcnt(14)
v_mfma_f32_16x16x32_bf16 v[28:31], v[84:87], v[96:99], v[28:31]
buffer_store_dwordx4 a[16:19], v224, s[20:23], s91 offen sc1
s_waitcnt lgkmcnt(12)
v_mfma_f32_16x16x32_bf16 v[32:35], v[88:91], v[96:99], v[32:35]
ds_read_b128 v[180:183], v57 offset:1344
v_mfma_f32_16x16x32_bf16 v[32:35], v[84:87], v[100:103], v[32:35]
v_mfma_f32_16x16x32_bf16 v[32:35], v[80:83], v[104:107], v[32:35]
ds_read_b128 v[148:151], v56 offset:2816
v_mfma_f32_16x16x32_bf16 v[32:35], v[76:79], v[108:111], v[32:35]
buffer_store_dwordx4 a[20:23], v224, s[20:23], s94 offen sc1
v_mfma_f32_16x16x32_bf16 v[32:35], v[72:75], v[112:115], v[32:35]
ds_read_b128 v[184:187], v57 offset:832
v_mfma_f32_16x16x32_bf16 v[32:35], v[68:71], v[116:119], v[32:35]
v_mfma_f32_16x16x32_bf16 v[32:35], v[64:67], v[120:123], v[32:35]
ds_read_b128 v[152:155], v56 offset:3328
s_waitcnt lgkmcnt(14)
v_mfma_f32_16x16x32_bf16 v[36:39], v[64:67], v[124:127], v[36:39]
buffer_store_dwordx4 a[24:27], v224, s[20:23], s95 offen sc1
v_mfma_f32_16x16x32_bf16 v[36:39], v[68:71], v[120:123], v[36:39]
ds_read_b128 v[188:191], v57 offset:320
v_mfma_f32_16x16x32_bf16 v[36:39], v[72:75], v[116:119], v[36:39]
v_mfma_f32_16x16x32_bf16 v[36:39], v[76:79], v[112:115], v[36:39]
ds_read_b128 v[156:159], v56 offset:3840
v_mfma_f32_16x16x32_bf16 v[36:39], v[80:83], v[108:111], v[36:39]
buffer_store_dwordx4 a[28:31], v224, s[20:23], s69 offen sc1
v_mfma_f32_16x16x32_bf16 v[36:39], v[84:87], v[104:107], v[36:39]
v_mfma_f32_16x16x32_bf16 v[36:39], v[88:91], v[100:103], v[36:39]
v_mfma_f32_16x16x32_bf16 v[36:39], v[92:95], v[96:99], v[36:39]
s_waitcnt lgkmcnt(14)
v_mfma_f32_16x16x32_bf16 v[8:11], v[128:131], v[160:163], v[8:11]
s_add_u32 m0, s11, 36864
s_add_u32 s12, s13, 114688
buffer_load_dwordx4 v54, s[24:27], s12 offen nt lds
s_waitcnt lgkmcnt(13)
v_mfma_f32_16x16x32_bf16 v[12:15], v[128:131], v[164:167], v[12:15]
ds_read_b128 v[96:99], v57 offset:3968
s_waitcnt lgkmcnt(13)
v_mfma_f32_16x16x32_bf16 v[12:15], v[132:135], v[160:163], v[12:15]
s_waitcnt lgkmcnt(11)
v_mfma_f32_16x16x32_bf16 v[16:19], v[136:139], v[160:163], v[16:19]
ds_read_b128 v[64:67], v56 offset:320
v_mfma_f32_16x16x32_bf16 v[16:19], v[132:135], v[164:167], v[16:19]
s_add_u32 m0, s11, 37888
s_add_u32 s12, s13, 143360
buffer_load_dwordx4 v54, s[24:27], s12 offen nt lds
v_mfma_f32_16x16x32_bf16 v[16:19], v[128:131], v[168:171], v[16:19]
ds_read_b128 v[100:103], v57 offset:3456
s_waitcnt lgkmcnt(12)
v_mfma_f32_16x16x32_bf16 v[20:23], v[128:131], v[172:175], v[20:23]
v_mfma_f32_16x16x32_bf16 v[20:23], v[132:135], v[168:171], v[20:23]
ds_read_b128 v[68:71], v56 offset:832
v_mfma_f32_16x16x32_bf16 v[20:23], v[136:139], v[164:167], v[20:23]
s_add_u32 m0, s11, 38912
s_add_u32 s12, s13, 172032
buffer_load_dwordx4 v58, s[24:27], s12 offen nt lds
s_waitcnt lgkmcnt(12)
v_mfma_f32_16x16x32_bf16 v[20:23], v[140:143], v[160:163], v[20:23]
ds_read_b128 v[104:107], v57 offset:2944
s_waitcnt lgkmcnt(11)
v_mfma_f32_16x16x32_bf16 v[24:27], v[144:147], v[160:163], v[24:27]
v_mfma_f32_16x16x32_bf16 v[24:27], v[140:143], v[164:167], v[24:27]
ds_read_b128 v[72:75], v56 offset:1344
v_mfma_f32_16x16x32_bf16 v[24:27], v[136:139], v[168:171], v[24:27]
s_add_u32 m0, s11, 39936
s_add_u32 s12, s13, 200704
buffer_load_dwordx4 v58, s[24:27], s12 offen nt lds
v_mfma_f32_16x16x32_bf16 v[24:27], v[132:135], v[172:175], v[24:27]
ds_read_b128 v[108:111], v57 offset:2432
v_mfma_f32_16x16x32_bf16 v[24:27], v[128:131], v[176:179], v[24:27]
s_waitcnt lgkmcnt(12)
v_mfma_f32_16x16x32_bf16 v[28:31], v[128:131], v[180:183], v[28:31]
ds_read_b128 v[76:79], v56 offset:1856
v_mfma_f32_16x16x32_bf16 v[28:31], v[132:135], v[176:179], v[28:31]
v_mfma_f32_16x16x32_bf16 v[28:31], v[136:139], v[172:175], v[28:31]
ds_read_b128 v[112:115], v57 offset:1920
v_mfma_f32_16x16x32_bf16 v[28:31], v[140:143], v[168:171], v[28:31]
v_mfma_f32_16x16x32_bf16 v[28:31], v[144:147], v[164:167], v[28:31]
ds_read_b128 v[80:83], v56 offset:2368
s_waitcnt lgkmcnt(14)
v_mfma_f32_16x16x32_bf16 v[28:31], v[148:151], v[160:163], v[28:31]
s_waitcnt lgkmcnt(12)
v_mfma_f32_16x16x32_bf16 v[32:35], v[152:155], v[160:163], v[32:35]
ds_read_b128 v[116:119], v57 offset:1408
v_mfma_f32_16x16x32_bf16 v[32:35], v[148:151], v[164:167], v[32:35]
v_mfma_f32_16x16x32_bf16 v[32:35], v[144:147], v[168:171], v[32:35]
ds_read_b128 v[84:87], v56 offset:2880
v_mfma_f32_16x16x32_bf16 v[32:35], v[140:143], v[172:175], v[32:35]
v_mfma_f32_16x16x32_bf16 v[32:35], v[136:139], v[176:179], v[32:35]
ds_read_b128 v[120:123], v57 offset:896
v_mfma_f32_16x16x32_bf16 v[32:35], v[132:135], v[180:183], v[32:35]
v_mfma_f32_16x16x32_bf16 v[32:35], v[128:131], v[184:187], v[32:35]
ds_read_b128 v[88:91], v56 offset:3392
s_waitcnt lgkmcnt(14)
v_mfma_f32_16x16x32_bf16 v[36:39], v[128:131], v[188:191], v[36:39]
v_mfma_f32_16x16x32_bf16 v[36:39], v[132:135], v[184:187], v[36:39]
ds_read_b128 v[124:127], v57 offset:384
v_mfma_f32_16x16x32_bf16 v[36:39], v[136:139], v[180:183], v[36:39]
v_mfma_f32_16x16x32_bf16 v[36:39], v[140:143], v[176:179], v[36:39]
ds_read_b128 v[92:95], v56 offset:3904
v_mfma_f32_16x16x32_bf16 v[36:39], v[144:147], v[172:175], v[36:39]
v_mfma_f32_16x16x32_bf16 v[36:39], v[148:151], v[168:171], v[36:39]
v_mfma_f32_16x16x32_bf16 v[36:39], v[152:155], v[164:167], v[36:39]
v_mfma_f32_16x16x32_bf16 v[36:39], v[156:159], v[160:163], v[36:39]
s_waitcnt lgkmcnt(14)
v_mfma_f32_16x16x32_bf16 v[8:11], v[64:67], v[96:99], v[8:11]
s_waitcnt lgkmcnt(13)
v_mfma_f32_16x16x32_bf16 v[12:15], v[64:67], v[100:103], v[12:15]
ds_read_b128 v[160:163], v57 offset:4032
s_waitcnt lgkmcnt(13)
v_mfma_f32_16x16x32_bf16 v[12:15], v[68:71], v[96:99], v[12:15]
s_waitcnt lgkmcnt(11)
v_mfma_f32_16x16x32_bf16 v[16:19], v[72:75], v[96:99], v[16:19]
ds_read_b128 v[128:131], v56 offset:384
v_mfma_f32_16x16x32_bf16 v[16:19], v[68:71], v[100:103], v[16:19]
v_mfma_f32_16x16x32_bf16 v[16:19], v[64:67], v[104:107], v[16:19]
ds_read_b128 v[164:167], v57 offset:3520
s_waitcnt lgkmcnt(12)
v_mfma_f32_16x16x32_bf16 v[20:23], v[64:67], v[108:111], v[20:23]
v_mfma_f32_16x16x32_bf16 v[20:23], v[68:71], v[104:107], v[20:23]
ds_read_b128 v[132:135], v56 offset:896
v_mfma_f32_16x16x32_bf16 v[20:23], v[72:75], v[100:103], v[20:23]
s_waitcnt lgkmcnt(12)
v_mfma_f32_16x16x32_bf16 v[20:23], v[76:79], v[96:99], v[20:23]
ds_read_b128 v[168:171], v57 offset:3008
s_waitcnt lgkmcnt(11)
v_mfma_f32_16x16x32_bf16 v[24:27], v[80:83], v[96:99], v[24:27]
v_mfma_f32_16x16x32_bf16 v[24:27], v[76:79], v[100:103], v[24:27]
ds_read_b128 v[136:139], v56 offset:1408
v_mfma_f32_16x16x32_bf16 v[24:27], v[72:75], v[104:107], v[24:27]
v_mfma_f32_16x16x32_bf16 v[24:27], v[68:71], v[108:111], v[24:27]
ds_read_b128 v[172:175], v57 offset:2496
v_mfma_f32_16x16x32_bf16 v[24:27], v[64:67], v[112:115], v[24:27]
s_waitcnt lgkmcnt(12)
v_mfma_f32_16x16x32_bf16 v[28:31], v[64:67], v[116:119], v[28:31]
ds_read_b128 v[140:143], v56 offset:1920
v_mfma_f32_16x16x32_bf16 v[28:31], v[68:71], v[112:115], v[28:31]
v_mfma_f32_16x16x32_bf16 v[28:31], v[72:75], v[108:111], v[28:31]
ds_read_b128 v[176:179], v57 offset:1984
v_mfma_f32_16x16x32_bf16 v[28:31], v[76:79], v[104:107], v[28:31]
v_mfma_f32_16x16x32_bf16 v[28:31], v[80:83], v[100:103], v[28:31]
ds_read_b128 v[144:147], v56 offset:2432
s_waitcnt lgkmcnt(14)
v_mfma_f32_16x16x32_bf16 v[28:31], v[84:87], v[96:99], v[28:31]
s_waitcnt lgkmcnt(12)
v_mfma_f32_16x16x32_bf16 v[32:35], v[88:91], v[96:99], v[32:35]
ds_read_b128 v[180:183], v57 offset:1472
v_mfma_f32_16x16x32_bf16 v[32:35], v[84:87], v[100:103], v[32:35]
v_mfma_f32_16x16x32_bf16 v[32:35], v[80:83], v[104:107], v[32:35]
ds_read_b128 v[148:151], v56 offset:2944
v_mfma_f32_16x16x32_bf16 v[32:35], v[76:79], v[108:111], v[32:35]
v_mfma_f32_16x16x32_bf16 v[32:35], v[72:75], v[112:115], v[32:35]
ds_read_b128 v[184:187], v57 offset:960
v_mfma_f32_16x16x32_bf16 v[32:35], v[68:71], v[116:119], v[32:35]
v_mfma_f32_16x16x32_bf16 v[32:35], v[64:67], v[120:123], v[32:35]
ds_read_b128 v[152:155], v56 offset:3456
s_waitcnt lgkmcnt(14)
v_mfma_f32_16x16x32_bf16 v[36:39], v[64:67], v[124:127], v[36:39]
v_mfma_f32_16x16x32_bf16 v[36:39], v[68:71], v[120:123], v[36:39]
ds_read_b128 v[188:191], v57 offset:448
v_mfma_f32_16x16x32_bf16 v[36:39], v[72:75], v[116:119], v[36:39]
v_mfma_f32_16x16x32_bf16 v[36:39], v[76:79], v[112:115], v[36:39]
ds_read_b128 v[156:159], v56 offset:3968
v_mfma_f32_16x16x32_bf16 v[36:39], v[80:83], v[108:111], v[36:39]
v_mfma_f32_16x16x32_bf16 v[36:39], v[84:87], v[104:107], v[36:39]
v_mfma_f32_16x16x32_bf16 v[36:39], v[88:91], v[100:103], v[36:39]
v_mfma_f32_16x16x32_bf16 v[36:39], v[92:95], v[96:99], v[36:39]
s_waitcnt lgkmcnt(14)
v_mfma_f32_16x16x32_bf16 v[8:11], v[128:131], v[160:163], v[8:11]
buffer_load_dwordx4 a[64:67], v53, s[32:35], s44 offen offset:0 nt
s_waitcnt lgkmcnt(13)
v_mfma_f32_16x16x32_bf16 v[12:15], v[128:131], v[164:167], v[12:15]
s_waitcnt lgkmcnt(12)
v_mfma_f32_16x16x32_bf16 v[12:15], v[132:135], v[160:163], v[12:15]
s_waitcnt lgkmcnt(10)
v_mfma_f32_16x16x32_bf16 v[16:19], v[136:139], v[160:163], v[16:19]
v_mfma_f32_16x16x32_bf16 v[16:19], v[132:135], v[164:167], v[16:19]
buffer_load_dwordx4 a[68:71], v53, s[32:35], s44 offen offset:64 nt
v_mfma_f32_16x16x32_bf16 v[16:19], v[128:131], v[168:171], v[16:19]
s_waitcnt lgkmcnt(9)
v_mfma_f32_16x16x32_bf16 v[20:23], v[128:131], v[172:175], v[20:23]
v_mfma_f32_16x16x32_bf16 v[20:23], v[132:135], v[168:171], v[20:23]
v_mfma_f32_16x16x32_bf16 v[20:23], v[136:139], v[164:167], v[20:23]
buffer_load_dwordx4 a[72:75], v53, s[32:35], s44 offen offset:128 nt
s_waitcnt lgkmcnt(8)
v_mfma_f32_16x16x32_bf16 v[20:23], v[140:143], v[160:163], v[20:23]
s_waitcnt lgkmcnt(6)
v_mfma_f32_16x16x32_bf16 v[24:27], v[144:147], v[160:163], v[24:27]
v_mfma_f32_16x16x32_bf16 v[24:27], v[140:143], v[164:167], v[24:27]
v_mfma_f32_16x16x32_bf16 v[24:27], v[136:139], v[168:171], v[24:27]
buffer_load_dwordx4 a[76:79], v53, s[32:35], s44 offen offset:192 nt
v_mfma_f32_16x16x32_bf16 v[24:27], v[132:135], v[172:175], v[24:27]
v_mfma_f32_16x16x32_bf16 v[24:27], v[128:131], v[176:179], v[24:27]
s_waitcnt lgkmcnt(5)
v_mfma_f32_16x16x32_bf16 v[28:31], v[128:131], v[180:183], v[28:31]
v_mfma_f32_16x16x32_bf16 v[28:31], v[132:135], v[176:179], v[28:31]
v_mfma_f32_16x16x32_bf16 v[28:31], v[136:139], v[172:175], v[28:31]
v_mfma_f32_16x16x32_bf16 v[28:31], v[140:143], v[168:171], v[28:31]
v_mfma_f32_16x16x32_bf16 v[28:31], v[144:147], v[164:167], v[28:31]
s_waitcnt lgkmcnt(4)
v_mfma_f32_16x16x32_bf16 v[28:31], v[148:151], v[160:163], v[28:31]
s_waitcnt lgkmcnt(2)
v_mfma_f32_16x16x32_bf16 v[32:35], v[152:155], v[160:163], v[32:35]
v_mfma_f32_16x16x32_bf16 v[32:35], v[148:151], v[164:167], v[32:35]
v_mfma_f32_16x16x32_bf16 v[32:35], v[144:147], v[168:171], v[32:35]
v_mfma_f32_16x16x32_bf16 v[32:35], v[140:143], v[172:175], v[32:35]
v_mfma_f32_16x16x32_bf16 v[32:35], v[136:139], v[176:179], v[32:35]
v_mfma_f32_16x16x32_bf16 v[32:35], v[132:135], v[180:183], v[32:35]
v_mfma_f32_16x16x32_bf16 v[32:35], v[128:131], v[184:187], v[32:35]
s_waitcnt lgkmcnt(1)
v_mfma_f32_16x16x32_bf16 v[36:39], v[128:131], v[188:191], v[36:39]
v_mfma_f32_16x16x32_bf16 v[36:39], v[132:135], v[184:187], v[36:39]
v_mfma_f32_16x16x32_bf16 v[36:39], v[136:139], v[180:183], v[36:39]
v_mfma_f32_16x16x32_bf16 v[36:39], v[140:143], v[176:179], v[36:39]
v_mfma_f32_16x16x32_bf16 v[36:39], v[144:147], v[172:175], v[36:39]
v_mfma_f32_16x16x32_bf16 v[36:39], v[148:151], v[168:171], v[36:39]
v_mfma_f32_16x16x32_bf16 v[36:39], v[152:155], v[164:167], v[36:39]
s_waitcnt lgkmcnt(0)
v_mfma_f32_16x16x32_bf16 v[36:39], v[156:159], v[160:163], v[36:39]
ds_write_b128 v59, v[8:11] offset:0
ds_write_b128 v59, v[12:15] offset:512
ds_write_b128 v59, v[16:19] offset:1024
ds_write_b128 v59, v[20:23] offset:1536
ds_write_b128 v59, v[24:27] offset:2048
ds_write_b128 v59, v[28:31] offset:2560
ds_write_b128 v59, v[32:35] offset:3072
s_nop 0
ds_write_b128 v59, v[36:39] offset:3584
v_lshrrev_b32 v4, 2, v0
v_bfe_u32 v5, v4, 3, 2
v_xor_b32 v5, v5, v4
v_lshlrev_b32 v5, 4, v5
v_and_b32 v6, 3, v0
v_lshl_add_u32 v5, v6, 2, v5
v_lshlrev_b32 v6, 4, v6
v_lshl_add_u32 v6, v4, 14, v6
s_lshl_b32 s12, s61, 6
s_add_u32 s12, s12, 0
v_add_u32 v41, 25920, v5
v_add_u32 v42, 51840, v5
v_add_u32 v43, 77760, v5
v_mov_b32 v40, v5
s_waitcnt vmcnt(20)
v_xor_b32 v236, v236, v253
v_xor_b32 v237, v237, v253
v_xor_b32 v238, v238, v253
v_xor_b32 v239, v239, v253
v_or3_b32 v234, v236, v237, v238
v_or_b32 v234, v234, v239
v_cmp_ne_u32 vcc, 0, v234
s_nop 0
s_or_b32 s14, vcc_lo, vcc_hi
s_cbranch_scc1 L_poll3
L_poll3_ok:
s_waitcnt vmcnt(8) lgkmcnt(0)
s_barrier
ds_read2st64_b32 v[64:65], v40 offset0:0 offset1:16
ds_read2st64_b32 v[66:67], v41 offset0:0 offset1:16
ds_read2st64_b32 v[68:69], v42 offset0:0 offset1:16
ds_read2st64_b32 v[70:71], v43 offset0:0 offset1:16
ds_read2st64_b32 v[72:73], v40 offset0:4 offset1:20
ds_read2st64_b32 v[74:75], v41 offset0:4 offset1:20
ds_read2st64_b32 v[76:77], v42 offset0:4 offset1:20
ds_read2st64_b32 v[78:79], v43 offset0:4 offset1:20
ds_read2st64_b32 v[80:81], v40 offset0:8 offset1:24
ds_read2st64_b32 v[82:83], v41 offset0:8 offset1:24
ds_read2st64_b32 v[84:85], v42 offset0:8 offset1:24
ds_read2st64_b32 v[86:87], v43 offset0:8 offset1:24
ds_read2st64_b32 v[88:89], v40 offset0:12 offset1:28
ds_read2st64_b32 v[90:91], v41 offset0:12 offset1:28
ds_read2st64_b32 v[92:93], v42 offset0:12 offset1:28
ds_read2st64_b32 v[94:95], v43 offset0:12 offset1:28
s_waitcnt lgkmcnt(12)
v_cvt_pk_bf16_f32 v96, v64, v66
v_cvt_pk_bf16_f32 v97, v68, v70
v_cvt_pk_bf16_f32 v98, v65, v67
v_cvt_pk_bf16_f32 v99, v69, v71
buffer_store_dwordx4 v[96:99], v6, s[20:23], s12 offen sc1
s_add_u32 s12, s12, 0x100000
s_waitcnt lgkmcnt(8)
v_cvt_pk_bf16_f32 v100, v72, v74
v_cvt_pk_bf16_f32 v101, v76, v78
v_cvt_pk_bf16_f32 v102, v73, v75
v_cvt_pk_bf16_f32 v103, v77, v79
buffer_store_dwordx4 v[100:103], v6, s[20:23], s12 offen sc1
s_add_u32 s12, s12, 0x100000
s_waitcnt lgkmcnt(4)
v_cvt_pk_bf16_f32 v104, v80, v82
v_cvt_pk_bf16_f32 v105, v84, v86
v_cvt_pk_bf16_f32 v106, v81, v83
v_cvt_pk_bf16_f32 v107, v85, v87
buffer_store_dwordx4 v[104:107], v6, s[20:23], s12 offen sc1
s_add_u32 s12, s12, 0x100000
s_waitcnt lgkmcnt(0)
v_cvt_pk_bf16_f32 v108, v88, v90
v_cvt_pk_bf16_f32 v109, v92, v94
v_cvt_pk_bf16_f32 v110, v89, v91
v_cvt_pk_bf16_f32 v111, v93, v95
buffer_store_dwordx4 v[108:111], v6, s[20:23], s12 offen sc1
v_and_b32 v6, 7, v230
v_bfe_u32 v5, v230, 3, 2
v_lshrrev_b32 v7, 5, v230
v_lshl_add_u32 v7, v7, 4, v5
v_lshlrev_b32 v0, 3, v6
v_lshl_add_u32 v0, v7, 7, v0
v_lshlrev_b32 v4, 11, v6
v_lshl_add_u32 v4, v7, 4, v4
v_lshrrev_b32 v1, 6, v230
v_lshlrev_b32 v1, 3, v1
v_lshl_add_u32 v1, v6, 5, v1
v_bfe_u32 v7, v230, 4, 1
v_lshl_add_u32 v1, v7, 2, v1
v_add_u32 v1, 130560, v1
v_lshlrev_b32 v2, 5, v6
v_add_u32 v2, 130560, v2
v_lshlrev_b32 v3, 4, v230
v_add_u32 v3, 131072, v3
s_mov_b32 s58, 524288
buffer_load_dwordx2 v[24:25], v0, s[20:23], s44 offen offset:0 sc1
buffer_load_dwordx2 v[26:27], v0, s[20:23], s44 offen offset:64 sc1
buffer_load_dwordx2 v[28:29], v0, s[20:23], s44 offen offset:512 sc1
buffer_load_dwordx2 v[30:31], v0, s[20:23], s44 offen offset:576 sc1
buffer_load_dwordx2 v[32:33], v0, s[20:23], s44 offen offset:1024 sc1
buffer_load_dwordx2 v[34:35], v0, s[20:23], s44 offen offset:1088 sc1
buffer_load_dwordx2 v[36:37], v0, s[20:23], s44 offen offset:1536 sc1
buffer_load_dwordx2 v[38:39], v0, s[20:23], s44 offen offset:1600 sc1
s_waitcnt vmcnt(12)
v_xor_b32 v48, 0, v55
ds_read_b64_tr_b16 a[224:225], v48 offset:32768
ds_read_b64_tr_b16 a[226:227], v48 offset:33792
v_xor_b32 v49, 32, v55
ds_read_b64_tr_b16 a[228:229], v49 offset:32768
ds_read_b64_tr_b16 a[230:231], v49 offset:33792
v_xor_b32 v48, 64, v55
ds_read_b64_tr_b16 a[232:233], v48 offset:32768
ds_read_b64_tr_b16 a[234:235], v48 offset:33792
v_xor_b32 v49, 96, v55
ds_read_b64_tr_b16 a[236:237], v49 offset:32768
ds_read_b64_tr_b16 a[238:239], v49 offset:33792
v_xor_b32 v48, 128, v55
ds_read_b64_tr_b16 a[240:241], v48 offset:32768
ds_read_b64_tr_b16 a[242:243], v48 offset:33792
v_xor_b32 v49, 160, v55
ds_read_b64_tr_b16 a[244:245], v49 offset:32768
ds_read_b64_tr_b16 a[246:247], v49 offset:33792
v_xor_b32 v48, 192, v55
ds_read_b64_tr_b16 a[248:249], v48 offset:32768
ds_read_b64_tr_b16 a[250:251], v48 offset:33792
v_xor_b32 v49, 224, v55
ds_read_b64_tr_b16 a[252:253], v49 offset:32768
ds_read_b64_tr_b16 a[254:255], v49 offset:33792
v_accvgpr_read_b32 v8, a64
v_accvgpr_read_b32 v9, a65
v_accvgpr_read_b32 v10, a66
v_accvgpr_read_b32 v11, a67
v_accvgpr_read_b32 v12, a68
v_accvgpr_read_b32 v13, a69
v_accvgpr_read_b32 v14, a70
v_accvgpr_read_b32 v15, a71
v_accvgpr_read_b32 v16, a72
v_accvgpr_read_b32 v17, a73
v_accvgpr_read_b32 v18, a74
v_accvgpr_read_b32 v19, a75
v_accvgpr_read_b32 v20, a76
v_accvgpr_read_b32 v21, a77
v_accvgpr_read_b32 v22, a78
v_accvgpr_read_b32 v23, a79
v_lshlrev_b32 v72, 16, v8
v_and_b32 v73, 0xffff0000, v8
v_lshlrev_b32 v74, 16, v9
v_and_b32 v75, 0xffff0000, v9
v_lshlrev_b32 v76, 16, v10
v_and_b32 v77, 0xffff0000, v10
v_lshlrev_b32 v78, 16, v11
v_and_b32 v79, 0xffff0000, v11
v_lshlrev_b32 v80, 16, v12
v_and_b32 v81, 0xffff0000, v12
v_lshlrev_b32 v82, 16, v13
v_and_b32 v83, 0xffff0000, v13
v_lshlrev_b32 v84, 16, v14
v_and_b32 v85, 0xffff0000, v14
v_lshlrev_b32 v86, 16, v15
v_and_b32 v87, 0xffff0000, v15
v_lshlrev_b32 v88, 16, v16
v_and_b32 v89, 0xffff0000, v16
v_lshlrev_b32 v90, 16, v17
v_and_b32 v91, 0xffff0000, v17
v_lshlrev_b32 v92, 16, v18
v_and_b32 v93, 0xffff0000, v18
v_lshlrev_b32 v94, 16, v19
v_and_b32 v95, 0xffff0000, v19
v_lshlrev_b32 v96, 16, v20
v_and_b32 v97, 0xffff0000, v20
v_lshlrev_b32 v98, 16, v21
v_and_b32 v99, 0xffff0000, v21
v_lshlrev_b32 v100, 16, v22
v_and_b32 v101, 0xffff0000, v22
v_lshlrev_b32 v102, 16, v23
v_and_b32 v103, 0xffff0000, v23
s_lshl_b32 s12, s2, 2
s_add_u32 s12, s12, s17
s_cmp_lt_u32 s12, 896
s_cselect_b32 s26, 7340032, 0
s_cselect_b32 s101, 268435456, 0
s_mov_b32 s24, s4
s_mov_b32 s25, s5
v_pk_mul_f32 v[60:61], v[72:73], v[72:73]
v_pk_mul_f32 v[62:63], v[74:75], v[74:75]
v_pk_add_f32 v[56:57], v[72:73], v[74:75]
v_pk_fma_f32 v[60:61], v[76:77], v[76:77], v[60:61]
v_pk_fma_f32 v[62:63], v[78:79], v[78:79], v[62:63]
v_pk_add_f32 v[58:59], v[76:77], v[78:79]
v_pk_fma_f32 v[60:61], v[80:81], v[80:81], v[60:61]
v_pk_add_f32 v[56:57], v[56:57], v[80:81]
v_pk_fma_f32 v[62:63], v[82:83], v[82:83], v[62:63]
v_pk_add_f32 v[58:59], v[58:59], v[82:83]
v_pk_fma_f32 v[60:61], v[84:85], v[84:85], v[60:61]
v_pk_add_f32 v[56:57], v[56:57], v[84:85]
v_pk_fma_f32 v[62:63], v[86:87], v[86:87], v[62:63]
v_pk_add_f32 v[58:59], v[58:59], v[86:87]
v_pk_fma_f32 v[60:61], v[88:89], v[88:89], v[60:61]
v_pk_add_f32 v[56:57], v[56:57], v[88:89]
v_pk_fma_f32 v[62:63], v[90:91], v[90:91], v[62:63]
v_pk_add_f32 v[58:59], v[58:59], v[90:91]
v_pk_fma_f32 v[60:61], v[92:93], v[92:93], v[60:61]
v_pk_add_f32 v[56:57], v[56:57], v[92:93]
v_pk_fma_f32 v[62:63], v[94:95], v[94:95], v[62:63]
v_pk_add_f32 v[58:59], v[58:59], v[94:95]
v_pk_fma_f32 v[60:61], v[96:97], v[96:97], v[60:61]
v_pk_add_f32 v[56:57], v[56:57], v[96:97]
v_pk_fma_f32 v[62:63], v[98:99], v[98:99], v[62:63]
v_pk_add_f32 v[58:59], v[58:59], v[98:99]
v_pk_fma_f32 v[60:61], v[100:101], v[100:101], v[60:61]
v_pk_add_f32 v[56:57], v[56:57], v[100:101]
v_pk_fma_f32 v[62:63], v[102:103], v[102:103], v[62:63]
v_pk_add_f32 v[58:59], v[58:59], v[102:103]
v_pk_add_f32 v[136:137], v[56:57], v[58:59]
v_pk_add_f32 v[138:139], v[60:61], v[62:63]
v_add_f32 v136, v136, v137
v_add_f32 v138, v138, v139
s_nop 1
v_permlane16_swap_b32 v136, v138
v_add_f32 v136, v136, v138
s_nop 1
v_add_f32_dpp v136, v136, v136 row_ror:8 row_mask:0xf bank_mask:0xf
v_mov_b32 v137, v136
s_nop 1
v_permlane32_swap_b32 v136, v137
v_add_f32 v136, v136, v137
ds_write_b32 v1, v136 offset:0
s_waitcnt lgkmcnt(0)
s_barrier
ds_read_b128 v[144:147], v2 offset:0
ds_read_b128 v[148:151], v2 offset:16
s_waitcnt lgkmcnt(0)
v_pk_add_f32 v[144:145], v[144:145], v[146:147]
v_pk_add_f32 v[148:149], v[148:149], v[150:151]
v_pk_add_f32 v[144:145], v[144:145], v[148:149]
v_mul_f32 v144, 0x3a800000, v144
v_mul_f32 v145, 0x3a800000, v145
v_fma_f32 v145, -v144, v144, v145
v_max_f32 v145, 0, v145
v_cvt_pk_bf16_f32 v146, v144, v145
v_lshlrev_b32 v144, 16, v146
v_and_b32 v145, 0xffff0000, v146
v_add_f32 v145, 0x3727c5ac, v145
v_cvt_pk_bf16_f32 v145, v145, v145
v_lshlrev_b32 v145, 16, v145
v_sqrt_f32 v145, v145
s_nop 0
v_cvt_pk_bf16_f32 v145, v145, v145
v_lshlrev_b32 v145, 16, v145
v_rcp_f32 v140, v145
s_nop 0
v_mov_b32 v141, v140
v_mul_f32_e64 v142, -v144, v140
v_mov_b32 v143, v142
s_waitcnt vmcnt(0)
s_branch L_ypoll_chk
L_ypoll:
buffer_load_dwordx2 v[24:25], v0, s[20:23], s44 offen offset:0 sc1
buffer_load_dwordx2 v[26:27], v0, s[20:23], s44 offen offset:64 sc1
buffer_load_dwordx2 v[28:29], v0, s[20:23], s44 offen offset:512 sc1
buffer_load_dwordx2 v[30:31], v0, s[20:23], s44 offen offset:576 sc1
buffer_load_dwordx2 v[32:33], v0, s[20:23], s44 offen offset:1024 sc1
buffer_load_dwordx2 v[34:35], v0, s[20:23], s44 offen offset:1088 sc1
buffer_load_dwordx2 v[36:37], v0, s[20:23], s44 offen offset:1536 sc1
buffer_load_dwordx2 v[38:39], v0, s[20:23], s44 offen offset:1600 sc1
s_waitcnt vmcnt(0)
L_ypoll_chk:
v_max_u32 v152, v24, v25
v_max3_u32 v152, v152, v26, v27
v_max3_u32 v152, v152, v28, v29
v_max3_u32 v152, v152, v30, v31
v_max3_u32 v152, v152, v32, v33
v_max3_u32 v152, v152, v34, v35
v_max3_u32 v152, v152, v36, v37
v_max3_u32 v152, v152, v38, v39
v_cmp_eq_u32 vcc, -1, v152
s_sub_u32 s58, s58, 1
s_cbranch_scc1 L_ypoll_out
s_cbranch_vccnz L_ypoll
L_ypoll_out:
s_barrier
v_lshlrev_b32 v104, 16, v24
v_and_b32 v105, 0xffff0000, v24
v_lshlrev_b32 v106, 16, v25
v_and_b32 v107, 0xffff0000, v25
v_lshlrev_b32 v108, 16, v26
v_and_b32 v109, 0xffff0000, v26
v_lshlrev_b32 v110, 16, v27
v_and_b32 v111, 0xffff0000, v27
v_lshlrev_b32 v112, 16, v28
v_and_b32 v113, 0xffff0000, v28
v_lshlrev_b32 v114, 16, v29
v_and_b32 v115, 0xffff0000, v29
v_lshlrev_b32 v116, 16, v30
v_and_b32 v117, 0xffff0000, v30
v_lshlrev_b32 v118, 16, v31
v_and_b32 v119, 0xffff0000, v31
v_lshlrev_b32 v120, 16, v32
v_and_b32 v121, 0xffff0000, v32
v_lshlrev_b32 v122, 16, v33
v_and_b32 v123, 0xffff0000, v33
v_lshlrev_b32 v124, 16, v34
v_and_b32 v125, 0xffff0000, v34
v_lshlrev_b32 v126, 16, v35
v_and_b32 v127, 0xffff0000, v35
v_lshlrev_b32 v128, 16, v36
v_and_b32 v129, 0xffff0000, v36
v_lshlrev_b32 v130, 16, v37
v_and_b32 v131, 0xffff0000, v37
v_lshlrev_b32 v132, 16, v38
v_and_b32 v133, 0xffff0000, v38
v_lshlrev_b32 v134, 16, v39
v_and_b32 v135, 0xffff0000, v39
ds_write_b128 v3, v[24:27] offset:0
ds_write_b128 v3, v[28:31] offset:4096
ds_write_b128 v3, v[32:35] offset:8192
ds_write_b128 v3, v[36:39] offset:12288
L_layer:
s_add_u32 s84, s40, s86
s_sub_u32 s85, s40, s86
s_add_u32 m0, s36, 0
v_pk_fma_f32 v[64:65], v[72:73], v[140:141], v[142:143]
v_pk_fma_f32 v[66:67], v[74:75], v[140:141], v[142:143]
v_pk_fma_f32 v[68:69], v[76:77], v[140:141], v[142:143]
v_pk_fma_f32 v[70:71], v[78:79], v[140:141], v[142:143]
v_pk_fma_f32 v[72:73], v[64:65], v[104:105], v[72:73]
s_add_u32 s57, s37, 0
v_pk_fma_f32 v[74:75], v[66:67], v[106:107], v[74:75]
v_pk_fma_f32 v[76:77], v[68:69], v[108:109], v[76:77]
v_pk_fma_f32 v[78:79], v[70:71], v[110:111], v[78:79]
v_cvt_pk_bf16_f32 v8, v72, v73
v_cvt_pk_bf16_f32 v9, v74, v75
buffer_load_dwordx4 v226, s[20:23], s57 offen offset:0 sc1 lds
v_cvt_pk_bf16_f32 v10, v76, v77
v_cvt_pk_bf16_f32 v11, v78, v79
v_pk_fma_f32 v[64:65], v[80:81], v[140:141], v[142:143]
v_pk_fma_f32 v[66:67], v[82:83], v[140:141], v[142:143]
v_pk_fma_f32 v[68:69], v[84:85], v[140:141], v[142:143]
buffer_load_dwordx4 v226, s[20:23], s57 offen offset:1024 sc1 lds
v_pk_fma_f32 v[70:71], v[86:87], v[140:141], v[142:143]
v_pk_fma_f32 v[80:81], v[64:65], v[112:113], v[80:81]
v_pk_fma_f32 v[82:83], v[66:67], v[114:115], v[82:83]
v_pk_fma_f32 v[84:85], v[68:69], v[116:117], v[84:85]
v_pk_fma_f32 v[86:87], v[70:71], v[118:119], v[86:87]
buffer_load_dwordx4 v226, s[20:23], s57 offen offset:2048 sc1 lds
v_cvt_pk_bf16_f32 v12, v80, v81
v_cvt_pk_bf16_f32 v13, v82, v83
v_cvt_pk_bf16_f32 v14, v84, v85
v_cvt_pk_bf16_f32 v15, v86, v87
v_pk_fma_f32 v[64:65], v[88:89], v[140:141], v[142:143]
buffer_load_dwordx4 v226, s[20:23], s57 offen offset:3072 sc1 lds
v_pk_fma_f32 v[66:67], v[90:91], v[140:141], v[142:143]
v_pk_fma_f32 v[68:69], v[92:93], v[140:141], v[142:143]
v_pk_fma_f32 v[70:71], v[94:95], v[140:141], v[142:143]
v_pk_fma_f32 v[88:89], v[64:65], v[120:121], v[88:89]
v_pk_fma_f32 v[90:91], v[66:67], v[122:123], v[90:91]
s_add_u32 m0, s36, 16384
v_pk_fma_f32 v[92:93], v[68:69], v[124:125], v[92:93]
v_pk_fma_f32 v[94:95], v[70:71], v[126:127], v[94:95]
v_cvt_pk_bf16_f32 v16, v88, v89
v_cvt_pk_bf16_f32 v17, v90, v91
v_cvt_pk_bf16_f32 v18, v92, v93
s_add_u32 s57, s37, 16384
v_cvt_pk_bf16_f32 v19, v94, v95
v_pk_fma_f32 v[64:65], v[96:97], v[140:141], v[142:143]
v_pk_fma_f32 v[66:67], v[98:99], v[140:141], v[142:143]
v_pk_fma_f32 v[68:69], v[100:101], v[140:141], v[142:143]
v_pk_fma_f32 v[70:71], v[102:103], v[140:141], v[142:143]
buffer_load_dwordx4 v226, s[20:23], s57 offen offset:0 sc1 lds
v_pk_fma_f32 v[96:97], v[64:65], v[128:129], v[96:97]
v_pk_fma_f32 v[98:99], v[66:67], v[130:131], v[98:99]
v_pk_fma_f32 v[100:101], v[68:69], v[132:133], v[100:101]
v_pk_fma_f32 v[102:103], v[70:71], v[134:135], v[102:103]
v_cvt_pk_bf16_f32 v20, v96, v97
buffer_load_dwordx4 v226, s[20:23], s57 offen offset:1024 sc1 lds
v_cvt_pk_bf16_f32 v21, v98, v99
v_cvt_pk_bf16_f32 v22, v100, v101
v_cvt_pk_bf16_f32 v23, v102, v103
v_lshlrev_b32 v72, 16, v8
v_and_b32 v73, 0xffff0000, v8
buffer_load_dwordx4 v226, s[20:23], s57 offen offset:2048 sc1 lds
v_lshlrev_b32 v74, 16, v9
v_and_b32 v75, 0xffff0000, v9
v_lshlrev_b32 v76, 16, v10
v_and_b32 v77, 0xffff0000, v10
v_lshlrev_b32 v78, 16, v11
buffer_load_dwordx4 v226, s[20:23], s57 offen offset:3072 sc1 lds
v_and_b32 v79, 0xffff0000, v11
v_lshlrev_b32 v80, 16, v12
v_and_b32 v81, 0xffff0000, v12
v_lshlrev_b32 v82, 16, v13
v_and_b32 v83, 0xffff0000, v13
s_add_u32 m0, s36, 32768
v_lshlrev_b32 v84, 16, v14
v_and_b32 v85, 0xffff0000, v14
v_lshlrev_b32 v86, 16, v15
v_and_b32 v87, 0xffff0000, v15
v_lshlrev_b32 v88, 16, v16
s_add_u32 s57, s37, 32768
v_and_b32 v89, 0xffff0000, v16
v_lshlrev_b32 v90, 16, v17
v_and_b32 v91, 0xffff0000, v17
v_lshlrev_b32 v92, 16, v18
v_and_b32 v93, 0xffff0000, v18
buffer_load_dwordx4 v226, s[20:23], s57 offen offset:0 sc1 lds
v_lshlrev_b32 v94, 16, v19
v_and_b32 v95, 0xffff0000, v19
v_lshlrev_b32 v96, 16, v20
v_and_b32 v97, 0xffff0000, v20
v_lshlrev_b32 v98, 16, v21
buffer_load_dwordx4 v226, s[20:23], s57 offen offset:1024 sc1 lds
v_and_b32 v99, 0xffff0000, v21
v_lshlrev_b32 v100, 16, v22
v_and_b32 v101, 0xffff0000, v22
v_lshlrev_b32 v102, 16, v23
v_and_b32 v103, 0xffff0000, v23
buffer_load_dwordx4 v226, s[20:23], s57 offen offset:2048 sc1 lds
v_pk_mul_f32 v[60:61], v[72:73], v[72:73]
v_pk_mul_f32 v[62:63], v[74:75], v[74:75]
v_pk_add_f32 v[56:57], v[72:73], v[74:75]
v_pk_fma_f32 v[60:61], v[76:77], v[76:77], v[60:61]
v_pk_fma_f32 v[62:63], v[78:79], v[78:79], v[62:63]
buffer_load_dwordx4 v226, s[20:23], s57 offen offset:3072 sc1 lds
v_pk_add_f32 v[58:59], v[76:77], v[78:79]
v_pk_fma_f32 v[60:61], v[80:81], v[80:81], v[60:61]
v_pk_add_f32 v[56:57], v[56:57], v[80:81]
v_pk_fma_f32 v[62:63], v[82:83], v[82:83], v[62:63]
v_pk_add_f32 v[58:59], v[58:59], v[82:83]
s_add_u32 m0, s36, 49152
v_pk_fma_f32 v[60:61], v[84:85], v[84:85], v[60:61]
v_pk_add_f32 v[56:57], v[56:57], v[84:85]
v_pk_fma_f32 v[62:63], v[86:87], v[86:87], v[62:63]
v_pk_add_f32 v[58:59], v[58:59], v[86:87]
v_pk_fma_f32 v[60:61], v[88:89], v[88:89], v[60:61]
s_add_u32 s57, s37, 49152
v_pk_add_f32 v[56:57], v[56:57], v[88:89]
v_pk_fma_f32 v[62:63], v[90:91], v[90:91], v[62:63]
v_pk_add_f32 v[58:59], v[58:59], v[90:91]
v_pk_fma_f32 v[60:61], v[92:93], v[92:93], v[60:61]
v_pk_add_f32 v[56:57], v[56:57], v[92:93]
buffer_load_dwordx4 v226, s[20:23], s57 offen offset:0 sc1 lds
v_pk_fma_f32 v[62:63], v[94:95], v[94:95], v[62:63]
v_pk_add_f32 v[58:59], v[58:59], v[94:95]
v_pk_fma_f32 v[60:61], v[96:97], v[96:97], v[60:61]
v_pk_add_f32 v[56:57], v[56:57], v[96:97]
v_pk_fma_f32 v[62:63], v[98:99], v[98:99], v[62:63]
buffer_load_dwordx4 v226, s[20:23], s57 offen offset:1024 sc1 lds
v_pk_add_f32 v[58:59], v[58:59], v[98:99]
v_pk_fma_f32 v[60:61], v[100:101], v[100:101], v[60:61]
v_pk_add_f32 v[56:57], v[56:57], v[100:101]
v_pk_fma_f32 v[62:63], v[102:103], v[102:103], v[62:63]
v_pk_add_f32 v[58:59], v[58:59], v[102:103]
buffer_load_dwordx4 v226, s[20:23], s57 offen offset:2048 sc1 lds
v_pk_add_f32 v[136:137], v[56:57], v[58:59]
v_pk_add_f32 v[138:139], v[60:61], v[62:63]
v_add_f32 v136, v136, v137
v_add_f32 v138, v138, v139
s_nop 1
v_permlane16_swap_b32 v136, v138
buffer_load_dwordx4 v226, s[20:23], s57 offen offset:3072 sc1 lds
v_add_f32 v136, v136, v138
s_nop 1
v_add_f32_dpp v136, v136, v136 row_ror:8 row_mask:0xf bank_mask:0xf
v_mov_b32 v137, v136
s_nop 1
v_permlane32_swap_b32 v136, v137
v_add_f32 v136, v136, v137
ds_write_b32 v1, v136 offset:256
s_waitcnt lgkmcnt(0)
s_barrier
ds_read_b128 v[144:147], v2 offset:256
ds_read_b128 v[148:151], v2 offset:272
s_waitcnt lgkmcnt(0)
v_pk_add_f32 v[144:145], v[144:145], v[146:147]
v_pk_add_f32 v[148:149], v[148:149], v[150:151]
v_pk_add_f32 v[144:145], v[144:145], v[148:149]
v_mul_f32 v144, 0x3a800000, v144
v_mul_f32 v145, 0x3a800000, v145
v_fma_f32 v145, -v144, v144, v145
v_max_f32 v145, 0, v145
v_cvt_pk_bf16_f32 v146, v144, v145
v_lshlrev_b32 v144, 16, v146
v_and_b32 v145, 0xffff0000, v146
v_add_f32 v145, 0x3727c5ac, v145
v_cvt_pk_bf16_f32 v145, v145, v145
v_lshlrev_b32 v145, 16, v145
v_sqrt_f32 v145, v145
s_nop 0
v_cvt_pk_bf16_f32 v145, v145, v145
v_lshlrev_b32 v145, 16, v145
v_rcp_f32 v140, v145
s_nop 0
v_mov_b32 v141, v140
v_mul_f32_e64 v142, -v144, v140
v_mov_b32 v143, v142
s_lshl_b32 s15, s3, 22
s_add_u32 s15, s15, s43
s_add_u32 s15, s15, 9437184
v_pk_fma_f32 v[72:73], v[72:73], v[140:141], v[142:143]
v_pk_fma_f32 v[74:75], v[74:75], v[140:141], v[142:143]
v_pk_fma_f32 v[76:77], v[76:77], v[140:141], v[142:143]
v_pk_fma_f32 v[78:79], v[78:79], v[140:141], v[142:143]
v_cvt_pk_bf16_f32 v40, v72, v73
v_cvt_pk_bf16_f32 v41, v74, v75
v_cvt_pk_bf16_f32 v42, v76, v77
v_cvt_pk_bf16_f32 v43, v78, v79
buffer_store_dwordx4 v[40:43], v233, s[20:23], s15 offen offset:0 sc1
v_pk_fma_f32 v[80:81], v[80:81], v[140:141], v[142:143]
v_pk_fma_f32 v[82:83], v[82:83], v[140:141], v[142:143]
v_pk_fma_f32 v[84:85], v[84:85], v[140:141], v[142:143]
v_pk_fma_f32 v[86:87], v[86:87], v[140:141], v[142:143]
v_cvt_pk_bf16_f32 v44, v80, v81
v_cvt_pk_bf16_f32 v45, v82, v83
v_cvt_pk_bf16_f32 v46, v84, v85
v_cvt_pk_bf16_f32 v47, v86, v87
buffer_store_dwordx4 v[44:47], v233, s[20:23], s15 offen offset:1024 sc1
v_pk_fma_f32 v[88:89], v[88:89], v[140:141], v[142:143]
v_pk_fma_f32 v[90:91], v[90:91], v[140:141], v[142:143]
v_pk_fma_f32 v[92:93], v[92:93], v[140:141], v[142:143]
v_pk_fma_f32 v[94:95], v[94:95], v[140:141], v[142:143]
v_cvt_pk_bf16_f32 v48, v88, v89
v_cvt_pk_bf16_f32 v49, v90, v91
v_cvt_pk_bf16_f32 v50, v92, v93
v_cvt_pk_bf16_f32 v51, v94, v95
buffer_store_dwordx4 v[48:51], v233, s[20:23], s15 offen offset:2048 sc1
v_pk_fma_f32 v[96:97], v[96:97], v[140:141], v[142:143]
v_pk_fma_f32 v[98:99], v[98:99], v[140:141], v[142:143]
v_pk_fma_f32 v[100:101], v[100:101], v[140:141], v[142:143]
v_pk_fma_f32 v[102:103], v[102:103], v[140:141], v[142:143]
v_cvt_pk_bf16_f32 v52, v96, v97
v_cvt_pk_bf16_f32 v53, v98, v99
v_cvt_pk_bf16_f32 v54, v100, v101
v_cvt_pk_bf16_f32 v55, v102, v103
buffer_store_dwordx4 v[52:55], v233, s[20:23], s15 offen offset:3072 sc1
ds_write_b128 v3, v[8:11] offset:16384
ds_write_b128 v3, v[12:15] offset:20480
ds_write_b128 v3, v[16:19] offset:24576
ds_write_b128 v3, v[20:23] offset:28672
s_add_u32 s10, s39, 0
s_add_u32 s11, s39, 32768
s_add_u32 s12, s39, 65536
s_add_u32 s13, s39, 98304
s_waitcnt vmcnt(0)
s_barrier
s_mov_b64 exec, 1
buffer_store_dword v253, off, s[20:23], s51 sc1
s_mov_b64 exec, -1
s_cmp_eq_u32 s62, 0
s_cbranch_scc1 L_now0
s_mov_b64 exec, 1
buffer_store_dword v253, off, s[20:23], s62 sc1
s_mov_b64 exec, -1
L_now0:
s_mov_b32 s62, 0
s_mov_b32 s58, 524288
buffer_load_dwordx4 v[160:163], v224, s[20:23], s10 offen offset:0 sc1
buffer_load_dwordx4 v[164:167], v224, s[20:23], s11 offen offset:0 sc1
buffer_load_dwordx4 v[168:171], v224, s[20:23], s12 offen offset:0 sc1
buffer_load_dwordx4 v[172:175], v224, s[20:23], s13 offen offset:0 sc1
buffer_load_dwordx4 v[176:179], v224, s[20:23], s10 offen offset:1024 sc1
buffer_load_dwordx4 v[180:183], v224, s[20:23], s11 offen offset:1024 sc1
buffer_load_dwordx4 v[184:187], v224, s[20:23], s12 offen offset:1024 sc1
buffer_load_dwordx4 v[188:191], v224, s[20:23], s13 offen offset:1024 sc1
s_branch L_epoll_chk
L_epoll:
buffer_load_dwordx4 v[160:163], v224, s[20:23], s10 offen offset:0 sc1
buffer_load_dwordx4 v[164:167], v224, s[20:23], s11 offen offset:0 sc1
buffer_load_dwordx4 v[168:171], v224, s[20:23], s12 offen offset:0 sc1
buffer_load_dwordx4 v[172:175], v224, s[20:23], s13 offen offset:0 sc1
buffer_load_dwordx4 v[176:179], v224, s[20:23], s10 offen offset:1024 sc1
buffer_load_dwordx4 v[180:183], v224, s[20:23], s11 offen offset:1024 sc1
buffer_load_dwordx4 v[184:187], v224, s[20:23], s12 offen offset:1024 sc1
buffer_load_dwordx4 v[188:191], v224, s[20:23], s13 offen offset:1024 sc1
L_epoll_chk:
s_waitcnt vmcnt(0)
v_max_u32 v152, v160, v161
v_max3_u32 v152, v152, v162, v163
v_max3_u32 v152, v152, v164, v165
v_max3_u32 v152, v152, v166, v167
v_max3_u32 v152, v152, v168, v169
v_max3_u32 v152, v152, v170, v171
v_max3_u32 v152, v152, v172, v173
v_max3_u32 v152, v152, v174, v175
v_max3_u32 v152, v152, v176, v177
v_max3_u32 v152, v152, v178, v179
v_max3_u32 v152, v152, v180, v181
v_max3_u32 v152, v152, v182, v183
v_max3_u32 v152, v152, v184, v185
v_max3_u32 v152, v152, v186, v187
v_max3_u32 v152, v152, v188, v189
v_max3_u32 v152, v152, v190, v191
v_cmp_eq_u32 vcc, -1, v152
s_sub_u32 s58, s58, 1
s_cbranch_scc1 L_epoll_out
s_cbranch_vccnz L_epoll
L_epoll_out:
s_cmp_lg_u32 s3, 0
s_cbranch_scc1 L_have
s_add_u32 m0, s36, 65536
s_add_u32 s57, s37, 65536
buffer_load_dwordx4 v226, s[20:23], s57 offen offset:0 sc1 lds
buffer_load_dwordx4 v226, s[20:23], s57 offen offset:1024 sc1 lds
buffer_load_dwordx4 v226, s[20:23], s57 offen offset:2048 sc1 lds
buffer_load_dwordx4 v226, s[20:23], s57 offen offset:3072 sc1 lds
s_add_u32 m0, s36, 81920
s_add_u32 s57, s37, 81920
buffer_load_dwordx4 v226, s[20:23], s57 offen offset:0 sc1 lds
buffer_load_dwordx4 v226, s[20:23], s57 offen offset:1024 sc1 lds
buffer_load_dwordx4 v226, s[20:23], s57 offen offset:2048 sc1 lds
buffer_load_dwordx4 v226, s[20:23], s57 offen offset:3072 sc1 lds
s_add_u32 m0, s36, 98304
s_add_u32 s57, s37, 98304
buffer_load_dwordx4 v226, s[20:23], s57 offen offset:0 sc1 lds
buffer_load_dwordx4 v226, s[20:23], s57 offen offset:1024 sc1 lds
buffer_load_dwordx4 v226, s[20:23], s57 offen offset:2048 sc1 lds
buffer_load_dwordx4 v226, s[20:23], s57 offen offset:3072 sc1 lds
L_have:
v_accvgpr_write_b32 a32, v160
v_accvgpr_write_b32 a33, v161
v_accvgpr_write_b32 a34, v162
v_accvgpr_write_b32 a35, v163
v_accvgpr_write_b32 a36, v164
v_accvgpr_write_b32 a37, v165
v_accvgpr_write_b32 a38, v166
v_accvgpr_write_b32 a39, v167
v_accvgpr_write_b32 a40, v168
v_accvgpr_write_b32 a41, v169
v_accvgpr_write_b32 a42, v170
v_accvgpr_write_b32 a43, v171
v_accvgpr_write_b32 a44, v172
v_accvgpr_write_b32 a45, v173
v_accvgpr_write_b32 a46, v174
v_accvgpr_write_b32 a47, v175
v_accvgpr_write_b32 a48, v176
v_accvgpr_write_b32 a49, v177
v_accvgpr_write_b32 a50, v178
v_accvgpr_write_b32 a51, v179
v_accvgpr_write_b32 a52, v180
v_accvgpr_write_b32 a53, v181
v_accvgpr_write_b32 a54, v182
v_accvgpr_write_b32 a55, v183
v_accvgpr_write_b32 a56, v184
v_accvgpr_write_b32 a57, v185
v_accvgpr_write_b32 a58, v186
v_accvgpr_write_b32 a59, v187
v_accvgpr_write_b32 a60, v188
v_accvgpr_write_b32 a61, v189
v_accvgpr_write_b32 a62, v190
v_accvgpr_write_b32 a63, v191
ds_read_b128 a[0:3], v224 offset:0
ds_read_b128 a[4:7], v224 offset:1024
ds_read_b128 a[8:11], v224 offset:2048
ds_read_b128 a[12:15], v224 offset:3072
ds_read_b128 a[16:19], v224 offset:4096
ds_read_b128 a[20:23], v224 offset:5120
buffer_load_dword v234, v235, s[20:23], s52 offen sc1
s_waitcnt lgkmcnt(4)
v_mfma_f32_16x16x32_bf16 v[0:3], a[0:3], a[32:35], 0
ds_read_b128 a[24:27], v224 offset:6144
v_mfma_f32_16x16x32_bf16 v[0:3], a[4:7], a[48:51], v[0:3]
v_mfma_f32_16x16x32_bf16 v[4:7], a[4:7], a[52:55], 0
v_mfma_f32_16x16x32_bf16 v[4:7], a[0:3], a[36:39], v[4:7]
v_mfma_f32_16x16x32_bf16 v[8:11], a[0:3], a[40:43], 0
ds_read_b128 a[28:31], v224 offset:7168
v_mfma_f32_16x16x32_bf16 v[8:11], a[4:7], a[56:59], v[8:11]
s_add_u32 m0, s36, 114688
v_mfma_f32_16x16x32_bf16 v[12:15], a[4:7], a[60:63], 0
s_add_u32 s57, s37, 114688
v_mfma_f32_16x16x32_bf16 v[12:15], a[0:3], a[44:47], v[12:15]
s_waitcnt lgkmcnt(4)
v_mfma_f32_16x16x32_bf16 v[28:31], a[8:11], a[44:47], 0
buffer_load_dwordx4 v226, s[20:23], s57 offen offset:0 sc1 lds
v_mfma_f32_16x16x32_bf16 v[28:31], a[12:15], a[60:63], v[28:31]
ds_read_b128 a[0:3], v224 offset:8192
v_mfma_f32_16x16x32_bf16 v[24:27], a[12:15], a[56:59], 0
buffer_load_dwordx4 v226, s[20:23], s57 offen offset:1024 sc1 lds
v_mfma_f32_16x16x32_bf16 v[24:27], a[8:11], a[40:43], v[24:27]
v_mfma_f32_16x16x32_bf16 v[20:23], a[8:11], a[36:39], 0
ds_read_b128 a[4:7], v224 offset:9216
v_mfma_f32_16x16x32_bf16 v[20:23], a[12:15], a[52:55], v[20:23]
v_mfma_f32_16x16x32_bf16 v[16:19], a[12:15], a[48:51], 0
v_mfma_f32_16x16x32_bf16 v[16:19], a[8:11], a[32:35], v[16:19]
s_waitcnt lgkmcnt(4)
v_mfma_f32_16x16x32_bf16 v[32:35], a[16:19], a[32:35], 0
ds_read_b128 a[8:11], v224 offset:10240
v_mfma_f32_16x16x32_bf16 v[32:35], a[20:23], a[48:51], v[32:35]
buffer_load_dwordx4 v226, s[20:23], s57 offen offset:2048 sc1 lds
v_mfma_f32_16x16x32_bf16 v[36:39], a[20:23], a[52:55], 0
v_mfma_f32_16x16x32_bf16 v[36:39], a[16:19], a[36:39], v[36:39]
v_mfma_f32_16x16x32_bf16 v[40:43], a[16:19], a[40:43], 0
ds_read_b128 a[12:15], v224 offset:11264
v_mfma_f32_16x16x32_bf16 v[40:43], a[20:23], a[56:59], v[40:43]
buffer_load_dwordx4 v226, s[20:23], s57 offen offset:3072 sc1 lds
v_mfma_f32_16x16x32_bf16 v[44:47], a[20:23], a[60:63], 0
v_mfma_f32_16x16x32_bf16 v[44:47], a[16:19], a[44:47], v[44:47]
s_waitcnt lgkmcnt(4)
v_mfma_f32_16x16x32_bf16 v[60:63], a[24:27], a[44:47], 0
ds_read_b128 a[16:19], v224 offset:12288
v_mfma_f32_16x16x32_bf16 v[60:63], a[28:31], a[60:63], v[60:63]
v_mfma_f32_16x16x32_bf16 v[56:59], a[28:31], a[56:59], 0
v_mfma_f32_16x16x32_bf16 v[56:59], a[24:27], a[40:43], v[56:59]
v_mfma_f32_16x16x32_bf16 v[52:55], a[24:27], a[36:39], 0
ds_read_b128 a[20:23], v224 offset:13312
v_mfma_f32_16x16x32_bf16 v[52:55], a[28:31], a[52:55], v[52:55]
v_mfma_f32_16x16x32_bf16 v[48:51], a[28:31], a[48:51], 0
v_mfma_f32_16x16x32_bf16 v[48:51], a[24:27], a[32:35], v[48:51]
s_waitcnt lgkmcnt(4)
v_mfma_f32_16x16x32_bf16 v[64:67], a[0:3], a[32:35], 0
ds_read_b128 a[24:27], v224 offset:14336
v_mfma_f32_16x16x32_bf16 v[64:67], a[4:7], a[48:51], v[64:67]
v_mfma_f32_16x16x32_bf16 v[68:71], a[4:7], a[52:55], 0
v_mfma_f32_16x16x32_bf16 v[68:71], a[0:3], a[36:39], v[68:71]
v_mfma_f32_16x16x32_bf16 v[72:75], a[0:3], a[40:43], 0
ds_read_b128 a[28:31], v224 offset:15360
v_mfma_f32_16x16x32_bf16 v[72:75], a[4:7], a[56:59], v[72:75]
v_mfma_f32_16x16x32_bf16 v[76:79], a[4:7], a[60:63], 0
v_mfma_f32_16x16x32_bf16 v[76:79], a[0:3], a[44:47], v[76:79]
s_waitcnt vmcnt(4)
v_cmp_ne_u32 vcc, v253, v234
s_nop 0
s_and_b32 s14, vcc_lo, 0xff
s_cbranch_scc1 L_poll4
L_poll4_ok:
s_waitcnt lgkmcnt(4)
v_mfma_f32_16x16x32_bf16 v[92:95], a[8:11], a[44:47], 0
ds_read_b128 a[0:3], v224 offset:16384
v_mfma_f32_16x16x32_bf16 v[92:95], a[12:15], a[60:63], v[92:95]
v_mfma_f32_16x16x32_bf16 v[88:91], a[12:15], a[56:59], 0
v_mfma_f32_16x16x32_bf16 v[88:91], a[8:11], a[40:43], v[88:91]
v_mfma_f32_16x16x32_bf16 v[84:87], a[8:11], a[36:39], 0
ds_read_b128 a[4:7], v224 offset:17408
v_mfma_f32_16x16x32_bf16 v[84:87], a[12:15], a[52:55], v[84:87]
buffer_load_dwordx4 a[64:67], v224, s[20:23], s10 offen offset:2048 sc1
v_mfma_f32_16x16x32_bf16 v[80:83], a[12:15], a[48:51], 0
v_mfma_f32_16x16x32_bf16 v[80:83], a[8:11], a[32:35], v[80:83]
s_waitcnt lgkmcnt(4)
v_mfma_f32_16x16x32_bf16 v[96:99], a[16:19], a[32:35], 0
ds_read_b128 a[8:11], v224 offset:18432
v_mfma_f32_16x16x32_bf16 v[96:99], a[20:23], a[48:51], v[96:99]
v_mfma_f32_16x16x32_bf16 v[100:103], a[20:23], a[52:55], 0
v_mfma_f32_16x16x32_bf16 v[100:103], a[16:19], a[36:39], v[100:103]
v_mfma_f32_16x16x32_bf16 v[104:107], a[16:19], a[40:43], 0
ds_read_b128 a[12:15], v224 offset:19456
v_mfma_f32_16x16x32_bf16 v[104:107], a[20:23], a[56:59], v[104:107]
buffer_load_dwordx4 a[68:71], v224, s[20:23], s11 offen offset:2048 sc1
v_mfma_f32_16x16x32_bf16 v[108:111], a[20:23], a[60:63], 0
v_mfma_f32_16x16x32_bf16 v[108:111], a[16:19], a[44:47], v[108:111]
s_waitcnt lgkmcnt(4)
v_mfma_f32_16x16x32_bf16 v[124:127], a[24:27], a[44:47], 0
ds_read_b128 a[16:19], v224 offset:20480
v_mfma_f32_16x16x32_bf16 v[124:127], a[28:31], a[60:63], v[124:127]
buffer_load_dwordx4 a[72:75], v224, s[20:23], s12 offen offset:2048 sc1
v_mfma_f32_16x16x32_bf16 v[120:123], a[28:31], a[56:59], 0
v_mfma_f32_16x16x32_bf16 v[120:123], a[24:27], a[40:43], v[120:123]
v_mfma_f32_16x16x32_bf16 v[116:119], a[24:27], a[36:39], 0
ds_read_b128 a[20:23], v224 offset:21504
v_mfma_f32_16x16x32_bf16 v[116:119], a[28:31], a[52:55], v[116:119]
buffer_load_dwordx4 a[76:79], v224, s[20:23], s13 offen offset:2048 sc1
v_mfma_f32_16x16x32_bf16 v[112:115], a[28:31], a[48:51], 0
v_mfma_f32_16x16x32_bf16 v[112:115], a[24:27], a[32:35], v[112:115]
s_waitcnt lgkmcnt(4)
v_mfma_f32_16x16x32_bf16 v[128:131], a[0:3], a[32:35], 0
ds_read_b128 a[24:27], v224 offset:22528
v_mfma_f32_16x16x32_bf16 v[128:131], a[4:7], a[48:51], v[128:131]
buffer_load_dwordx4 a[80:83], v224, s[20:23], s10 offen offset:3072 sc1
v_mfma_f32_16x16x32_bf16 v[132:135], a[4:7], a[52:55], 0
v_mfma_f32_16x16x32_bf16 v[132:135], a[0:3], a[36:39], v[132:135]
v_mfma_f32_16x16x32_bf16 v[136:139], a[0:3], a[40:43], 0
ds_read_b128 a[28:31], v224 offset:23552
v_mfma_f32_16x16x32_bf16 v[136:139], a[4:7], a[56:59], v[136:139]
v_mfma_f32_16x16x32_bf16 v[140:143], a[4:7], a[60:63], 0
v_mfma_f32_16x16x32_bf16 v[140:143], a[0:3], a[44:47], v[140:143]
s_waitcnt lgkmcnt(4)
v_mfma_f32_16x16x32_bf16 v[156:159], a[8:11], a[44:47], 0
ds_read_b128 a[0:3], v224 offset:24576
v_mfma_f32_16x16x32_bf16 v[156:159], a[12:15], a[60:63], v[156:159]
buffer_load_dwordx4 a[84:87], v224, s[20:23], s11 offen offset:3072 sc1
v_mfma_f32_16x16x32_bf16 v[152:155], a[12:15], a[56:59], 0
v_mfma_f32_16x16x32_bf16 v[152:155], a[8:11], a[40:43], v[152:155]
v_mfma_f32_16x16x32_bf16 v[148:151], a[8:11], a[36:39], 0
ds_read_b128 a[4:7], v224 offset:25600
v_mfma_f32_16x16x32_bf16 v[148:151], a[12:15], a[52:55], v[148:151]
buffer_load_dwordx4 a[88:91], v224, s[20:23], s12 offen offset:3072 sc1
v_mfma_f32_16x16x32_bf16 v[144:147], a[12:15], a[48:51], 0
v_mfma_f32_16x16x32_bf16 v[144:147], a[8:11], a[32:35], v[144:147]
s_waitcnt lgkmcnt(4)
v_mfma_f32_16x16x32_bf16 v[160:163], a[16:19], a[32:35], 0
ds_read_b128 a[8:11], v224 offset:26624
v_mfma_f32_16x16x32_bf16 v[160:163], a[20:23], a[48:51], v[160:163]
buffer_load_dwordx4 a[92:95], v224, s[20:23], s13 offen offset:3072 sc1
v_mfma_f32_16x16x32_bf16 v[164:167], a[20:23], a[52:55], 0
v_mfma_f32_16x16x32_bf16 v[164:167], a[16:19], a[36:39], v[164:167]
v_mfma_f32_16x16x32_bf16 v[168:171], a[16:19], a[40:43], 0
ds_read_b128 a[12:15], v224 offset:27648
v_mfma_f32_16x16x32_bf16 v[168:171], a[20:23], a[56:59], v[168:171]
s_add_u32 s10, s39, 4096
v_mfma_f32_16x16x32_bf16 v[172:175], a[20:23], a[60:63], 0
buffer_load_dwordx4 a[96:99], v224, s[20:23], s10 offen offset:0 sc1
v_mfma_f32_16x16x32_bf16 v[172:175], a[16:19], a[44:47], v[172:175]
s_waitcnt lgkmcnt(4)
v_mfma_f32_16x16x32_bf16 v[188:191], a[24:27], a[44:47], 0
ds_read_b128 a[16:19], v224 offset:28672
v_mfma_f32_16x16x32_bf16 v[188:191], a[28:31], a[60:63], v[188:191]
v_mfma_f32_16x16x32_bf16 v[184:187], a[28:31], a[56:59], 0
v_mfma_f32_16x16x32_bf16 v[184:187], a[24:27], a[40:43], v[184:187]
v_mfma_f32_16x16x32_bf16 v[180:183], a[24:27], a[36:39], 0
ds_read_b128 a[20:23], v224 offset:29696
v_mfma_f32_16x16x32_bf16 v[180:183], a[28:31], a[52:55], v[180:183]
s_add_u32 s11, s39, 36864
v_mfma_f32_16x16x32_bf16 v[176:179], a[28:31], a[48:51], 0
buffer_load_dwordx4 a[100:103], v224, s[20:23], s11 offen offset:0 sc1
v_mfma_f32_16x16x32_bf16 v[176:179], a[24:27], a[32:35], v[176:179]
s_waitcnt lgkmcnt(4)
v_mfma_f32_16x16x32_bf16 v[192:195], a[0:3], a[32:35], 0
ds_read_b128 a[24:27], v224 offset:30720
v_mfma_f32_16x16x32_bf16 v[192:195], a[4:7], a[48:51], v[192:195]
s_add_u32 s12, s39, 69632
v_mfma_f32_16x16x32_bf16 v[196:199], a[4:7], a[52:55], 0
buffer_load_dwordx4 a[104:107], v224, s[20:23], s12 offen offset:0 sc1
v_mfma_f32_16x16x32_bf16 v[196:199], a[0:3], a[36:39], v[196:199]
v_mfma_f32_16x16x32_bf16 v[200:203], a[0:3], a[40:43], 0
ds_read_b128 a[28:31], v224 offset:31744
v_mfma_f32_16x16x32_bf16 v[200:203], a[4:7], a[56:59], v[200:203]
s_add_u32 s13, s39, 102400
v_mfma_f32_16x16x32_bf16 v[204:207], a[4:7], a[60:63], 0
buffer_load_dwordx4 a[108:111], v224, s[20:23], s13 offen offset:0 sc1
v_mfma_f32_16x16x32_bf16 v[204:207], a[0:3], a[44:47], v[204:207]
s_waitcnt lgkmcnt(4)
v_mfma_f32_16x16x32_bf16 v[220:223], a[8:11], a[44:47], 0
ds_read_b128 a[0:3], v224 offset:32768
v_mfma_f32_16x16x32_bf16 v[220:223], a[12:15], a[60:63], v[220:223]
buffer_load_dwordx4 a[112:115], v224, s[20:23], s10 offen offset:1024 sc1
v_mfma_f32_16x16x32_bf16 v[216:219], a[12:15], a[56:59], 0
v_mfma_f32_16x16x32_bf16 v[216:219], a[8:11], a[40:43], v[216:219]
v_mfma_f32_16x16x32_bf16 v[212:215], a[8:11], a[36:39], 0
ds_read_b128 a[4:7], v224 offset:33792
v_mfma_f32_16x16x32_bf16 v[212:215], a[12:15], a[52:55], v[212:215]
v_mfma_f32_16x16x32_bf16 v[208:211], a[12:15], a[48:51], 0
v_mfma_f32_16x16x32_bf16 v[208:211], a[8:11], a[32:35], v[208:211]
s_waitcnt vmcnt(12) lgkmcnt(4)
v_mfma_f32_16x16x32_bf16 v[0:3], a[16:19], a[64:67], v[0:3]
ds_read_b128 a[8:11], v224 offset:34816
s_waitcnt vmcnt(5)
v_mfma_f32_16x16x32_bf16 v[0:3], a[20:23], a[80:83], v[0:3]
buffer_load_dwordx4 a[116:119], v224, s[20:23], s11 offen offset:1024 sc1
v_mfma_f32_16x16x32_bf16 v[4:7], a[20:23], a[84:87], v[4:7]
v_mfma_f32_16x16x32_bf16 v[4:7], a[16:19], a[68:71], v[4:7]
v_mfma_f32_16x16x32_bf16 v[8:11], a[16:19], a[72:75], v[8:11]
ds_read_b128 a[12:15], v224 offset:35840
v_mfma_f32_16x16x32_bf16 v[8:11], a[20:23], a[88:91], v[8:11]
buffer_load_dwordx4 a[120:123], v224, s[20:23], s12 offen offset:1024 sc1
v_mfma_f32_16x16x32_bf16 v[12:15], a[20:23], a[92:95], v[12:15]
v_mfma_f32_16x16x32_bf16 v[12:15], a[16:19], a[76:79], v[12:15]
s_waitcnt lgkmcnt(4)
v_mfma_f32_16x16x32_bf16 v[28:31], a[24:27], a[76:79], v[28:31]
ds_read_b128 a[16:19], v224 offset:36864
v_mfma_f32_16x16x32_bf16 v[28:31], a[28:31], a[92:95], v[28:31]
buffer_load_dwordx4 a[124:127], v224, s[20:23], s13 offen offset:1024 sc1
v_mfma_f32_16x16x32_bf16 v[24:27], a[28:31], a[88:91], v[24:27]
v_mfma_f32_16x16x32_bf16 v[24:27], a[24:27], a[72:75], v[24:27]
v_mfma_f32_16x16x32_bf16 v[20:23], a[24:27], a[68:71], v[20:23]
ds_read_b128 a[20:23], v224 offset:37888
v_mfma_f32_16x16x32_bf16 v[20:23], a[28:31], a[84:87], v[20:23]
buffer_load_dwordx4 a[128:131], v224, s[20:23], s10 offen offset:2048 sc1
v_mfma_f32_16x16x32_bf16 v[16:19], a[28:31], a[80:83], v[16:19]
v_mfma_f32_16x16x32_bf16 v[16:19], a[24:27], a[64:67], v[16:19]
s_waitcnt lgkmcnt(4)
v_mfma_f32_16x16x32_bf16 v[32:35], a[0:3], a[64:67], v[32:35]
ds_read_b128 a[24:27], v224 offset:38912
v_mfma_f32_16x16x32_bf16 v[32:35], a[4:7], a[80:83], v[32:35]
v_mfma_f32_16x16x32_bf16 v[36:39], a[4:7], a[84:87], v[36:39]
v_mfma_f32_16x16x32_bf16 v[36:39], a[0:3], a[68:71], v[36:39]
v_mfma_f32_16x16x32_bf16 v[40:43], a[0:3], a[72:75], v[40:43]
ds_read_b128 a[28:31], v224 offset:39936
v_mfma_f32_16x16x32_bf16 v[40:43], a[4:7], a[88:91], v[40:43]
buffer_load_dwordx4 a[132:135], v224, s[20:23], s11 offen offset:2048 sc1
v_mfma_f32_16x16x32_bf16 v[44:47], a[4:7], a[92:95], v[44:47]
v_mfma_f32_16x16x32_bf16 v[44:47], a[0:3], a[76:79], v[44:47]
s_waitcnt lgkmcnt(4)
v_mfma_f32_16x16x32_bf16 v[60:63], a[8:11], a[76:79], v[60:63]
ds_read_b128 a[0:3], v224 offset:40960
v_mfma_f32_16x16x32_bf16 v[60:63], a[12:15], a[92:95], v[60:63]
buffer_load_dwordx4 a[136:139], v224, s[20:23], s12 offen offset:2048 sc1
v_mfma_f32_16x16x32_bf16 v[56:59], a[12:15], a[88:91], v[56:59]
v_mfma_f32_16x16x32_bf16 v[56:59], a[8:11], a[72:75], v[56:59]
v_mfma_f32_16x16x32_bf16 v[52:55], a[8:11], a[68:71], v[52:55]
ds_read_b128 a[4:7], v224 offset:41984
v_mfma_f32_16x16x32_bf16 v[52:55], a[12:15], a[84:87], v[52:55]
buffer_load_dwordx4 a[140:143], v224, s[20:23], s13 offen offset:2048 sc1
v_mfma_f32_16x16x32_bf16 v[48:51], a[12:15], a[80:83], v[48:51]
v_mfma_f32_16x16x32_bf16 v[48:51], a[8:11], a[64:67], v[48:51]
s_waitcnt lgkmcnt(4)
v_mfma_f32_16x16x32_bf16 v[64:67], a[16:19], a[64:67], v[64:67]
ds_read_b128 a[8:11], v224 offset:43008
v_mfma_f32_16x16x32_bf16 v[64:67], a[20:23], a[80:83], v[64:67]
buffer_load_dwordx4 a[144:147], v224, s[20:23], s10 offen offset:3072 sc1
v_mfma_f32_16x16x32_bf16 v[68:71], a[20:23], a[84:87], v[68:71]
v_mfma_f32_16x16x32_bf16 v[68:71], a[16:19], a[68:71], v[68:71]
v_mfma_f32_16x16x32_bf16 v[72:75], a[16:19], a[72:75], v[72:75]
ds_read_b128 a[12:15], v224 offset:44032
v_mfma_f32_16x16x32_bf16 v[72:75], a[20:23], a[88:91], v[72:75]
v_mfma_f32_16x16x32_bf16 v[76:79], a[20:23], a[92:95], v[76:79]
v_mfma_f32_16x16x32_bf16 v[76:79], a[16:19], a[76:79], v[76:79]
s_waitcnt lgkmcnt(4)
v_mfma_f32_16x16x32_bf16 v[92:95], a[24:27], a[76:79], v[92:95]
ds_read_b128 a[16:19], v224 offset:45056
v_mfma_f32_16x16x32_bf16 v[92:95], a[28:31], a[92:95], v[92:95]
buffer_load_dwordx4 a[148:151], v224, s[20:23], s11 offen offset:3072 sc1
v_mfma_f32_16x16x32_bf16 v[88:91], a[28:31], a[88:91], v[88:91]
v_mfma_f32_16x16x32_bf16 v[88:91], a[24:27], a[72:75], v[88:91]
v_mfma_f32_16x16x32_bf16 v[84:87], a[24:27], a[68:71], v[84:87]
ds_read_b128 a[20:23], v224 offset:46080
v_mfma_f32_16x16x32_bf16 v[84:87], a[28:31], a[84:87], v[84:87]
buffer_load_dwordx4 a[152:155], v224, s[20:23], s12 offen offset:3072 sc1
v_mfma_f32_16x16x32_bf16 v[80:83], a[28:31], a[80:83], v[80:83]
v_mfma_f32_16x16x32_bf16 v[80:83], a[24:27], a[64:67], v[80:83]
s_waitcnt lgkmcnt(4)
v_mfma_f32_16x16x32_bf16 v[96:99], a[0:3], a[64:67], v[96:99]
ds_read_b128 a[24:27], v224 offset:47104
v_mfma_f32_16x16x32_bf16 v[96:99], a[4:7], a[80:83], v[96:99]
buffer_load_dwordx4 a[156:159], v224, s[20:23], s13 offen offset:3072 sc1
v_mfma_f32_16x16x32_bf16 v[100:103], a[4:7], a[84:87], v[100:103]
v_mfma_f32_16x16x32_bf16 v[100:103], a[0:3], a[68:71], v[100:103]
v_mfma_f32_16x16x32_bf16 v[104:107], a[0:3], a[72:75], v[104:107]
ds_read_b128 a[28:31], v224 offset:48128
v_mfma_f32_16x16x32_bf16 v[104:107], a[4:7], a[88:91], v[104:107]
s_add_u32 s10, s39, 8192
v_mfma_f32_16x16x32_bf16 v[108:111], a[4:7], a[92:95], v[108:111]
buffer_load_dwordx4 a[160:163], v224, s[20:23], s10 offen offset:0 sc1
v_mfma_f32_16x16x32_bf16 v[108:111], a[0:3], a[76:79], v[108:111]
s_waitcnt lgkmcnt(4)
v_mfma_f32_16x16x32_bf16 v[124:127], a[8:11], a[76:79], v[124:127]
ds_read_b128 a[0:3], v224 offset:49152
v_mfma_f32_16x16x32_bf16 v[124:127], a[12:15], a[92:95], v[124:127]
v_mfma_f32_16x16x32_bf16 v[120:123], a[12:15], a[88:91], v[120:123]
v_mfma_f32_16x16x32_bf16 v[120:123], a[8:11], a[72:75], v[120:123]
v_mfma_f32_16x16x32_bf16 v[116:119], a[8:11], a[68:71], v[116:119]
ds_read_b128 a[4:7], v224 offset:50176
s_add_u32 s11, s39, 40960
v_mfma_f32_16x16x32_bf16 v[116:119], a[12:15], a[84:87], v[116:119]
buffer_load_dwordx4 a[164:167], v224, s[20:23], s11 offen offset:0 sc1
v_mfma_f32_16x16x32_bf16 v[112:115], a[12:15], a[80:83], v[112:115]
v_lshlrev_b32 v252, 3, v224
v_mfma_f32_16x16x32_bf16 v[112:115], a[8:11], a[64:67], v[112:115]
s_mov_b32 s58, L_ct0-L_body
s_waitcnt lgkmcnt(4)
v_mfma_f32_16x16x32_bf16 v[128:131], a[16:19], a[64:67], v[128:131]
buffer_load_dword v252, v252, s[80:83], s58 offen
v_mfma_f32_16x16x32_bf16 v[128:131], a[20:23], a[80:83], v[128:131]
ds_read_b128 a[8:11], v224 offset:51200
v_mfma_f32_16x16x32_bf16 v[132:135], a[20:23], a[84:87], v[132:135]
s_add_u32 s12, s39, 73728
v_mfma_f32_16x16x32_bf16 v[132:135], a[16:19], a[68:71], v[132:135]
buffer_load_dwordx4 a[168:171], v224, s[20:23], s12 offen offset:0 sc1
v_mfma_f32_16x16x32_bf16 v[136:139], a[16:19], a[72:75], v[136:139]
ds_read_b128 a[12:15], v224 offset:52224
v_mfma_f32_16x16x32_bf16 v[136:139], a[20:23], a[88:91], v[136:139]
s_add_u32 s13, s39, 106496
v_mfma_f32_16x16x32_bf16 v[140:143], a[20:23], a[92:95], v[140:143]
buffer_load_dwordx4 a[172:175], v224, s[20:23], s13 offen offset:0 sc1
v_mfma_f32_16x16x32_bf16 v[140:143], a[16:19], a[76:79], v[140:143]
s_waitcnt lgkmcnt(4)
v_mfma_f32_16x16x32_bf16 v[156:159], a[24:27], a[76:79], v[156:159]
ds_read_b128 a[16:19], v224 offset:53248
v_mfma_f32_16x16x32_bf16 v[156:159], a[28:31], a[92:95], v[156:159]
buffer_load_dwordx4 a[176:179], v224, s[20:23], s10 offen offset:1024 sc1
v_mfma_f32_16x16x32_bf16 v[152:155], a[28:31], a[88:91], v[152:155]
v_mfma_f32_16x16x32_bf16 v[152:155], a[24:27], a[72:75], v[152:155]
v_mfma_f32_16x16x32_bf16 v[148:151], a[24:27], a[68:71], v[148:151]
ds_read_b128 a[20:23], v224 offset:54272
v_mfma_f32_16x16x32_bf16 v[148:151], a[28:31], a[84:87], v[148:151]
v_mfma_f32_16x16x32_bf16 v[144:147], a[28:31], a[80:83], v[144:147]
v_mfma_f32_16x16x32_bf16 v[144:147], a[24:27], a[64:67], v[144:147]
s_waitcnt lgkmcnt(4)
v_mfma_f32_16x16x32_bf16 v[160:163], a[0:3], a[64:67], v[160:163]
ds_read_b128 a[24:27], v224 offset:55296
v_mfma_f32_16x16x32_bf16 v[160:163], a[4:7], a[80:83], v[160:163]
buffer_load_dwordx4 a[180:183], v224, s[20:23], s11 offen offset:1024 sc1
v_mfma_f32_16x16x32_bf16 v[164:167], a[4:7], a[84:87], v[164:167]
v_mfma_f32_16x16x32_bf16 v[164:167], a[0:3], a[68:71], v[164:167]
v_mfma_f32_16x16x32_bf16 v[168:171], a[0:3], a[72:75], v[168:171]
ds_read_b128 a[28:31], v224 offset:56320
v_mfma_f32_16x16x32_bf16 v[168:171], a[4:7], a[88:91], v[168:171]
buffer_load_dwordx4 a[184:187], v224, s[20:23], s12 offen offset:1024 sc1
v_mfma_f32_16x16x32_bf16 v[172:175], a[4:7], a[92:95], v[172:175]
v_mfma_f32_16x16x32_bf16 v[172:175], a[0:3], a[76:79], v[172:175]
s_waitcnt lgkmcnt(4)
v_mfma_f32_16x16x32_bf16 v[188:191], a[8:11], a[76:79], v[188:191]
ds_read_b128 a[0:3], v224 offset:57344
v_mfma_f32_16x16x32_bf16 v[188:191], a[12:15], a[92:95], v[188:191]
buffer_load_dwordx4 a[188:191], v224, s[20:23], s13 offen offset:1024 sc1
v_mfma_f32_16x16x32_bf16 v[184:187], a[12:15], a[88:91], v[184:187]
buffer_store_dwordx4 a[224:227], v224, s[28:31], s70 offen sc1
v_mfma_f32_16x16x32_bf16 v[184:187], a[8:11], a[72:75], v[184:187]
v_mfma_f32_16x16x32_bf16 v[180:183], a[8:11], a[68:71], v[180:183]
ds_read_b128 a[4:7], v224 offset:58368
v_mfma_f32_16x16x32_bf16 v[180:183], a[12:15], a[84:87], v[180:183]
buffer_load_dwordx4 a[192:195], v224, s[20:23], s10 offen offset:2048 sc1
v_mfma_f32_16x16x32_bf16 v[176:179], a[12:15], a[80:83], v[176:179]
v_mfma_f32_16x16x32_bf16 v[176:179], a[8:11], a[64:67], v[176:179]
s_waitcnt lgkmcnt(4)
v_mfma_f32_16x16x32_bf16 v[192:195], a[16:19], a[64:67], v[192:195]
ds_read_b128 a[8:11], v224 offset:59392
v_mfma_f32_16x16x32_bf16 v[192:195], a[20:23], a[80:83], v[192:195]
v_mfma_f32_16x16x32_bf16 v[196:199], a[20:23], a[84:87], v[196:199]
v_mfma_f32_16x16x32_bf16 v[196:199], a[16:19], a[68:71], v[196:199]
v_mfma_f32_16x16x32_bf16 v[200:203], a[16:19], a[72:75], v[200:203]
ds_read_b128 a[12:15], v224 offset:60416
v_mfma_f32_16x16x32_bf16 v[200:203], a[20:23], a[88:91], v[200:203]
buffer_load_dwordx4 a[196:199], v224, s[20:23], s11 offen offset:2048 sc1
v_mfma_f32_16x16x32_bf16 v[204:207], a[20:23], a[92:95], v[204:207]
v_mfma_f32_16x16x32_bf16 v[204:207], a[16:19], a[76:79], v[204:207]
s_waitcnt lgkmcnt(4)
v_mfma_f32_16x16x32_bf16 v[220:223], a[24:27], a[76:79], v[220:223]
ds_read_b128 a[16:19], v224 offset:61440
v_mfma_f32_16x16x32_bf16 v[220:223], a[28:31], a[92:95], v[220:223]
buffer_load_dwordx4 a[200:203], v224, s[20:23], s12 offen offset:2048 sc1
v_mfma_f32_16x16x32_bf16 v[216:219], a[28:31], a[88:91], v[216:219]
buffer_store_dwordx4 a[228:231], v224, s[28:31], s71 offen sc1
v_mfma_f32_16x16x32_bf16 v[216:219], a[24:27], a[72:75], v[216:219]
v_mfma_f32_16x16x32_bf16 v[212:215], a[24:27], a[68:71], v[212:215]
ds_read_b128 a[20:23], v224 offset:62464
v_mfma_f32_16x16x32_bf16 v[212:215], a[28:31], a[84:87], v[212:215]
buffer_load_dwordx4 a[204:207], v224, s[20:23], s13 offen offset:2048 sc1
v_mfma_f32_16x16x32_bf16 v[208:211], a[28:31], a[80:83], v[208:211]
v_mfma_f32_16x16x32_bf16 v[208:211], a[24:27], a[64:67], v[208:211]
s_waitcnt vmcnt(27) lgkmcnt(4)
v_mfma_f32_16x16x32_bf16 v[0:3], a[0:3], a[96:99], v[0:3]
ds_read_b128 a[24:27], v224 offset:63488
s_waitcnt vmcnt(23)
v_mfma_f32_16x16x32_bf16 v[0:3], a[4:7], a[112:115], v[0:3]
buffer_load_dwordx4 a[208:211], v224, s[20:23], s10 offen offset:3072 sc1
v_mfma_f32_16x16x32_bf16 v[4:7], a[4:7], a[116:119], v[4:7]
v_mfma_f32_16x16x32_bf16 v[4:7], a[0:3], a[100:103], v[4:7]
s_barrier
v_mfma_f32_16x16x32_bf16 v[8:11], a[0:3], a[104:107], v[8:11]
ds_read_b128 a[28:31], v224 offset:64512
v_mfma_f32_16x16x32_bf16 v[8:11], a[4:7], a[120:123], v[8:11]
v_mfma_f32_16x16x32_bf16 v[12:15], a[4:7], a[124:127], v[12:15]
v_mfma_f32_16x16x32_bf16 v[12:15], a[0:3], a[108:111], v[12:15]
s_waitcnt lgkmcnt(4)
v_mfma_f32_16x16x32_bf16 v[28:31], a[8:11], a[108:111], v[28:31]
ds_read_b128 a[0:3], v225 offset:0
v_mfma_f32_16x16x32_bf16 v[28:31], a[12:15], a[124:127], v[28:31]
buffer_load_dwordx4 a[212:215], v224, s[20:23], s11 offen offset:3072 sc1
v_mfma_f32_16x16x32_bf16 v[24:27], a[12:15], a[120:123], v[24:27]
buffer_store_dwordx4 a[232:235], v224, s[28:31], s72 offen sc1
v_mfma_f32_16x16x32_bf16 v[24:27], a[8:11], a[104:107], v[24:27]
v_mfma_f32_16x16x32_bf16 v[20:23], a[8:11], a[100:103], v[20:23]
ds_read_b128 a[4:7], v225 offset:1024
v_mfma_f32_16x16x32_bf16 v[20:23], a[12:15], a[116:119], v[20:23]
buffer_load_dwordx4 a[216:219], v224, s[20:23], s12 offen offset:3072 sc1
v_mfma_f32_16x16x32_bf16 v[16:19], a[12:15], a[112:115], v[16:19]
v_mfma_f32_16x16x32_bf16 v[16:19], a[8:11], a[96:99], v[16:19]
s_waitcnt lgkmcnt(4)
v_mfma_f32_16x16x32_bf16 v[32:35], a[16:19], a[96:99], v[32:35]
ds_read_b128 a[8:11], v225 offset:2048
v_mfma_f32_16x16x32_bf16 v[32:35], a[20:23], a[112:115], v[32:35]
buffer_load_dwordx4 a[220:223], v224, s[20:23], s13 offen offset:3072 sc1
v_mfma_f32_16x16x32_bf16 v[36:39], a[20:23], a[116:119], v[36:39]
v_mfma_f32_16x16x32_bf16 v[36:39], a[16:19], a[100:103], v[36:39]
v_mfma_f32_16x16x32_bf16 v[40:43], a[16:19], a[104:107], v[40:43]
ds_read_b128 a[12:15], v225 offset:3072
v_mfma_f32_16x16x32_bf16 v[40:43], a[20:23], a[120:123], v[40:43]
s_add_u32 m0, s36, 0
v_mfma_f32_16x16x32_bf16 v[44:47], a[20:23], a[124:127], v[44:47]
s_add_u32 s57, s37, 131072
v_mfma_f32_16x16x32_bf16 v[44:47], a[16:19], a[108:111], v[44:47]
s_waitcnt lgkmcnt(4)
v_mfma_f32_16x16x32_bf16 v[60:63], a[24:27], a[108:111], v[60:63]
buffer_load_dwordx4 v226, s[20:23], s57 offen offset:0 sc1 lds
v_mfma_f32_16x16x32_bf16 v[60:63], a[28:31], a[124:127], v[60:63]
ds_read_b128 a[16:19], v225 offset:4096
v_mfma_f32_16x16x32_bf16 v[56:59], a[28:31], a[120:123], v[56:59]
buffer_store_dwordx4 a[236:239], v224, s[28:31], s73 offen sc1
v_mfma_f32_16x16x32_bf16 v[56:59], a[24:27], a[104:107], v[56:59]
v_mfma_f32_16x16x32_bf16 v[52:55], a[24:27], a[100:103], v[52:55]
ds_read_b128 a[20:23], v225 offset:5120
v_mfma_f32_16x16x32_bf16 v[52:55], a[28:31], a[116:119], v[52:55]
buffer_load_dwordx4 v226, s[20:23], s57 offen offset:1024 sc1 lds
v_mfma_f32_16x16x32_bf16 v[48:51], a[28:31], a[112:115], v[48:51]
v_mfma_f32_16x16x32_bf16 v[48:51], a[24:27], a[96:99], v[48:51]
s_waitcnt lgkmcnt(4)
v_mfma_f32_16x16x32_bf16 v[64:67], a[0:3], a[96:99], v[64:67]
ds_read_b128 a[24:27], v225 offset:6144
v_mfma_f32_16x16x32_bf16 v[64:67], a[4:7], a[112:115], v[64:67]
buffer_load_dwordx4 v226, s[20:23], s57 offen offset:2048 sc1 lds
v_mfma_f32_16x16x32_bf16 v[68:71], a[4:7], a[116:119], v[68:71]
v_mfma_f32_16x16x32_bf16 v[68:71], a[0:3], a[100:103], v[68:71]
v_mfma_f32_16x16x32_bf16 v[72:75], a[0:3], a[104:107], v[72:75]
ds_read_b128 a[28:31], v225 offset:7168
v_mfma_f32_16x16x32_bf16 v[72:75], a[4:7], a[120:123], v[72:75]
buffer_load_dwordx4 v226, s[20:23], s57 offen offset:3072 sc1 lds
v_mfma_f32_16x16x32_bf16 v[76:79], a[4:7], a[124:127], v[76:79]
v_mfma_f32_16x16x32_bf16 v[76:79], a[0:3], a[108:111], v[76:79]
s_waitcnt lgkmcnt(4)
v_mfma_f32_16x16x32_bf16 v[92:95], a[8:11], a[108:111], v[92:95]
ds_read_b128 a[0:3], v225 offset:8192
v_mfma_f32_16x16x32_bf16 v[92:95], a[12:15], a[124:127], v[92:95]
s_add_u32 m0, s36, 16384
v_mfma_f32_16x16x32_bf16 v[88:91], a[12:15], a[120:123], v[88:91]
s_add_u32 s57, s37, 147456
v_mfma_f32_16x16x32_bf16 v[88:91], a[8:11], a[104:107], v[88:91]
buffer_load_dwordx4 v226, s[20:23], s57 offen offset:0 sc1 lds
v_mfma_f32_16x16x32_bf16 v[84:87], a[8:11], a[100:103], v[84:87]
buffer_store_dwordx4 a[240:243], v224, s[28:31], s74 offen sc1
v_mfma_f32_16x16x32_bf16 v[84:87], a[12:15], a[116:119], v[84:87]
ds_read_b128 a[4:7], v225 offset:9216
v_mfma_f32_16x16x32_bf16 v[80:83], a[12:15], a[112:115], v[80:83]
v_mfma_f32_16x16x32_bf16 v[80:83], a[8:11], a[96:99], v[80:83]
s_waitcnt lgkmcnt(4)
v_mfma_f32_16x16x32_bf16 v[96:99], a[16:19], a[96:99], v[96:99]
ds_read_b128 a[8:11], v225 offset:10240
v_mfma_f32_16x16x32_bf16 v[96:99], a[20:23], a[112:115], v[96:99]
buffer_load_dwordx4 v226, s[20:23], s57 offen offset:1024 sc1 lds
v_mfma_f32_16x16x32_bf16 v[100:103], a[20:23], a[116:119], v[100:103]
v_mfma_f32_16x16x32_bf16 v[100:103], a[16:19], a[100:103], v[100:103]
v_mfma_f32_16x16x32_bf16 v[104:107], a[16:19], a[104:107], v[104:107]
ds_read_b128 a[12:15], v225 offset:11264
v_mfma_f32_16x16x32_bf16 v[104:107], a[20:23], a[120:123], v[104:107]
buffer_load_dwordx4 v226, s[20:23], s57 offen offset:2048 sc1 lds
v_mfma_f32_16x16x32_bf16 v[108:111], a[20:23], a[124:127], v[108:111]
v_mfma_f32_16x16x32_bf16 v[108:111], a[16:19], a[108:111], v[108:111]
s_waitcnt lgkmcnt(4)
v_mfma_f32_16x16x32_bf16 v[124:127], a[24:27], a[108:111], v[124:127]
ds_read_b128 a[16:19], v225 offset:12288
v_mfma_f32_16x16x32_bf16 v[124:127], a[28:31], a[124:127], v[124:127]
buffer_load_dwordx4 v226, s[20:23], s57 offen offset:3072 sc1 lds
v_mfma_f32_16x16x32_bf16 v[120:123], a[28:31], a[120:123], v[120:123]
buffer_store_dwordx4 a[244:247], v224, s[28:31], s75 offen sc1
v_mfma_f32_16x16x32_bf16 v[120:123], a[24:27], a[104:107], v[120:123]
v_mfma_f32_16x16x32_bf16 v[116:119], a[24:27], a[100:103], v[116:119]
ds_read_b128 a[20:23], v225 offset:13312
v_mfma_f32_16x16x32_bf16 v[116:119], a[28:31], a[116:119], v[116:119]
s_add_u32 m0, s36, 32768
v_mfma_f32_16x16x32_bf16 v[112:115], a[28:31], a[112:115], v[112:115]
s_add_u32 s57, s37, 163840
v_mfma_f32_16x16x32_bf16 v[112:115], a[24:27], a[96:99], v[112:115]
s_waitcnt lgkmcnt(4)
v_mfma_f32_16x16x32_bf16 v[128:131], a[0:3], a[96:99], v[128:131]
buffer_load_dwordx4 v226, s[20:23], s57 offen offset:0 sc1 lds
v_mfma_f32_16x16x32_bf16 v[128:131], a[4:7], a[112:115], v[128:131]
ds_read_b128 a[24:27], v225 offset:14336
v_mfma_f32_16x16x32_bf16 v[132:135], a[4:7], a[116:119], v[132:135]
v_mfma_f32_16x16x32_bf16 v[132:135], a[0:3], a[100:103], v[132:135]
s_barrier
v_mfma_f32_16x16x32_bf16 v[136:139], a[0:3], a[104:107], v[136:139]
ds_read_b128 a[28:31], v225 offset:15360
v_mfma_f32_16x16x32_bf16 v[136:139], a[4:7], a[120:123], v[136:139]
buffer_load_dwordx4 v226, s[20:23], s57 offen offset:1024 sc1 lds
v_mfma_f32_16x16x32_bf16 v[140:143], a[4:7], a[124:127], v[140:143]
v_mfma_f32_16x16x32_bf16 v[140:143], a[0:3], a[108:111], v[140:143]
s_waitcnt lgkmcnt(4)
v_mfma_f32_16x16x32_bf16 v[156:159], a[8:11], a[108:111], v[156:159]
ds_read_b128 a[0:3], v225 offset:16384
v_mfma_f32_16x16x32_bf16 v[156:159], a[12:15], a[124:127], v[156:159]
buffer_load_dwordx4 v226, s[20:23], s57 offen offset:2048 sc1 lds
v_mfma_f32_16x16x32_bf16 v[152:155], a[12:15], a[120:123], v[152:155]
buffer_store_dwordx4 a[248:251], v224, s[28:31], s76 offen sc1
v_mfma_f32_16x16x32_bf16 v[152:155], a[8:11], a[104:107], v[152:155]
v_mfma_f32_16x16x32_bf16 v[148:151], a[8:11], a[100:103], v[148:151]
ds_read_b128 a[4:7], v225 offset:17408
v_mfma_f32_16x16x32_bf16 v[148:151], a[12:15], a[116:119], v[148:151]
buffer_load_dwordx4 v226, s[20:23], s57 offen offset:3072 sc1 lds
v_mfma_f32_16x16x32_bf16 v[144:147], a[12:15], a[112:115], v[144:147]
v_mfma_f32_16x16x32_bf16 v[144:147], a[8:11], a[96:99], v[144:147]
s_waitcnt lgkmcnt(4)
v_mfma_f32_16x16x32_bf16 v[160:163], a[16:19], a[96:99], v[160:163]
ds_read_b128 a[8:11], v225 offset:18432
v_mfma_f32_16x16x32_bf16 v[160:163], a[20:23], a[112:115], v[160:163]
s_add_u32 s10, s39, 12288
v_mfma_f32_16x16x32_bf16 v[164:167], a[20:23], a[116:119], v[164:167]
buffer_load_dwordx4 a[32:35], v224, s[20:23], s10 offen offset:2048 sc1
v_mfma_f32_16x16x32_bf16 v[164:167], a[16:19], a[100:103], v[164:167]
v_mfma_f32_16x16x32_bf16 v[168:171], a[16:19], a[104:107], v[168:171]
ds_read_b128 a[12:15], v225 offset:19456
v_mfma_f32_16x16x32_bf16 v[168:171], a[20:23], a[120:123], v[168:171]
v_mfma_f32_16x16x32_bf16 v[172:175], a[20:23], a[124:127], v[172:175]
v_mfma_f32_16x16x32_bf16 v[172:175], a[16:19], a[108:111], v[172:175]
s_waitcnt lgkmcnt(4)
v_mfma_f32_16x16x32_bf16 v[188:191], a[24:27], a[108:111], v[188:191]
ds_read_b128 a[16:19], v225 offset:20480
v_mfma_f32_16x16x32_bf16 v[188:191], a[28:31], a[124:127], v[188:191]
s_add_u32 s11, s39, 45056
v_mfma_f32_16x16x32_bf16 v[184:187], a[28:31], a[120:123], v[184:187]
buffer_load_dwordx4 a[36:39], v224, s[20:23], s11 offen offset:2048 sc1
v_mfma_f32_16x16x32_bf16 v[184:187], a[24:27], a[104:107], v[184:187]
buffer_store_dwordx4 a[252:255], v224, s[28:31], s77 offen sc1
v_mfma_f32_16x16x32_bf16 v[180:183], a[24:27], a[100:103], v[180:183]
ds_read_b128 a[20:23], v225 offset:21504
v_mfma_f32_16x16x32_bf16 v[180:183], a[28:31], a[116:119], v[180:183]
s_add_u32 s12, s39, 77824
v_mfma_f32_16x16x32_bf16 v[176:179], a[28:31], a[112:115], v[176:179]
buffer_load_dwordx4 a[40:43], v224, s[20:23], s12 offen offset:2048 sc1
v_mfma_f32_16x16x32_bf16 v[176:179], a[24:27], a[96:99], v[176:179]
s_waitcnt lgkmcnt(4)
v_mfma_f32_16x16x32_bf16 v[192:195], a[0:3], a[96:99], v[192:195]
ds_read_b128 a[24:27], v225 offset:22528
v_mfma_f32_16x16x32_bf16 v[192:195], a[4:7], a[112:115], v[192:195]
s_add_u32 m0, s36, 49152
v_mfma_f32_16x16x32_bf16 v[196:199], a[4:7], a[116:119], v[196:199]
s_add_u32 s57, s37, 180224
v_mfma_f32_16x16x32_bf16 v[196:199], a[0:3], a[100:103], v[196:199]
buffer_load_dwordx4 v226, s[20:23], s57 offen offset:0 sc1 lds
v_mfma_f32_16x16x32_bf16 v[200:203], a[0:3], a[104:107], v[200:203]
ds_read_b128 a[28:31], v225 offset:23552
v_mfma_f32_16x16x32_bf16 v[200:203], a[4:7], a[120:123], v[200:203]
buffer_load_dwordx4 v226, s[20:23], s57 offen offset:1024 sc1 lds
v_mfma_f32_16x16x32_bf16 v[204:207], a[4:7], a[124:127], v[204:207]
v_mfma_f32_16x16x32_bf16 v[204:207], a[0:3], a[108:111], v[204:207]
s_waitcnt lgkmcnt(4)
v_mfma_f32_16x16x32_bf16 v[220:223], a[8:11], a[108:111], v[220:223]
ds_read_b128 a[0:3], v225 offset:24576
v_mfma_f32_16x16x32_bf16 v[220:223], a[12:15], a[124:127], v[220:223]
v_mfma_f32_16x16x32_bf16 v[216:219], a[12:15], a[120:123], v[216:219]
v_mfma_f32_16x16x32_bf16 v[216:219], a[8:11], a[104:107], v[216:219]
v_mfma_f32_16x16x32_bf16 v[212:215], a[8:11], a[100:103], v[212:215]
ds_read_b128 a[4:7], v225 offset:25600
v_mfma_f32_16x16x32_bf16 v[212:215], a[12:15], a[116:119], v[212:215]
buffer_load_dwordx4 v226, s[20:23], s57 offen offset:2048 sc1 lds
v_mfma_f32_16x16x32_bf16 v[208:211], a[12:15], a[112:115], v[208:211]
v_mfma_f32_16x16x32_bf16 v[208:211], a[8:11], a[96:99], v[208:211]
s_waitcnt vmcnt(47) lgkmcnt(4)
v_mfma_f32_16x16x32_bf16 v[0:3], a[16:19], a[128:131], v[0:3]
ds_read_b128 a[8:11], v225 offset:26624
s_waitcnt vmcnt(43)
v_mfma_f32_16x16x32_bf16 v[0:3], a[20:23], a[144:147], v[0:3]
buffer_load_dwordx4 v226, s[20:23], s57 offen offset:3072 sc1 lds
v_mfma_f32_16x16x32_bf16 v[4:7], a[20:23], a[148:151], v[4:7]
v_mfma_f32_16x16x32_bf16 v[4:7], a[16:19], a[132:135], v[4:7]
v_mfma_f32_16x16x32_bf16 v[8:11], a[16:19], a[136:139], v[8:11]
ds_read_b128 a[12:15], v225 offset:27648
v_mfma_f32_16x16x32_bf16 v[8:11], a[20:23], a[152:155], v[8:11]
s_add_u32 s13, s39, 110592
v_mfma_f32_16x16x32_bf16 v[12:15], a[20:23], a[156:159], v[12:15]
buffer_load_dwordx4 a[44:47], v224, s[20:23], s13 offen offset:2048 sc1
v_mfma_f32_16x16x32_bf16 v[12:15], a[16:19], a[140:143], v[12:15]
s_waitcnt lgkmcnt(4)
v_mfma_f32_16x16x32_bf16 v[28:31], a[24:27], a[140:143], v[28:31]
ds_read_b128 a[16:19], v225 offset:28672
v_mfma_f32_16x16x32_bf16 v[28:31], a[28:31], a[156:159], v[28:31]
buffer_load_dwordx4 a[48:51], v224, s[20:23], s10 offen offset:3072 sc1
v_mfma_f32_16x16x32_bf16 v[24:27], a[28:31], a[152:155], v[24:27]
v_mfma_f32_16x16x32_bf16 v[24:27], a[24:27], a[136:139], v[24:27]
v_mfma_f32_16x16x32_bf16 v[20:23], a[24:27], a[132:135], v[20:23]
ds_read_b128 a[20:23], v225 offset:29696
v_mfma_f32_16x16x32_bf16 v[20:23], a[28:31], a[148:151], v[20:23]
v_mfma_f32_16x16x32_bf16 v[16:19], a[28:31], a[144:147], v[16:19]
v_mfma_f32_16x16x32_bf16 v[16:19], a[24:27], a[128:131], v[16:19]
s_waitcnt lgkmcnt(4)
v_mfma_f32_16x16x32_bf16 v[32:35], a[0:3], a[128:131], v[32:35]
ds_read_b128 a[24:27], v225 offset:30720
v_mfma_f32_16x16x32_bf16 v[32:35], a[4:7], a[144:147], v[32:35]
buffer_load_dwordx4 a[52:55], v224, s[20:23], s11 offen offset:3072 sc1
v_mfma_f32_16x16x32_bf16 v[36:39], a[4:7], a[148:151], v[36:39]
v_mfma_f32_16x16x32_bf16 v[36:39], a[0:3], a[132:135], v[36:39]
s_barrier
v_mfma_f32_16x16x32_bf16 v[40:43], a[0:3], a[136:139], v[40:43]
ds_read_b128 a[28:31], v225 offset:31744
v_mfma_f32_16x16x32_bf16 v[40:43], a[4:7], a[152:155], v[40:43]
buffer_load_dwordx4 a[56:59], v224, s[20:23], s12 offen offset:3072 sc1
v_mfma_f32_16x16x32_bf16 v[44:47], a[4:7], a[156:159], v[44:47]
v_mfma_f32_16x16x32_bf16 v[44:47], a[0:3], a[140:143], v[44:47]
s_waitcnt lgkmcnt(4)
v_mfma_f32_16x16x32_bf16 v[60:63], a[8:11], a[140:143], v[60:63]
ds_read_b128 a[0:3], v225 offset:32768
v_mfma_f32_16x16x32_bf16 v[60:63], a[12:15], a[156:159], v[60:63]
buffer_load_dwordx4 a[60:63], v224, s[20:23], s13 offen offset:3072 sc1
v_mfma_f32_16x16x32_bf16 v[56:59], a[12:15], a[152:155], v[56:59]
v_mfma_f32_16x16x32_bf16 v[56:59], a[8:11], a[136:139], v[56:59]
v_mfma_f32_16x16x32_bf16 v[52:55], a[8:11], a[132:135], v[52:55]
ds_read_b128 a[4:7], v225 offset:33792
v_mfma_f32_16x16x32_bf16 v[52:55], a[12:15], a[148:151], v[52:55]
buffer_load_dwordx4 a[224:227], v224, s[20:23], s10 offen offset:0 sc1
v_mfma_f32_16x16x32_bf16 v[48:51], a[12:15], a[144:147], v[48:51]
v_mfma_f32_16x16x32_bf16 v[48:51], a[8:11], a[128:131], v[48:51]
s_waitcnt lgkmcnt(4)
v_mfma_f32_16x16x32_bf16 v[64:67], a[16:19], a[128:131], v[64:67]
ds_read_b128 a[8:11], v225 offset:34816
v_mfma_f32_16x16x32_bf16 v[64:67], a[20:23], a[144:147], v[64:67]
v_mfma_f32_16x16x32_bf16 v[68:71], a[20:23], a[148:151], v[68:71]
v_mfma_f32_16x16x32_bf16 v[68:71], a[16:19], a[132:135], v[68:71]
v_mfma_f32_16x16x32_bf16 v[72:75], a[16:19], a[136:139], v[72:75]
ds_read_b128 a[12:15], v225 offset:35840
v_mfma_f32_16x16x32_bf16 v[72:75], a[20:23], a[152:155], v[72:75]
buffer_load_dwordx4 a[228:231], v224, s[20:23], s11 offen offset:0 sc1
v_mfma_f32_16x16x32_bf16 v[76:79], a[20:23], a[156:159], v[76:79]
v_mfma_f32_16x16x32_bf16 v[76:79], a[16:19], a[140:143], v[76:79]
s_waitcnt lgkmcnt(4)
v_mfma_f32_16x16x32_bf16 v[92:95], a[24:27], a[140:143], v[92:95]
ds_read_b128 a[16:19], v225 offset:36864
v_mfma_f32_16x16x32_bf16 v[92:95], a[28:31], a[156:159], v[92:95]
buffer_load_dwordx4 a[232:235], v224, s[20:23], s12 offen offset:0 sc1
v_mfma_f32_16x16x32_bf16 v[88:91], a[28:31], a[152:155], v[88:91]
v_mfma_f32_16x16x32_bf16 v[88:91], a[24:27], a[136:139], v[88:91]
v_mfma_f32_16x16x32_bf16 v[84:87], a[24:27], a[132:135], v[84:87]
ds_read_b128 a[20:23], v225 offset:37888
v_mfma_f32_16x16x32_bf16 v[84:87], a[28:31], a[148:151], v[84:87]
buffer_load_dwordx4 a[236:239], v224, s[20:23], s13 offen offset:0 sc1
v_mfma_f32_16x16x32_bf16 v[80:83], a[28:31], a[144:147], v[80:83]
v_mfma_f32_16x16x32_bf16 v[80:83], a[24:27], a[128:131], v[80:83]
s_waitcnt lgkmcnt(4)
v_mfma_f32_16x16x32_bf16 v[96:99], a[0:3], a[128:131], v[96:99]
ds_read_b128 a[24:27], v225 offset:38912
v_mfma_f32_16x16x32_bf16 v[96:99], a[4:7], a[144:147], v[96:99]
buffer_load_dwordx4 a[240:243], v224, s[20:23], s10 offen offset:1024 sc1
v_mfma_f32_16x16x32_bf16 v[100:103], a[4:7], a[148:151], v[100:103]
v_mfma_f32_16x16x32_bf16 v[100:103], a[0:3], a[132:135], v[100:103]
v_mfma_f32_16x16x32_bf16 v[104:107], a[0:3], a[136:139], v[104:107]
ds_read_b128 a[28:31], v225 offset:39936
v_mfma_f32_16x16x32_bf16 v[104:107], a[4:7], a[152:155], v[104:107]
v_mfma_f32_16x16x32_bf16 v[108:111], a[4:7], a[156:159], v[108:111]
v_mfma_f32_16x16x32_bf16 v[108:111], a[0:3], a[140:143], v[108:111]
s_waitcnt lgkmcnt(4)
v_mfma_f32_16x16x32_bf16 v[124:127], a[8:11], a[140:143], v[124:127]
ds_read_b128 a[0:3], v225 offset:40960
v_mfma_f32_16x16x32_bf16 v[124:127], a[12:15], a[156:159], v[124:127]
buffer_load_dwordx4 a[244:247], v224, s[20:23], s11 offen offset:1024 sc1
v_mfma_f32_16x16x32_bf16 v[120:123], a[12:15], a[152:155], v[120:123]
v_mfma_f32_16x16x32_bf16 v[120:123], a[8:11], a[136:139], v[120:123]
v_mfma_f32_16x16x32_bf16 v[116:119], a[8:11], a[132:135], v[116:119]
ds_read_b128 a[4:7], v225 offset:41984
v_mfma_f32_16x16x32_bf16 v[116:119], a[12:15], a[148:151], v[116:119]
buffer_load_dwordx4 a[248:251], v224, s[20:23], s12 offen offset:1024 sc1
v_mfma_f32_16x16x32_bf16 v[112:115], a[12:15], a[144:147], v[112:115]
v_mfma_f32_16x16x32_bf16 v[112:115], a[8:11], a[128:131], v[112:115]
s_waitcnt lgkmcnt(4)
v_mfma_f32_16x16x32_bf16 v[128:131], a[16:19], a[128:131], v[128:131]
ds_read_b128 a[8:11], v225 offset:43008
v_mfma_f32_16x16x32_bf16 v[128:131], a[20:23], a[144:147], v[128:131]
buffer_load_dwordx4 a[252:255], v224, s[20:23], s13 offen offset:1024 sc1
v_mfma_f32_16x16x32_bf16 v[132:135], a[20:23], a[148:151], v[132:135]
v_mfma_f32_16x16x32_bf16 v[132:135], a[16:19], a[132:135], v[132:135]
v_mfma_f32_16x16x32_bf16 v[136:139], a[16:19], a[136:139], v[136:139]
ds_read_b128 a[12:15], v225 offset:44032
v_mfma_f32_16x16x32_bf16 v[136:139], a[20:23], a[152:155], v[136:139]
s_add_u32 m0, s36, 65536
v_mfma_f32_16x16x32_bf16 v[140:143], a[20:23], a[156:159], v[140:143]
s_add_u32 s57, s37, 196608
v_mfma_f32_16x16x32_bf16 v[140:143], a[16:19], a[140:143], v[140:143]
s_waitcnt lgkmcnt(4)
v_mfma_f32_16x16x32_bf16 v[156:159], a[24:27], a[140:143], v[156:159]
buffer_load_dwordx4 v226, s[20:23], s57 offen offset:0 sc1 lds
v_mfma_f32_16x16x32_bf16 v[156:159], a[28:31], a[156:159], v[156:159]
ds_read_b128 a[16:19], v225 offset:45056
v_mfma_f32_16x16x32_bf16 v[152:155], a[28:31], a[152:155], v[152:155]
v_mfma_f32_16x16x32_bf16 v[152:155], a[24:27], a[136:139], v[152:155]
v_mfma_f32_16x16x32_bf16 v[148:151], a[24:27], a[132:135], v[148:151]
ds_read_b128 a[20:23], v225 offset:46080
v_mfma_f32_16x16x32_bf16 v[148:151], a[28:31], a[148:151], v[148:151]
buffer_load_dwordx4 v226, s[20:23], s57 offen offset:1024 sc1 lds
v_mfma_f32_16x16x32_bf16 v[144:147], a[28:31], a[144:147], v[144:147]
v_mfma_f32_16x16x32_bf16 v[144:147], a[24:27], a[128:131], v[144:147]
s_waitcnt lgkmcnt(4)
v_mfma_f32_16x16x32_bf16 v[160:163], a[0:3], a[128:131], v[160:163]
ds_read_b128 a[24:27], v225 offset:47104
v_mfma_f32_16x16x32_bf16 v[160:163], a[4:7], a[144:147], v[160:163]
buffer_load_dwordx4 v226, s[20:23], s57 offen offset:2048 sc1 lds
v_mfma_f32_16x16x32_bf16 v[164:167], a[4:7], a[148:151], v[164:167]
v_mfma_f32_16x16x32_bf16 v[164:167], a[0:3], a[132:135], v[164:167]
s_barrier
v_mfma_f32_16x16x32_bf16 v[168:171], a[0:3], a[136:139], v[168:171]
ds_read_b128 a[28:31], v225 offset:48128
v_mfma_f32_16x16x32_bf16 v[168:171], a[4:7], a[152:155], v[168:171]
buffer_load_dwordx4 v226, s[20:23], s57 offen offset:3072 sc1 lds
v_mfma_f32_16x16x32_bf16 v[172:175], a[4:7], a[156:159], v[172:175]
v_mfma_f32_16x16x32_bf16 v[172:175], a[0:3], a[140:143], v[172:175]
s_waitcnt lgkmcnt(4)
v_mfma_f32_16x16x32_bf16 v[188:191], a[8:11], a[140:143], v[188:191]
ds_read_b128 a[0:3], v225 offset:49152
v_mfma_f32_16x16x32_bf16 v[188:191], a[12:15], a[156:159], v[188:191]
s_add_u32 s10, s39, 16384
v_mfma_f32_16x16x32_bf16 v[184:187], a[12:15], a[152:155], v[184:187]
buffer_load_dwordx4 a[64:67], v224, s[20:23], s10 offen offset:0 sc1
v_mfma_f32_16x16x32_bf16 v[184:187], a[8:11], a[136:139], v[184:187]
v_mfma_f32_16x16x32_bf16 v[180:183], a[8:11], a[132:135], v[180:183]
ds_read_b128 a[4:7], v225 offset:50176
v_mfma_f32_16x16x32_bf16 v[180:183], a[12:15], a[148:151], v[180:183]
v_mfma_f32_16x16x32_bf16 v[176:179], a[12:15], a[144:147], v[176:179]
v_mfma_f32_16x16x32_bf16 v[176:179], a[8:11], a[128:131], v[176:179]
s_waitcnt lgkmcnt(4)
v_mfma_f32_16x16x32_bf16 v[192:195], a[16:19], a[128:131], v[192:195]
ds_read_b128 a[8:11], v225 offset:51200
v_mfma_f32_16x16x32_bf16 v[192:195], a[20:23], a[144:147], v[192:195]
s_add_u32 s11, s39, 49152
v_mfma_f32_16x16x32_bf16 v[196:199], a[20:23], a[148:151], v[196:199]
buffer_load_dwordx4 a[68:71], v224, s[20:23], s11 offen offset:0 sc1
v_mfma_f32_16x16x32_bf16 v[196:199], a[16:19], a[132:135], v[196:199]
v_mfma_f32_16x16x32_bf16 v[200:203], a[16:19], a[136:139], v[200:203]
ds_read_b128 a[12:15], v225 offset:52224
v_mfma_f32_16x16x32_bf16 v[200:203], a[20:23], a[152:155], v[200:203]
s_add_u32 s12, s39, 81920
v_mfma_f32_16x16x32_bf16 v[204:207], a[20:23], a[156:159], v[204:207]
buffer_load_dwordx4 a[72:75], v224, s[20:23], s12 offen offset:0 sc1
v_mfma_f32_16x16x32_bf16 v[204:207], a[16:19], a[140:143], v[204:207]
s_waitcnt vmcnt(25)
s_mov_b64 exec, 1
buffer_store_dword v253, off, s[28:31], s63 sc1
s_mov_b64 exec, -1
s_mov_b32 s30, s101
s_waitcnt lgkmcnt(4)
v_mfma_f32_16x16x32_bf16 v[220:223], a[24:27], a[140:143], v[220:223]
ds_read_b128 a[16:19], v225 offset:53248
v_mfma_f32_16x16x32_bf16 v[220:223], a[28:31], a[156:159], v[220:223]
s_add_u32 s13, s39, 114688
v_mfma_f32_16x16x32_bf16 v[216:219], a[28:31], a[152:155], v[216:219]
buffer_load_dwordx4 a[76:79], v224, s[20:23], s13 offen offset:0 sc1
v_mfma_f32_16x16x32_bf16 v[216:219], a[24:27], a[136:139], v[216:219]
v_mfma_f32_16x16x32_bf16 v[212:215], a[24:27], a[132:135], v[212:215]
ds_read_b128 a[20:23], v225 offset:54272
v_mfma_f32_16x16x32_bf16 v[212:215], a[28:31], a[148:151], v[212:215]
buffer_load_dwordx4 a[80:83], v224, s[20:23], s10 offen offset:1024 sc1
v_mfma_f32_16x16x32_bf16 v[208:211], a[28:31], a[144:147], v[208:211]
v_mfma_f32_16x16x32_bf16 v[208:211], a[24:27], a[128:131], v[208:211]
s_waitcnt lgkmcnt(4)
v_mfma_f32_16x16x32_bf16 v[0:3], a[0:3], a[160:163], v[0:3]
ds_read_b128 a[24:27], v225 offset:55296
v_mfma_f32_16x16x32_bf16 v[0:3], a[4:7], a[176:179], v[0:3]
v_mfma_f32_16x16x32_bf16 v[4:7], a[4:7], a[180:183], v[4:7]
v_mfma_f32_16x16x32_bf16 v[4:7], a[0:3], a[164:167], v[4:7]
v_mfma_f32_16x16x32_bf16 v[8:11], a[0:3], a[168:171], v[8:11]
ds_read_b128 a[28:31], v225 offset:56320
v_mfma_f32_16x16x32_bf16 v[8:11], a[4:7], a[184:187], v[8:11]
buffer_load_dwordx4 a[84:87], v224, s[20:23], s11 offen offset:1024 sc1
v_mfma_f32_16x16x32_bf16 v[12:15], a[4:7], a[188:191], v[12:15]
v_mfma_f32_16x16x32_bf16 v[12:15], a[0:3], a[172:175], v[12:15]
s_waitcnt lgkmcnt(4)
v_mfma_f32_16x16x32_bf16 v[28:31], a[8:11], a[172:175], v[28:31]
ds_read_b128 a[0:3], v225 offset:57344
v_mfma_f32_16x16x32_bf16 v[28:31], a[12:15], a[188:191], v[28:31]
buffer_load_dwordx4 a[88:91], v224, s[20:23], s12 offen offset:1024 sc1
v_mfma_f32_16x16x32_bf16 v[24:27], a[12:15], a[184:187], v[24:27]
v_mfma_f32_16x16x32_bf16 v[24:27], a[8:11], a[168:171], v[24:27]
v_mfma_f32_16x16x32_bf16 v[20:23], a[8:11], a[164:167], v[20:23]
ds_read_b128 a[4:7], v225 offset:58368
v_mfma_f32_16x16x32_bf16 v[20:23], a[12:15], a[180:183], v[20:23]
buffer_load_dwordx4 a[92:95], v224, s[20:23], s13 offen offset:1024 sc1
v_mfma_f32_16x16x32_bf16 v[16:19], a[12:15], a[176:179], v[16:19]
v_mfma_f32_16x16x32_bf16 v[16:19], a[8:11], a[160:163], v[16:19]
s_waitcnt lgkmcnt(4)
v_mfma_f32_16x16x32_bf16 v[32:35], a[16:19], a[160:163], v[32:35]
ds_read_b128 a[8:11], v225 offset:59392
v_mfma_f32_16x16x32_bf16 v[32:35], a[20:23], a[176:179], v[32:35]
s_add_u32 m0, s36, 81920
v_mfma_f32_16x16x32_bf16 v[36:39], a[20:23], a[180:183], v[36:39]
s_add_u32 s57, s37, 212992
v_mfma_f32_16x16x32_bf16 v[36:39], a[16:19], a[164:167], v[36:39]
buffer_load_dwordx4 v226, s[20:23], s57 offen offset:0 sc1 lds
v_mfma_f32_16x16x32_bf16 v[40:43], a[16:19], a[168:171], v[40:43]
ds_read_b128 a[12:15], v225 offset:60416
v_mfma_f32_16x16x32_bf16 v[40:43], a[20:23], a[184:187], v[40:43]
v_mfma_f32_16x16x32_bf16 v[44:47], a[20:23], a[188:191], v[44:47]
v_mfma_f32_16x16x32_bf16 v[44:47], a[16:19], a[172:175], v[44:47]
s_waitcnt lgkmcnt(4)
v_mfma_f32_16x16x32_bf16 v[60:63], a[24:27], a[172:175], v[60:63]
ds_read_b128 a[16:19], v225 offset:61440
v_mfma_f32_16x16x32_bf16 v[60:63], a[28:31], a[188:191], v[60:63]
buffer_load_dwordx4 v226, s[20:23], s57 offen offset:1024 sc1 lds
v_mfma_f32_16x16x32_bf16 v[56:59], a[28:31], a[184:187], v[56:59]
v_mfma_f32_16x16x32_bf16 v[56:59], a[24:27], a[168:171], v[56:59]
v_mfma_f32_16x16x32_bf16 v[52:55], a[24:27], a[164:167], v[52:55]
ds_read_b128 a[20:23], v225 offset:62464
v_mfma_f32_16x16x32_bf16 v[52:55], a[28:31], a[180:183], v[52:55]
buffer_load_dwordx4 v226, s[20:23], s57 offen offset:2048 sc1 lds
v_mfma_f32_16x16x32_bf16 v[48:51], a[28:31], a[176:179], v[48:51]
v_mfma_f32_16x16x32_bf16 v[48:51], a[24:27], a[160:163], v[48:51]
s_waitcnt lgkmcnt(4)
v_mfma_f32_16x16x32_bf16 v[64:67], a[0:3], a[160:163], v[64:67]
ds_read_b128 a[24:27], v225 offset:63488
v_mfma_f32_16x16x32_bf16 v[64:67], a[4:7], a[176:179], v[64:67]
buffer_load_dwordx4 v226, s[20:23], s57 offen offset:3072 sc1 lds
v_mfma_f32_16x16x32_bf16 v[68:71], a[4:7], a[180:183], v[68:71]
v_mfma_f32_16x16x32_bf16 v[68:71], a[0:3], a[164:167], v[68:71]
s_barrier
v_mfma_f32_16x16x32_bf16 v[72:75], a[0:3], a[168:171], v[72:75]
ds_read_b128 a[28:31], v225 offset:64512
v_mfma_f32_16x16x32_bf16 v[72:75], a[4:7], a[184:187], v[72:75]
s_add_u32 m0, s36, 98304
v_mfma_f32_16x16x32_bf16 v[76:79], a[4:7], a[188:191], v[76:79]
s_add_u32 s57, s37, 229376
v_mfma_f32_16x16x32_bf16 v[76:79], a[0:3], a[172:175], v[76:79]
s_waitcnt lgkmcnt(4)
v_mfma_f32_16x16x32_bf16 v[92:95], a[8:11], a[172:175], v[92:95]
buffer_load_dwordx4 v226, s[20:23], s57 offen offset:0 sc1 lds
v_mfma_f32_16x16x32_bf16 v[92:95], a[12:15], a[188:191], v[92:95]
ds_read_b128 a[0:3], v224 offset:0
v_mfma_f32_16x16x32_bf16 v[88:91], a[12:15], a[184:187], v[88:91]
v_mfma_f32_16x16x32_bf16 v[88:91], a[8:11], a[168:171], v[88:91]
v_mfma_f32_16x16x32_bf16 v[84:87], a[8:11], a[164:167], v[84:87]
ds_read_b128 a[4:7], v224 offset:1024
v_mfma_f32_16x16x32_bf16 v[84:87], a[12:15], a[180:183], v[84:87]
buffer_load_dwordx4 v226, s[20:23], s57 offen offset:1024 sc1 lds
v_mfma_f32_16x16x32_bf16 v[80:83], a[12:15], a[176:179], v[80:83]
v_mfma_f32_16x16x32_bf16 v[80:83], a[8:11], a[160:163], v[80:83]
s_waitcnt lgkmcnt(4)
v_mfma_f32_16x16x32_bf16 v[96:99], a[16:19], a[160:163], v[96:99]
ds_read_b128 a[8:11], v224 offset:2048
v_mfma_f32_16x16x32_bf16 v[96:99], a[20:23], a[176:179], v[96:99]
buffer_load_dwordx4 v226, s[20:23], s57 offen offset:2048 sc1 lds
v_mfma_f32_16x16x32_bf16 v[100:103], a[20:23], a[180:183], v[100:103]
v_mfma_f32_16x16x32_bf16 v[100:103], a[16:19], a[164:167], v[100:103]
L_ct0:
v_mfma_f32_16x16x32_bf16 v[104:107], a[16:19], a[168:171], v[104:107]
ds_read_b128 a[12:15], v224 offset:3072
v_mfma_f32_16x16x32_bf16 v[104:107], a[20:23], a[184:187], v[104:107]
buffer_load_dwordx4 v226, s[20:23], s57 offen offset:3072 sc1 lds
v_mfma_f32_16x16x32_bf16 v[108:111], a[20:23], a[188:191], v[108:111]
v_mfma_f32_16x16x32_bf16 v[108:111], a[16:19], a[172:175], v[108:111]
s_waitcnt lgkmcnt(4)
v_mfma_f32_16x16x32_bf16 v[124:127], a[24:27], a[172:175], v[124:127]
ds_read_b128 a[16:19], v224 offset:4096
v_mfma_f32_16x16x32_bf16 v[124:127], a[28:31], a[188:191], v[124:127]
v_mfma_f32_16x16x32_bf16 v[120:123], a[28:31], a[184:187], v[120:123]
v_mfma_f32_16x16x32_bf16 v[120:123], a[24:27], a[168:171], v[120:123]
v_mfma_f32_16x16x32_bf16 v[116:119], a[24:27], a[164:167], v[116:119]
ds_read_b128 a[20:23], v224 offset:5120
v_mfma_f32_16x16x32_bf16 v[116:119], a[28:31], a[180:183], v[116:119]
buffer_load_dwordx4 a[96:99], v224, s[20:23], s10 offen offset:2048 sc1
v_mfma_f32_16x16x32_bf16 v[112:115], a[28:31], a[176:179], v[112:115]
v_mfma_f32_16x16x32_bf16 v[112:115], a[24:27], a[160:163], v[112:115]
s_waitcnt lgkmcnt(4)
v_mfma_f32_16x16x32_bf16 v[128:131], a[0:3], a[160:163], v[128:131]
ds_read_b128 a[24:27], v224 offset:6144
v_mfma_f32_16x16x32_bf16 v[128:131], a[4:7], a[176:179], v[128:131]
buffer_load_dwordx4 a[100:103], v224, s[20:23], s11 offen offset:2048 sc1
v_mfma_f32_16x16x32_bf16 v[132:135], a[4:7], a[180:183], v[132:135]
v_mfma_f32_16x16x32_bf16 v[132:135], a[0:3], a[164:167], v[132:135]
v_mfma_f32_16x16x32_bf16 v[136:139], a[0:3], a[168:171], v[136:139]
ds_read_b128 a[28:31], v224 offset:7168
v_mfma_f32_16x16x32_bf16 v[136:139], a[4:7], a[184:187], v[136:139]
buffer_load_dwordx4 a[104:107], v224, s[20:23], s12 offen offset:2048 sc1
v_mfma_f32_16x16x32_bf16 v[140:143], a[4:7], a[188:191], v[140:143]
v_mfma_f32_16x16x32_bf16 v[140:143], a[0:3], a[172:175], v[140:143]
s_waitcnt lgkmcnt(4)
v_mfma_f32_16x16x32_bf16 v[156:159], a[8:11], a[172:175], v[156:159]
ds_read_b128 a[0:3], v224 offset:8192
v_mfma_f32_16x16x32_bf16 v[156:159], a[12:15], a[188:191], v[156:159]
v_mfma_f32_16x16x32_bf16 v[152:155], a[12:15], a[184:187], v[152:155]
v_mfma_f32_16x16x32_bf16 v[152:155], a[8:11], a[168:171], v[152:155]
v_mfma_f32_16x16x32_bf16 v[148:151], a[8:11], a[164:167], v[148:151]
ds_read_b128 a[4:7], v224 offset:9216
v_mfma_f32_16x16x32_bf16 v[148:151], a[12:15], a[180:183], v[148:151]
buffer_load_dwordx4 a[108:111], v224, s[20:23], s13 offen offset:2048 sc1
v_mfma_f32_16x16x32_bf16 v[144:147], a[12:15], a[176:179], v[144:147]
v_mfma_f32_16x16x32_bf16 v[144:147], a[8:11], a[160:163], v[144:147]
s_waitcnt lgkmcnt(4)
v_mfma_f32_16x16x32_bf16 v[160:163], a[16:19], a[160:163], v[160:163]
ds_read_b128 a[8:11], v224 offset:10240
v_mfma_f32_16x16x32_bf16 v[160:163], a[20:23], a[176:179], v[160:163]
buffer_load_dwordx4 a[112:115], v224, s[20:23], s10 offen offset:3072 sc1
v_mfma_f32_16x16x32_bf16 v[164:167], a[20:23], a[180:183], v[164:167]
v_mfma_f32_16x16x32_bf16 v[164:167], a[16:19], a[164:167], v[164:167]
v_mfma_f32_16x16x32_bf16 v[168:171], a[16:19], a[168:171], v[168:171]
ds_read_b128 a[12:15], v224 offset:11264
v_mfma_f32_16x16x32_bf16 v[168:171], a[20:23], a[184:187], v[168:171]
v_mfma_f32_16x16x32_bf16 v[172:175], a[20:23], a[188:191], v[172:175]
v_mfma_f32_16x16x32_bf16 v[172:175], a[16:19], a[172:175], v[172:175]
s_waitcnt lgkmcnt(4)
v_mfma_f32_16x16x32_bf16 v[188:191], a[24:27], a[172:175], v[188:191]
ds_read_b128 a[16:19], v224 offset:12288
v_mfma_f32_16x16x32_bf16 v[188:191], a[28:31], a[188:191], v[188:191]
buffer_load_dwordx4 a[116:119], v224, s[20:23], s11 offen offset:3072 sc1
v_mfma_f32_16x16x32_bf16 v[184:187], a[28:31], a[184:187], v[184:187]
v_mfma_f32_16x16x32_bf16 v[184:187], a[24:27], a[168:171], v[184:187]
v_mfma_f32_16x16x32_bf16 v[180:183], a[24:27], a[164:167], v[180:183]
ds_read_b128 a[20:23], v224 offset:13312
v_mfma_f32_16x16x32_bf16 v[180:183], a[28:31], a[180:183], v[180:183]
buffer_load_dwordx4 a[120:123], v224, s[20:23], s12 offen offset:3072 sc1
v_mfma_f32_16x16x32_bf16 v[176:179], a[28:31], a[176:179], v[176:179]
v_mfma_f32_16x16x32_bf16 v[176:179], a[24:27], a[160:163], v[176:179]
s_waitcnt lgkmcnt(4)
v_mfma_f32_16x16x32_bf16 v[192:195], a[0:3], a[160:163], v[192:195]
ds_read_b128 a[24:27], v224 offset:14336
v_mfma_f32_16x16x32_bf16 v[192:195], a[4:7], a[176:179], v[192:195]
v_mfma_f32_16x16x32_bf16 v[196:199], a[4:7], a[180:183], v[196:199]
v_mfma_f32_16x16x32_bf16 v[196:199], a[0:3], a[164:167], v[196:199]
s_barrier
v_mfma_f32_16x16x32_bf16 v[200:203], a[0:3], a[168:171], v[200:203]
ds_read_b128 a[28:31], v224 offset:15360
v_mfma_f32_16x16x32_bf16 v[200:203], a[4:7], a[184:187], v[200:203]
buffer_load_dwordx4 a[124:127], v224, s[20:23], s13 offen offset:3072 sc1
v_mfma_f32_16x16x32_bf16 v[204:207], a[4:7], a[188:191], v[204:207]
v_mfma_f32_16x16x32_bf16 v[204:207], a[0:3], a[172:175], v[204:207]
s_waitcnt lgkmcnt(4)
v_mfma_f32_16x16x32_bf16 v[220:223], a[8:11], a[172:175], v[220:223]
ds_read_b128 a[0:3], v224 offset:16384
v_mfma_f32_16x16x32_bf16 v[220:223], a[12:15], a[188:191], v[220:223]
s_add_u32 s10, s39, 20480
v_mfma_f32_16x16x32_bf16 v[216:219], a[12:15], a[184:187], v[216:219]
buffer_load_dwordx4 a[128:131], v224, s[20:23], s10 offen offset:0 sc1
v_mfma_f32_16x16x32_bf16 v[216:219], a[8:11], a[168:171], v[216:219]
v_mfma_f32_16x16x32_bf16 v[212:215], a[8:11], a[164:167], v[212:215]
ds_read_b128 a[4:7], v224 offset:17408
v_mfma_f32_16x16x32_bf16 v[212:215], a[12:15], a[180:183], v[212:215]
s_add_u32 s11, s39, 53248
v_mfma_f32_16x16x32_bf16 v[208:211], a[12:15], a[176:179], v[208:211]
buffer_load_dwordx4 a[132:135], v224, s[20:23], s11 offen offset:0 sc1
v_mfma_f32_16x16x32_bf16 v[208:211], a[8:11], a[160:163], v[208:211]
s_waitcnt lgkmcnt(4)
v_mfma_f32_16x16x32_bf16 v[0:3], a[16:19], a[192:195], v[0:3]
ds_read_b128 a[8:11], v224 offset:18432
v_mfma_f32_16x16x32_bf16 v[0:3], a[20:23], a[208:211], v[0:3]
v_mfma_f32_16x16x32_bf16 v[4:7], a[20:23], a[212:215], v[4:7]
v_mfma_f32_16x16x32_bf16 v[4:7], a[16:19], a[196:199], v[4:7]
v_mfma_f32_16x16x32_bf16 v[8:11], a[16:19], a[200:203], v[8:11]
ds_read_b128 a[12:15], v224 offset:19456
v_mfma_f32_16x16x32_bf16 v[8:11], a[20:23], a[216:219], v[8:11]
s_add_u32 s12, s39, 86016
v_mfma_f32_16x16x32_bf16 v[12:15], a[20:23], a[220:223], v[12:15]
buffer_load_dwordx4 a[136:139], v224, s[20:23], s12 offen offset:0 sc1
v_mfma_f32_16x16x32_bf16 v[12:15], a[16:19], a[204:207], v[12:15]
s_waitcnt lgkmcnt(4)
v_mfma_f32_16x16x32_bf16 v[28:31], a[24:27], a[204:207], v[28:31]
ds_read_b128 a[16:19], v224 offset:20480
v_mfma_f32_16x16x32_bf16 v[28:31], a[28:31], a[220:223], v[28:31]
s_add_u32 s13, s39, 118784
v_mfma_f32_16x16x32_bf16 v[24:27], a[28:31], a[216:219], v[24:27]
buffer_load_dwordx4 a[140:143], v224, s[20:23], s13 offen offset:0 sc1
v_mfma_f32_16x16x32_bf16 v[24:27], a[24:27], a[200:203], v[24:27]
v_mfma_f32_16x16x32_bf16 v[20:23], a[24:27], a[196:199], v[20:23]
ds_read_b128 a[20:23], v224 offset:21504
v_mfma_f32_16x16x32_bf16 v[20:23], a[28:31], a[212:215], v[20:23]
v_mfma_f32_16x16x32_bf16 v[16:19], a[28:31], a[208:211], v[16:19]
v_mfma_f32_16x16x32_bf16 v[16:19], a[24:27], a[192:195], v[16:19]
s_waitcnt lgkmcnt(4)
v_mfma_f32_16x16x32_bf16 v[32:35], a[0:3], a[192:195], v[32:35]
ds_read_b128 a[24:27], v224 offset:22528
v_mfma_f32_16x16x32_bf16 v[32:35], a[4:7], a[208:211], v[32:35]
buffer_load_dwordx4 a[144:147], v224, s[20:23], s10 offen offset:1024 sc1
v_mfma_f32_16x16x32_bf16 v[36:39], a[4:7], a[212:215], v[36:39]
v_mfma_f32_16x16x32_bf16 v[36:39], a[0:3], a[196:199], v[36:39]
v_mfma_f32_16x16x32_bf16 v[40:43], a[0:3], a[200:203], v[40:43]
ds_read_b128 a[28:31], v224 offset:23552
v_mfma_f32_16x16x32_bf16 v[40:43], a[4:7], a[216:219], v[40:43]
buffer_load_dwordx4 a[148:151], v224, s[20:23], s11 offen offset:1024 sc1
v_mfma_f32_16x16x32_bf16 v[44:47], a[4:7], a[220:223], v[44:47]
v_mfma_f32_16x16x32_bf16 v[44:47], a[0:3], a[204:207], v[44:47]
s_waitcnt lgkmcnt(4)
v_mfma_f32_16x16x32_bf16 v[60:63], a[8:11], a[204:207], v[60:63]
ds_read_b128 a[0:3], v224 offset:24576
v_mfma_f32_16x16x32_bf16 v[60:63], a[12:15], a[220:223], v[60:63]
v_mfma_f32_16x16x32_bf16 v[56:59], a[12:15], a[216:219], v[56:59]
v_mfma_f32_16x16x32_bf16 v[56:59], a[8:11], a[200:203], v[56:59]
v_mfma_f32_16x16x32_bf16 v[52:55], a[8:11], a[196:199], v[52:55]
ds_read_b128 a[4:7], v224 offset:25600
v_mfma_f32_16x16x32_bf16 v[52:55], a[12:15], a[212:215], v[52:55]
buffer_load_dwordx4 a[152:155], v224, s[20:23], s12 offen offset:1024 sc1
v_mfma_f32_16x16x32_bf16 v[48:51], a[12:15], a[208:211], v[48:51]
v_mfma_f32_16x16x32_bf16 v[48:51], a[8:11], a[192:195], v[48:51]
s_waitcnt lgkmcnt(4)
v_mfma_f32_16x16x32_bf16 v[64:67], a[16:19], a[192:195], v[64:67]
ds_read_b128 a[8:11], v224 offset:26624
v_mfma_f32_16x16x32_bf16 v[64:67], a[20:23], a[208:211], v[64:67]
buffer_load_dwordx4 a[156:159], v224, s[20:23], s13 offen offset:1024 sc1
v_mfma_f32_16x16x32_bf16 v[68:71], a[20:23], a[212:215], v[68:71]
v_mfma_f32_16x16x32_bf16 v[68:71], a[16:19], a[196:199], v[68:71]
v_mfma_f32_16x16x32_bf16 v[72:75], a[16:19], a[200:203], v[72:75]
ds_read_b128 a[12:15], v224 offset:27648
v_mfma_f32_16x16x32_bf16 v[72:75], a[20:23], a[216:219], v[72:75]
buffer_load_dwordx4 a[160:163], v224, s[20:23], s10 offen offset:2048 sc1
v_mfma_f32_16x16x32_bf16 v[76:79], a[20:23], a[220:223], v[76:79]
v_mfma_f32_16x16x32_bf16 v[76:79], a[16:19], a[204:207], v[76:79]
buffer_load_dword v234, v229, s[20:23], s19 offen sc1
s_waitcnt lgkmcnt(4)
v_mfma_f32_16x16x32_bf16 v[92:95], a[24:27], a[204:207], v[92:95]
ds_read_b128 a[16:19], v224 offset:28672
v_mfma_f32_16x16x32_bf16 v[92:95], a[28:31], a[220:223], v[92:95]
v_mfma_f32_16x16x32_bf16 v[88:91], a[28:31], a[216:219], v[88:91]
v_mfma_f32_16x16x32_bf16 v[88:91], a[24:27], a[200:203], v[88:91]
v_mfma_f32_16x16x32_bf16 v[84:87], a[24:27], a[196:199], v[84:87]
ds_read_b128 a[20:23], v224 offset:29696
v_mfma_f32_16x16x32_bf16 v[84:87], a[28:31], a[212:215], v[84:87]
buffer_load_dwordx4 a[164:167], v224, s[20:23], s11 offen offset:2048 sc1
v_mfma_f32_16x16x32_bf16 v[80:83], a[28:31], a[208:211], v[80:83]
v_mfma_f32_16x16x32_bf16 v[80:83], a[24:27], a[192:195], v[80:83]
s_waitcnt lgkmcnt(4)
v_mfma_f32_16x16x32_bf16 v[96:99], a[0:3], a[192:195], v[96:99]
ds_read_b128 a[24:27], v224 offset:30720
v_mfma_f32_16x16x32_bf16 v[96:99], a[4:7], a[208:211], v[96:99]
buffer_load_dwordx4 a[168:171], v224, s[20:23], s12 offen offset:2048 sc1
v_mfma_f32_16x16x32_bf16 v[100:103], a[4:7], a[212:215], v[100:103]
v_mfma_f32_16x16x32_bf16 v[100:103], a[0:3], a[196:199], v[100:103]
s_barrier
v_mfma_f32_16x16x32_bf16 v[104:107], a[0:3], a[200:203], v[104:107]
ds_read_b128 a[28:31], v224 offset:31744
v_mfma_f32_16x16x32_bf16 v[104:107], a[4:7], a[216:219], v[104:107]
v_mfma_f32_16x16x32_bf16 v[108:111], a[4:7], a[220:223], v[108:111]
v_mfma_f32_16x16x32_bf16 v[108:111], a[0:3], a[204:207], v[108:111]
s_waitcnt lgkmcnt(4)
v_mfma_f32_16x16x32_bf16 v[124:127], a[8:11], a[204:207], v[124:127]
ds_read_b128 a[0:3], v224 offset:32768
v_mfma_f32_16x16x32_bf16 v[124:127], a[12:15], a[220:223], v[124:127]
buffer_load_dwordx4 a[172:175], v224, s[20:23], s13 offen offset:2048 sc1
v_mfma_f32_16x16x32_bf16 v[120:123], a[12:15], a[216:219], v[120:123]
v_mfma_f32_16x16x32_bf16 v[120:123], a[8:11], a[200:203], v[120:123]
v_mfma_f32_16x16x32_bf16 v[116:119], a[8:11], a[196:199], v[116:119]
ds_read_b128 a[4:7], v224 offset:33792
v_mfma_f32_16x16x32_bf16 v[116:119], a[12:15], a[212:215], v[116:119]
buffer_load_dwordx4 a[176:179], v224, s[20:23], s10 offen offset:3072 sc1
v_mfma_f32_16x16x32_bf16 v[112:115], a[12:15], a[208:211], v[112:115]
v_mfma_f32_16x16x32_bf16 v[112:115], a[8:11], a[192:195], v[112:115]
s_waitcnt lgkmcnt(4)
v_mfma_f32_16x16x32_bf16 v[128:131], a[16:19], a[192:195], v[128:131]
ds_read_b128 a[8:11], v224 offset:34816
v_mfma_f32_16x16x32_bf16 v[128:131], a[20:23], a[208:211], v[128:131]
v_mfma_f32_16x16x32_bf16 v[132:135], a[20:23], a[212:215], v[132:135]
v_mfma_f32_16x16x32_bf16 v[132:135], a[16:19], a[196:199], v[132:135]
v_mfma_f32_16x16x32_bf16 v[136:139], a[16:19], a[200:203], v[136:139]
ds_read_b128 a[12:15], v224 offset:35840
v_mfma_f32_16x16x32_bf16 v[136:139], a[20:23], a[216:219], v[136:139]
buffer_load_dwordx4 a[180:183], v224, s[20:23], s11 offen offset:3072 sc1
v_mfma_f32_16x16x32_bf16 v[140:143], a[20:23], a[220:223], v[140:143]
v_mfma_f32_16x16x32_bf16 v[140:143], a[16:19], a[204:207], v[140:143]
s_waitcnt lgkmcnt(4)
v_mfma_f32_16x16x32_bf16 v[156:159], a[24:27], a[204:207], v[156:159]
ds_read_b128 a[16:19], v224 offset:36864
v_mfma_f32_16x16x32_bf16 v[156:159], a[28:31], a[220:223], v[156:159]
buffer_load_dwordx4 a[184:187], v224, s[20:23], s12 offen offset:3072 sc1
v_mfma_f32_16x16x32_bf16 v[152:155], a[28:31], a[216:219], v[152:155]
v_mfma_f32_16x16x32_bf16 v[152:155], a[24:27], a[200:203], v[152:155]
v_mfma_f32_16x16x32_bf16 v[148:151], a[24:27], a[196:199], v[148:151]
ds_read_b128 a[20:23], v224 offset:37888
v_mfma_f32_16x16x32_bf16 v[148:151], a[28:31], a[212:215], v[148:151]
buffer_load_dwordx4 a[188:191], v224, s[20:23], s13 offen offset:3072 sc1
v_mfma_f32_16x16x32_bf16 v[144:147], a[28:31], a[208:211], v[144:147]
v_mfma_f32_16x16x32_bf16 v[144:147], a[24:27], a[192:195], v[144:147]
s_waitcnt vmcnt(7)
v_cmp_ne_u32 vcc, v253, v234
s_nop 0
s_or_b32 s14, vcc_lo, vcc_hi
s_and_b32 s14, s14, 0xfffffff
s_cbranch_scc1 L_poll5
L_poll5_ok:
s_waitcnt lgkmcnt(4)
v_mfma_f32_16x16x32_bf16 v[160:163], a[0:3], a[192:195], v[160:163]
ds_read_b128 a[24:27], v224 offset:38912
v_mfma_f32_16x16x32_bf16 v[160:163], a[4:7], a[208:211], v[160:163]
v_mfma_f32_16x16x32_bf16 v[164:167], a[4:7], a[212:215], v[164:167]
v_mfma_f32_16x16x32_bf16 v[164:167], a[0:3], a[196:199], v[164:167]
v_mfma_f32_16x16x32_bf16 v[168:171], a[0:3], a[200:203], v[168:171]
ds_read_b128 a[28:31], v224 offset:39936
v_mfma_f32_16x16x32_bf16 v[168:171], a[4:7], a[216:219], v[168:171]
s_add_u32 m0, s36, 114688
v_mfma_f32_16x16x32_bf16 v[172:175], a[4:7], a[220:223], v[172:175]
s_add_u32 s57, s37, 245760
v_mfma_f32_16x16x32_bf16 v[172:175], a[0:3], a[204:207], v[172:175]
s_waitcnt lgkmcnt(4)
v_mfma_f32_16x16x32_bf16 v[188:191], a[8:11], a[204:207], v[188:191]
buffer_load_dwordx4 v226, s[20:23], s57 offen offset:0 sc1 lds
v_mfma_f32_16x16x32_bf16 v[188:191], a[12:15], a[220:223], v[188:191]
ds_read_b128 a[0:3], v224 offset:40960
v_mfma_f32_16x16x32_bf16 v[184:187], a[12:15], a[216:219], v[184:187]
v_mfma_f32_16x16x32_bf16 v[184:187], a[8:11], a[200:203], v[184:187]
v_mfma_f32_16x16x32_bf16 v[180:183], a[8:11], a[196:199], v[180:183]
ds_read_b128 a[4:7], v224 offset:41984
v_mfma_f32_16x16x32_bf16 v[180:183], a[12:15], a[212:215], v[180:183]
buffer_load_dwordx4 v226, s[20:23], s57 offen offset:1024 sc1 lds
v_mfma_f32_16x16x32_bf16 v[176:179], a[12:15], a[208:211], v[176:179]
v_mfma_f32_16x16x32_bf16 v[176:179], a[8:11], a[192:195], v[176:179]
s_waitcnt lgkmcnt(4)
v_mfma_f32_16x16x32_bf16 v[192:195], a[16:19], a[192:195], v[192:195]
ds_read_b128 a[8:11], v224 offset:43008
v_mfma_f32_16x16x32_bf16 v[192:195], a[20:23], a[208:211], v[192:195]
buffer_load_dwordx4 v226, s[20:23], s57 offen offset:2048 sc1 lds
v_mfma_f32_16x16x32_bf16 v[196:199], a[20:23], a[212:215], v[196:199]
v_mfma_f32_16x16x32_bf16 v[196:199], a[16:19], a[196:199], v[196:199]
v_mfma_f32_16x16x32_bf16 v[200:203], a[16:19], a[200:203], v[200:203]
ds_read_b128 a[12:15], v224 offset:44032
v_mfma_f32_16x16x32_bf16 v[200:203], a[20:23], a[216:219], v[200:203]
buffer_load_dwordx4 v226, s[20:23], s57 offen offset:3072 sc1 lds
v_mfma_f32_16x16x32_bf16 v[204:207], a[20:23], a[220:223], v[204:207]
v_mfma_f32_16x16x32_bf16 v[204:207], a[16:19], a[204:207], v[204:207]
s_waitcnt lgkmcnt(4)
v_mfma_f32_16x16x32_bf16 v[220:223], a[24:27], a[204:207], v[220:223]
ds_read_b128 a[16:19], v224 offset:45056
v_mfma_f32_16x16x32_bf16 v[220:223], a[28:31], a[220:223], v[220:223]
s_add_u32 m0, s36, 0
v_mfma_f32_16x16x32_bf16 v[216:219], a[28:31], a[216:219], v[216:219]
s_add_u32 s57, s37, 262144
v_mfma_f32_16x16x32_bf16 v[216:219], a[24:27], a[200:203], v[216:219]
buffer_load_dwordx4 v226, s[20:23], s57 offen offset:0 sc1 lds
v_mfma_f32_16x16x32_bf16 v[212:215], a[24:27], a[196:199], v[212:215]
ds_read_b128 a[20:23], v224 offset:46080
v_mfma_f32_16x16x32_bf16 v[212:215], a[28:31], a[212:215], v[212:215]
v_mfma_f32_16x16x32_bf16 v[208:211], a[28:31], a[208:211], v[208:211]
v_mfma_f32_16x16x32_bf16 v[208:211], a[24:27], a[192:195], v[208:211]
s_waitcnt lgkmcnt(4)
v_mfma_f32_16x16x32_bf16 v[0:3], a[0:3], a[224:227], v[0:3]
ds_read_b128 a[24:27], v224 offset:47104
v_mfma_f32_16x16x32_bf16 v[0:3], a[4:7], a[240:243], v[0:3]
buffer_load_dwordx4 v226, s[20:23], s57 offen offset:1024 sc1 lds
v_mfma_f32_16x16x32_bf16 v[4:7], a[4:7], a[244:247], v[4:7]
v_mfma_f32_16x16x32_bf16 v[4:7], a[0:3], a[228:231], v[4:7]
s_barrier
v_mfma_f32_16x16x32_bf16 v[8:11], a[0:3], a[232:235], v[8:11]
ds_read_b128 a[28:31], v224 offset:48128
v_mfma_f32_16x16x32_bf16 v[8:11], a[4:7], a[248:251], v[8:11]
buffer_load_dwordx4 v226, s[20:23], s57 offen offset:2048 sc1 lds
v_mfma_f32_16x16x32_bf16 v[12:15], a[4:7], a[252:255], v[12:15]
v_mfma_f32_16x16x32_bf16 v[12:15], a[0:3], a[236:239], v[12:15]
s_waitcnt lgkmcnt(4)
v_mfma_f32_16x16x32_bf16 v[28:31], a[8:11], a[236:239], v[28:31]
ds_read_b128 a[0:3], v224 offset:49152
v_mfma_f32_16x16x32_bf16 v[28:31], a[12:15], a[252:255], v[28:31]
buffer_load_dwordx4 v226, s[20:23], s57 offen offset:3072 sc1 lds
v_mfma_f32_16x16x32_bf16 v[24:27], a[12:15], a[248:251], v[24:27]
v_mfma_f32_16x16x32_bf16 v[24:27], a[8:11], a[232:235], v[24:27]
v_mfma_f32_16x16x32_bf16 v[20:23], a[8:11], a[228:231], v[20:23]
ds_read_b128 a[4:7], v224 offset:50176
v_mfma_f32_16x16x32_bf16 v[20:23], a[12:15], a[244:247], v[20:23]
s_add_u32 s10, s39, 24576
v_mfma_f32_16x16x32_bf16 v[16:19], a[12:15], a[240:243], v[16:19]
buffer_load_dwordx4 a[192:195], v224, s[20:23], s10 offen offset:0 sc1
v_mfma_f32_16x16x32_bf16 v[16:19], a[8:11], a[224:227], v[16:19]
s_waitcnt lgkmcnt(4)
v_mfma_f32_16x16x32_bf16 v[32:35], a[16:19], a[224:227], v[32:35]
ds_read_b128 a[8:11], v224 offset:51200
v_mfma_f32_16x16x32_bf16 v[32:35], a[20:23], a[240:243], v[32:35]
v_mfma_f32_16x16x32_bf16 v[36:39], a[20:23], a[244:247], v[36:39]
v_mfma_f32_16x16x32_bf16 v[36:39], a[16:19], a[228:231], v[36:39]
v_mfma_f32_16x16x32_bf16 v[40:43], a[16:19], a[232:235], v[40:43]
ds_read_b128 a[12:15], v224 offset:52224
v_mfma_f32_16x16x32_bf16 v[40:43], a[20:23], a[248:251], v[40:43]
s_add_u32 s11, s39, 57344
v_mfma_f32_16x16x32_bf16 v[44:47], a[20:23], a[252:255], v[44:47]
buffer_load_dwordx4 a[196:199], v224, s[20:23], s11 offen offset:0 sc1
v_mfma_f32_16x16x32_bf16 v[44:47], a[16:19], a[236:239], v[44:47]
s_waitcnt lgkmcnt(4)
v_mfma_f32_16x16x32_bf16 v[60:63], a[24:27], a[236:239], v[60:63]
ds_read_b128 a[16:19], v224 offset:53248
v_mfma_f32_16x16x32_bf16 v[60:63], a[28:31], a[252:255], v[60:63]
s_add_u32 s12, s39, 90112
v_mfma_f32_16x16x32_bf16 v[56:59], a[28:31], a[248:251], v[56:59]
buffer_load_dwordx4 a[200:203], v224, s[20:23], s12 offen offset:0 sc1
v_mfma_f32_16x16x32_bf16 v[56:59], a[24:27], a[232:235], v[56:59]
v_mfma_f32_16x16x32_bf16 v[52:55], a[24:27], a[228:231], v[52:55]
ds_read_b128 a[20:23], v224 offset:54272
v_mfma_f32_16x16x32_bf16 v[52:55], a[28:31], a[244:247], v[52:55]
s_add_u32 s13, s39, 122880
v_mfma_f32_16x16x32_bf16 v[48:51], a[28:31], a[240:243], v[48:51]
buffer_load_dwordx4 a[204:207], v224, s[20:23], s13 offen offset:0 sc1
v_mfma_f32_16x16x32_bf16 v[48:51], a[24:27], a[224:227], v[48:51]
s_waitcnt lgkmcnt(4)
v_mfma_f32_16x16x32_bf16 v[64:67], a[0:3], a[224:227], v[64:67]
ds_read_b128 a[24:27], v224 offset:55296
v_mfma_f32_16x16x32_bf16 v[64:67], a[4:7], a[240:243], v[64:67]
buffer_load_dwordx4 a[208:211], v224, s[20:23], s10 offen offset:1024 sc1
v_mfma_f32_16x16x32_bf16 v[68:71], a[4:7], a[244:247], v[68:71]
v_mfma_f32_16x16x32_bf16 v[68:71], a[0:3], a[228:231], v[68:71]
v_mfma_f32_16x16x32_bf16 v[72:75], a[0:3], a[232:235], v[72:75]
ds_read_b128 a[28:31], v224 offset:56320
v_mfma_f32_16x16x32_bf16 v[72:75], a[4:7], a[248:251], v[72:75]
v_mfma_f32_16x16x32_bf16 v[76:79], a[4:7], a[252:255], v[76:79]
v_mfma_f32_16x16x32_bf16 v[76:79], a[0:3], a[236:239], v[76:79]
s_waitcnt lgkmcnt(4)
v_mfma_f32_16x16x32_bf16 v[92:95], a[8:11], a[236:239], v[92:95]
ds_read_b128 a[0:3], v224 offset:57344
v_mfma_f32_16x16x32_bf16 v[92:95], a[12:15], a[252:255], v[92:95]
buffer_load_dwordx4 a[212:215], v224, s[20:23], s11 offen offset:1024 sc1
v_mfma_f32_16x16x32_bf16 v[88:91], a[12:15], a[248:251], v[88:91]
v_mfma_f32_16x16x32_bf16 v[88:91], a[8:11], a[232:235], v[88:91]
v_mfma_f32_16x16x32_bf16 v[84:87], a[8:11], a[228:231], v[84:87]
ds_read_b128 a[4:7], v224 offset:58368
v_mfma_f32_16x16x32_bf16 v[84:87], a[12:15], a[244:247], v[84:87]
buffer_load_dwordx4 a[216:219], v224, s[20:23], s12 offen offset:1024 sc1
v_mfma_f32_16x16x32_bf16 v[80:83], a[12:15], a[240:243], v[80:83]
v_mfma_f32_16x16x32_bf16 v[80:83], a[8:11], a[224:227], v[80:83]
s_waitcnt lgkmcnt(4)
v_mfma_f32_16x16x32_bf16 v[96:99], a[16:19], a[224:227], v[96:99]
ds_read_b128 a[8:11], v224 offset:59392
v_mfma_f32_16x16x32_bf16 v[96:99], a[20:23], a[240:243], v[96:99]
s_add_u32 m0, s36, 16384
v_mfma_f32_16x16x32_bf16 v[100:103], a[20:23], a[244:247], v[100:103]
s_add_u32 s57, s53, 0
v_mfma_f32_16x16x32_bf16 v[100:103], a[16:19], a[228:231], v[100:103]
buffer_load_dwordx4 v231, s[24:27], s57 offen nt lds
v_mfma_f32_16x16x32_bf16 v[104:107], a[16:19], a[232:235], v[104:107]
ds_read_b128 a[12:15], v224 offset:60416
s_add_u32 m0, s36, 17408
v_mfma_f32_16x16x32_bf16 v[104:107], a[20:23], a[248:251], v[104:107]
s_add_u32 s57, s53, 8192
v_mfma_f32_16x16x32_bf16 v[108:111], a[20:23], a[252:255], v[108:111]
buffer_load_dwordx4 v231, s[24:27], s57 offen nt lds
v_mfma_f32_16x16x32_bf16 v[108:111], a[16:19], a[236:239], v[108:111]
v_lshlrev_b32 v252, 3, v224
s_waitcnt lgkmcnt(4)
v_mfma_f32_16x16x32_bf16 v[124:127], a[24:27], a[236:239], v[124:127]
s_mov_b32 s58, L_ct1-L_body
v_mfma_f32_16x16x32_bf16 v[124:127], a[28:31], a[252:255], v[124:127]
buffer_load_dword v252, v252, s[80:83], s58 offen
v_mfma_f32_16x16x32_bf16 v[120:123], a[28:31], a[248:251], v[120:123]
ds_read_b128 a[16:19], v224 offset:61440
v_mfma_f32_16x16x32_bf16 v[120:123], a[24:27], a[232:235], v[120:123]
v_mfma_f32_16x16x32_bf16 v[116:119], a[24:27], a[228:231], v[116:119]
ds_read_b128 a[20:23], v224 offset:62464
v_mfma_f32_16x16x32_bf16 v[116:119], a[28:31], a[244:247], v[116:119]
s_add_u32 m0, s36, 18432
v_mfma_f32_16x16x32_bf16 v[112:115], a[28:31], a[240:243], v[112:115]
s_add_u32 s57, s53, 16384
v_mfma_f32_16x16x32_bf16 v[112:115], a[24:27], a[224:227], v[112:115]
s_waitcnt lgkmcnt(4)
v_mfma_f32_16x16x32_bf16 v[128:131], a[0:3], a[224:227], v[128:131]
buffer_load_dwordx4 v231, s[24:27], s57 offen nt lds
v_mfma_f32_16x16x32_bf16 v[128:131], a[4:7], a[240:243], v[128:131]
ds_read_b128 a[24:27], v224 offset:63488
v_mfma_f32_16x16x32_bf16 v[132:135], a[4:7], a[244:247], v[132:135]
s_add_u32 m0, s36, 19456
v_mfma_f32_16x16x32_bf16 v[132:135], a[0:3], a[228:231], v[132:135]
s_add_u32 s57, s53, 24576
s_barrier
v_mfma_f32_16x16x32_bf16 v[136:139], a[0:3], a[232:235], v[136:139]
buffer_load_dwordx4 v231, s[24:27], s57 offen nt lds
v_mfma_f32_16x16x32_bf16 v[136:139], a[4:7], a[248:251], v[136:139]
ds_read_b128 a[28:31], v224 offset:64512
v_mfma_f32_16x16x32_bf16 v[140:143], a[4:7], a[252:255], v[140:143]
buffer_load_dwordx4 a[220:223], v224, s[20:23], s13 offen offset:1024 sc1
v_mfma_f32_16x16x32_bf16 v[140:143], a[0:3], a[236:239], v[140:143]
s_waitcnt lgkmcnt(4)
v_mfma_f32_16x16x32_bf16 v[156:159], a[8:11], a[236:239], v[156:159]
ds_read_b128 a[0:3], v225 offset:0
v_mfma_f32_16x16x32_bf16 v[156:159], a[12:15], a[252:255], v[156:159]
s_add_u32 m0, s36, 32768
v_mfma_f32_16x16x32_bf16 v[152:155], a[12:15], a[248:251], v[152:155]
s_add_u32 s57, s54, 0
v_mfma_f32_16x16x32_bf16 v[152:155], a[8:11], a[232:235], v[152:155]
buffer_load_dwordx4 v231, s[24:27], s57 offen nt lds
v_mfma_f32_16x16x32_bf16 v[148:151], a[8:11], a[228:231], v[148:151]
ds_read_b128 a[4:7], v225 offset:1024
v_mfma_f32_16x16x32_bf16 v[148:151], a[12:15], a[244:247], v[148:151]
v_mfma_f32_16x16x32_bf16 v[144:147], a[12:15], a[240:243], v[144:147]
v_mfma_f32_16x16x32_bf16 v[144:147], a[8:11], a[224:227], v[144:147]
s_waitcnt lgkmcnt(4)
v_mfma_f32_16x16x32_bf16 v[160:163], a[16:19], a[224:227], v[160:163]
ds_read_b128 a[8:11], v225 offset:2048
v_mfma_f32_16x16x32_bf16 v[160:163], a[20:23], a[240:243], v[160:163]
s_add_u32 m0, s36, 33792
v_mfma_f32_16x16x32_bf16 v[164:167], a[20:23], a[244:247], v[164:167]
s_add_u32 s57, s54, 8192
v_mfma_f32_16x16x32_bf16 v[164:167], a[16:19], a[228:231], v[164:167]
buffer_load_dwordx4 v231, s[24:27], s57 offen nt lds
v_mfma_f32_16x16x32_bf16 v[168:171], a[16:19], a[232:235], v[168:171]
ds_read_b128 a[12:15], v225 offset:3072
v_mfma_f32_16x16x32_bf16 v[168:171], a[20:23], a[248:251], v[168:171]
s_add_u32 m0, s36, 34816
v_mfma_f32_16x16x32_bf16 v[172:175], a[20:23], a[252:255], v[172:175]
s_add_u32 s57, s54, 16384
v_mfma_f32_16x16x32_bf16 v[172:175], a[16:19], a[236:239], v[172:175]
s_waitcnt lgkmcnt(4)
v_mfma_f32_16x16x32_bf16 v[188:191], a[24:27], a[236:239], v[188:191]
buffer_load_dwordx4 v231, s[24:27], s57 offen nt lds
v_mfma_f32_16x16x32_bf16 v[188:191], a[28:31], a[252:255], v[188:191]
ds_read_b128 a[16:19], v225 offset:4096
v_mfma_f32_16x16x32_bf16 v[184:187], a[28:31], a[248:251], v[184:187]
s_add_u32 m0, s36, 35840
v_mfma_f32_16x16x32_bf16 v[184:187], a[24:27], a[232:235], v[184:187]
s_add_u32 s57, s54, 24576
v_mfma_f32_16x16x32_bf16 v[180:183], a[24:27], a[228:231], v[180:183]
buffer_load_dwordx4 v231, s[24:27], s57 offen nt lds
v_mfma_f32_16x16x32_bf16 v[180:183], a[28:31], a[244:247], v[180:183]
ds_read_b128 a[20:23], v225 offset:5120
v_mfma_f32_16x16x32_bf16 v[176:179], a[28:31], a[240:243], v[176:179]
v_mfma_f32_16x16x32_bf16 v[176:179], a[24:27], a[224:227], v[176:179]
s_waitcnt lgkmcnt(4)
v_mfma_f32_16x16x32_bf16 v[192:195], a[0:3], a[224:227], v[192:195]
ds_read_b128 a[24:27], v225 offset:6144
v_mfma_f32_16x16x32_bf16 v[192:195], a[4:7], a[240:243], v[192:195]
v_mfma_f32_16x16x32_bf16 v[196:199], a[4:7], a[244:247], v[196:199]
v_mfma_f32_16x16x32_bf16 v[196:199], a[0:3], a[228:231], v[196:199]
v_mfma_f32_16x16x32_bf16 v[200:203], a[0:3], a[232:235], v[200:203]
ds_read_b128 a[28:31], v225 offset:7168
v_mfma_f32_16x16x32_bf16 v[200:203], a[4:7], a[248:251], v[200:203]
v_mfma_f32_16x16x32_bf16 v[204:207], a[4:7], a[252:255], v[204:207]
v_mfma_f32_16x16x32_bf16 v[204:207], a[0:3], a[236:239], v[204:207]
s_waitcnt lgkmcnt(4)
v_mfma_f32_16x16x32_bf16 v[220:223], a[8:11], a[236:239], v[220:223]
ds_read_b128 a[0:3], v225 offset:8192
v_mfma_f32_16x16x32_bf16 v[220:223], a[12:15], a[252:255], v[220:223]
v_mfma_f32_16x16x32_bf16 v[216:219], a[12:15], a[248:251], v[216:219]
v_mfma_f32_16x16x32_bf16 v[216:219], a[8:11], a[232:235], v[216:219]
v_mfma_f32_16x16x32_bf16 v[212:215], a[8:11], a[228:231], v[212:215]
ds_read_b128 a[4:7], v225 offset:9216
v_mfma_f32_16x16x32_bf16 v[212:215], a[12:15], a[244:247], v[212:215]
v_mfma_f32_16x16x32_bf16 v[208:211], a[12:15], a[240:243], v[208:211]
v_mfma_f32_16x16x32_bf16 v[208:211], a[8:11], a[224:227], v[208:211]
s_waitcnt lgkmcnt(4)
v_mfma_f32_16x16x32_bf16 v[0:3], a[16:19], a[32:35], v[0:3]
ds_read_b128 a[8:11], v225 offset:10240
v_mfma_f32_16x16x32_bf16 v[0:3], a[20:23], a[48:51], v[0:3]
buffer_load_dwordx4 a[224:227], v224, s[20:23], s10 offen offset:2048 sc1
v_mfma_f32_16x16x32_bf16 v[4:7], a[20:23], a[52:55], v[4:7]
v_mfma_f32_16x16x32_bf16 v[4:7], a[16:19], a[36:39], v[4:7]
v_mfma_f32_16x16x32_bf16 v[8:11], a[16:19], a[40:43], v[8:11]
ds_read_b128 a[12:15], v225 offset:11264
v_mfma_f32_16x16x32_bf16 v[8:11], a[20:23], a[56:59], v[8:11]
v_mfma_f32_16x16x32_bf16 v[12:15], a[20:23], a[60:63], v[12:15]
v_mfma_f32_16x16x32_bf16 v[12:15], a[16:19], a[44:47], v[12:15]
s_waitcnt lgkmcnt(4)
v_mfma_f32_16x16x32_bf16 v[28:31], a[24:27], a[44:47], v[28:31]
ds_read_b128 a[16:19], v225 offset:12288
v_mfma_f32_16x16x32_bf16 v[28:31], a[28:31], a[60:63], v[28:31]
buffer_load_dwordx4 a[228:231], v224, s[20:23], s11 offen offset:2048 sc1
v_mfma_f32_16x16x32_bf16 v[24:27], a[28:31], a[56:59], v[24:27]
v_mfma_f32_16x16x32_bf16 v[24:27], a[24:27], a[40:43], v[24:27]
v_mfma_f32_16x16x32_bf16 v[20:23], a[24:27], a[36:39], v[20:23]
ds_read_b128 a[20:23], v225 offset:13312
v_mfma_f32_16x16x32_bf16 v[20:23], a[28:31], a[52:55], v[20:23]
buffer_load_dwordx4 a[232:235], v224, s[20:23], s12 offen offset:2048 sc1
v_mfma_f32_16x16x32_bf16 v[16:19], a[28:31], a[48:51], v[16:19]
v_mfma_f32_16x16x32_bf16 v[16:19], a[24:27], a[32:35], v[16:19]
s_waitcnt lgkmcnt(4)
v_mfma_f32_16x16x32_bf16 v[32:35], a[0:3], a[32:35], v[32:35]
ds_read_b128 a[24:27], v225 offset:14336
v_mfma_f32_16x16x32_bf16 v[32:35], a[4:7], a[48:51], v[32:35]
buffer_load_dwordx4 a[236:239], v224, s[20:23], s13 offen offset:2048 sc1
v_mfma_f32_16x16x32_bf16 v[36:39], a[4:7], a[52:55], v[36:39]
v_mfma_f32_16x16x32_bf16 v[36:39], a[0:3], a[36:39], v[36:39]
s_barrier
v_mfma_f32_16x16x32_bf16 v[40:43], a[0:3], a[40:43], v[40:43]
ds_read_b128 a[28:31], v225 offset:15360
v_mfma_f32_16x16x32_bf16 v[40:43], a[4:7], a[56:59], v[40:43]
buffer_load_dwordx4 a[240:243], v224, s[20:23], s10 offen offset:3072 sc1
v_mfma_f32_16x16x32_bf16 v[44:47], a[4:7], a[60:63], v[44:47]
v_mfma_f32_16x16x32_bf16 v[44:47], a[0:3], a[44:47], v[44:47]
s_waitcnt lgkmcnt(4)
v_mfma_f32_16x16x32_bf16 v[60:63], a[8:11], a[44:47], v[60:63]
ds_read_b128 a[0:3], v225 offset:16384
v_mfma_f32_16x16x32_bf16 v[60:63], a[12:15], a[60:63], v[60:63]
v_mfma_f32_16x16x32_bf16 v[56:59], a[12:15], a[56:59], v[56:59]
v_mfma_f32_16x16x32_bf16 v[56:59], a[8:11], a[40:43], v[56:59]
v_mfma_f32_16x16x32_bf16 v[52:55], a[8:11], a[36:39], v[52:55]
ds_read_b128 a[4:7], v225 offset:17408
v_mfma_f32_16x16x32_bf16 v[52:55], a[12:15], a[52:55], v[52:55]
buffer_load_dwordx4 a[244:247], v224, s[20:23], s11 offen offset:3072 sc1
v_mfma_f32_16x16x32_bf16 v[48:51], a[12:15], a[48:51], v[48:51]
v_mfma_f32_16x16x32_bf16 v[48:51], a[8:11], a[32:35], v[48:51]
s_waitcnt lgkmcnt(4)
v_mfma_f32_16x16x32_bf16 v[64:67], a[16:19], a[32:35], v[64:67]
ds_read_b128 a[8:11], v225 offset:18432
v_mfma_f32_16x16x32_bf16 v[64:67], a[20:23], a[48:51], v[64:67]
buffer_load_dwordx4 a[248:251], v224, s[20:23], s12 offen offset:3072 sc1
v_mfma_f32_16x16x32_bf16 v[68:71], a[20:23], a[52:55], v[68:71]
v_mfma_f32_16x16x32_bf16 v[68:71], a[16:19], a[36:39], v[68:71]
v_mfma_f32_16x16x32_bf16 v[72:75], a[16:19], a[40:43], v[72:75]
ds_read_b128 a[12:15], v225 offset:19456
v_mfma_f32_16x16x32_bf16 v[72:75], a[20:23], a[56:59], v[72:75]
buffer_load_dwordx4 a[252:255], v224, s[20:23], s13 offen offset:3072 sc1
v_mfma_f32_16x16x32_bf16 v[76:79], a[20:23], a[60:63], v[76:79]
v_mfma_f32_16x16x32_bf16 v[76:79], a[16:19], a[44:47], v[76:79]
s_waitcnt lgkmcnt(4)
v_mfma_f32_16x16x32_bf16 v[92:95], a[24:27], a[44:47], v[92:95]
ds_read_b128 a[16:19], v225 offset:20480
v_mfma_f32_16x16x32_bf16 v[92:95], a[28:31], a[60:63], v[92:95]
s_add_u32 m0, s36, 49152
v_mfma_f32_16x16x32_bf16 v[88:91], a[28:31], a[56:59], v[88:91]
s_add_u32 s57, s37, 278528
v_mfma_f32_16x16x32_bf16 v[88:91], a[24:27], a[40:43], v[88:91]
buffer_load_dwordx4 v226, s[20:23], s57 offen offset:0 sc1 lds
v_mfma_f32_16x16x32_bf16 v[84:87], a[24:27], a[36:39], v[84:87]
ds_read_b128 a[20:23], v225 offset:21504
v_mfma_f32_16x16x32_bf16 v[84:87], a[28:31], a[52:55], v[84:87]
v_mfma_f32_16x16x32_bf16 v[80:83], a[28:31], a[48:51], v[80:83]
v_mfma_f32_16x16x32_bf16 v[80:83], a[24:27], a[32:35], v[80:83]
s_waitcnt lgkmcnt(4)
v_mfma_f32_16x16x32_bf16 v[96:99], a[0:3], a[32:35], v[96:99]
ds_read_b128 a[24:27], v225 offset:22528
v_mfma_f32_16x16x32_bf16 v[96:99], a[4:7], a[48:51], v[96:99]
buffer_load_dwordx4 v226, s[20:23], s57 offen offset:1024 sc1 lds
v_mfma_f32_16x16x32_bf16 v[100:103], a[4:7], a[52:55], v[100:103]
v_mfma_f32_16x16x32_bf16 v[100:103], a[0:3], a[36:39], v[100:103]
v_mfma_f32_16x16x32_bf16 v[104:107], a[0:3], a[40:43], v[104:107]
ds_read_b128 a[28:31], v225 offset:23552
v_mfma_f32_16x16x32_bf16 v[104:107], a[4:7], a[56:59], v[104:107]
buffer_load_dwordx4 v226, s[20:23], s57 offen offset:2048 sc1 lds
v_mfma_f32_16x16x32_bf16 v[108:111], a[4:7], a[60:63], v[108:111]
v_mfma_f32_16x16x32_bf16 v[108:111], a[0:3], a[44:47], v[108:111]
s_waitcnt lgkmcnt(4)
v_mfma_f32_16x16x32_bf16 v[124:127], a[8:11], a[44:47], v[124:127]
ds_read_b128 a[0:3], v225 offset:24576
v_mfma_f32_16x16x32_bf16 v[124:127], a[12:15], a[60:63], v[124:127]
buffer_load_dwordx4 v226, s[20:23], s57 offen offset:3072 sc1 lds
v_mfma_f32_16x16x32_bf16 v[120:123], a[12:15], a[56:59], v[120:123]
v_mfma_f32_16x16x32_bf16 v[120:123], a[8:11], a[40:43], v[120:123]
v_mfma_f32_16x16x32_bf16 v[116:119], a[8:11], a[36:39], v[116:119]
ds_read_b128 a[4:7], v225 offset:25600
v_mfma_f32_16x16x32_bf16 v[116:119], a[12:15], a[52:55], v[116:119]
v_mfma_f32_16x16x32_bf16 v[112:115], a[12:15], a[48:51], v[112:115]
v_mfma_f32_16x16x32_bf16 v[112:115], a[8:11], a[32:35], v[112:115]
s_waitcnt lgkmcnt(4)
v_mfma_f32_16x16x32_bf16 v[128:131], a[16:19], a[32:35], v[128:131]
ds_read_b128 a[8:11], v225 offset:26624
v_mfma_f32_16x16x32_bf16 v[128:131], a[20:23], a[48:51], v[128:131]
v_mfma_f32_16x16x32_bf16 v[132:135], a[20:23], a[52:55], v[132:135]
v_mfma_f32_16x16x32_bf16 v[132:135], a[16:19], a[36:39], v[132:135]
v_mfma_f32_16x16x32_bf16 v[136:139], a[16:19], a[40:43], v[136:139]
ds_read_b128 a[12:15], v225 offset:27648
v_mfma_f32_16x16x32_bf16 v[136:139], a[20:23], a[56:59], v[136:139]
v_mfma_f32_16x16x32_bf16 v[140:143], a[20:23], a[60:63], v[140:143]
v_mfma_f32_16x16x32_bf16 v[140:143], a[16:19], a[44:47], v[140:143]
s_waitcnt lgkmcnt(4)
v_mfma_f32_16x16x32_bf16 v[156:159], a[24:27], a[44:47], v[156:159]
ds_read_b128 a[16:19], v225 offset:28672
v_mfma_f32_16x16x32_bf16 v[156:159], a[28:31], a[60:63], v[156:159]
v_mfma_f32_16x16x32_bf16 v[152:155], a[28:31], a[56:59], v[152:155]
v_mfma_f32_16x16x32_bf16 v[152:155], a[24:27], a[40:43], v[152:155]
v_mfma_f32_16x16x32_bf16 v[148:151], a[24:27], a[36:39], v[148:151]
ds_read_b128 a[20:23], v225 offset:29696
v_mfma_f32_16x16x32_bf16 v[148:151], a[28:31], a[52:55], v[148:151]
v_mfma_f32_16x16x32_bf16 v[144:147], a[28:31], a[48:51], v[144:147]
v_mfma_f32_16x16x32_bf16 v[144:147], a[24:27], a[32:35], v[144:147]
s_waitcnt lgkmcnt(4)
v_mfma_f32_16x16x32_bf16 v[160:163], a[0:3], a[32:35], v[160:163]
ds_read_b128 a[24:27], v225 offset:30720
v_mfma_f32_16x16x32_bf16 v[160:163], a[4:7], a[48:51], v[160:163]
v_mfma_f32_16x16x32_bf16 v[164:167], a[4:7], a[52:55], v[164:167]
v_mfma_f32_16x16x32_bf16 v[164:167], a[0:3], a[36:39], v[164:167]
s_barrier
v_mfma_f32_16x16x32_bf16 v[168:171], a[0:3], a[40:43], v[168:171]
ds_read_b128 a[28:31], v225 offset:31744
v_mfma_f32_16x16x32_bf16 v[168:171], a[4:7], a[56:59], v[168:171]
s_add_u32 m0, s36, 65536
v_mfma_f32_16x16x32_bf16 v[172:175], a[4:7], a[60:63], v[172:175]
s_add_u32 s57, s37, 294912
v_mfma_f32_16x16x32_bf16 v[172:175], a[0:3], a[44:47], v[172:175]
s_waitcnt lgkmcnt(4)
v_mfma_f32_16x16x32_bf16 v[188:191], a[8:11], a[44:47], v[188:191]
buffer_load_dwordx4 v226, s[20:23], s57 offen offset:0 sc1 lds
v_mfma_f32_16x16x32_bf16 v[188:191], a[12:15], a[60:63], v[188:191]
ds_read_b128 a[0:3], v225 offset:32768
v_mfma_f32_16x16x32_bf16 v[184:187], a[12:15], a[56:59], v[184:187]
v_mfma_f32_16x16x32_bf16 v[184:187], a[8:11], a[40:43], v[184:187]
v_mfma_f32_16x16x32_bf16 v[180:183], a[8:11], a[36:39], v[180:183]
ds_read_b128 a[4:7], v225 offset:33792
v_mfma_f32_16x16x32_bf16 v[180:183], a[12:15], a[52:55], v[180:183]
buffer_load_dwordx4 v226, s[20:23], s57 offen offset:1024 sc1 lds
v_mfma_f32_16x16x32_bf16 v[176:179], a[12:15], a[48:51], v[176:179]
v_mfma_f32_16x16x32_bf16 v[176:179], a[8:11], a[32:35], v[176:179]
s_waitcnt lgkmcnt(4)
v_mfma_f32_16x16x32_bf16 v[192:195], a[16:19], a[32:35], v[192:195]
ds_read_b128 a[8:11], v225 offset:34816
v_mfma_f32_16x16x32_bf16 v[192:195], a[20:23], a[48:51], v[192:195]
buffer_load_dwordx4 v226, s[20:23], s57 offen offset:2048 sc1 lds
v_mfma_f32_16x16x32_bf16 v[196:199], a[20:23], a[52:55], v[196:199]
v_mfma_f32_16x16x32_bf16 v[196:199], a[16:19], a[36:39], v[196:199]
v_mfma_f32_16x16x32_bf16 v[200:203], a[16:19], a[40:43], v[200:203]
ds_read_b128 a[12:15], v225 offset:35840
v_mfma_f32_16x16x32_bf16 v[200:203], a[20:23], a[56:59], v[200:203]
buffer_load_dwordx4 v226, s[20:23], s57 offen offset:3072 sc1 lds
v_mfma_f32_16x16x32_bf16 v[204:207], a[20:23], a[60:63], v[204:207]
v_mfma_f32_16x16x32_bf16 v[204:207], a[16:19], a[44:47], v[204:207]
s_waitcnt lgkmcnt(4)
v_mfma_f32_16x16x32_bf16 v[220:223], a[24:27], a[44:47], v[220:223]
ds_read_b128 a[16:19], v225 offset:36864
v_mfma_f32_16x16x32_bf16 v[220:223], a[28:31], a[60:63], v[220:223]
v_mfma_f32_16x16x32_bf16 v[216:219], a[28:31], a[56:59], v[216:219]
v_mfma_f32_16x16x32_bf16 v[216:219], a[24:27], a[40:43], v[216:219]
v_mfma_f32_16x16x32_bf16 v[212:215], a[24:27], a[36:39], v[212:215]
ds_read_b128 a[20:23], v225 offset:37888
v_mfma_f32_16x16x32_bf16 v[212:215], a[28:31], a[52:55], v[212:215]
v_mfma_f32_16x16x32_bf16 v[208:211], a[28:31], a[48:51], v[208:211]
v_mfma_f32_16x16x32_bf16 v[208:211], a[24:27], a[32:35], v[208:211]
s_waitcnt lgkmcnt(4)
v_mfma_f32_16x16x32_bf16 v[0:3], a[0:3], a[64:67], v[0:3]
ds_read_b128 a[24:27], v225 offset:38912
v_mfma_f32_16x16x32_bf16 v[0:3], a[4:7], a[80:83], v[0:3]
s_add_u32 s10, s39, 28672
v_mfma_f32_16x16x32_bf16 v[4:7], a[4:7], a[84:87], v[4:7]
buffer_load_dwordx4 a[32:35], v224, s[20:23], s10 offen offset:0 sc1
v_mfma_f32_16x16x32_bf16 v[4:7], a[0:3], a[68:71], v[4:7]
v_mfma_f32_16x16x32_bf16 v[8:11], a[0:3], a[72:75], v[8:11]
ds_read_b128 a[28:31], v225 offset:39936
v_mfma_f32_16x16x32_bf16 v[8:11], a[4:7], a[88:91], v[8:11]
v_mfma_f32_16x16x32_bf16 v[12:15], a[4:7], a[92:95], v[12:15]
v_mfma_f32_16x16x32_bf16 v[12:15], a[0:3], a[76:79], v[12:15]
s_waitcnt lgkmcnt(4)
v_mfma_f32_16x16x32_bf16 v[28:31], a[8:11], a[76:79], v[28:31]
ds_read_b128 a[0:3], v225 offset:40960
v_mfma_f32_16x16x32_bf16 v[28:31], a[12:15], a[92:95], v[28:31]
s_add_u32 s11, s39, 61440
v_mfma_f32_16x16x32_bf16 v[24:27], a[12:15], a[88:91], v[24:27]
buffer_load_dwordx4 a[36:39], v224, s[20:23], s11 offen offset:0 sc1
v_mfma_f32_16x16x32_bf16 v[24:27], a[8:11], a[72:75], v[24:27]
v_mfma_f32_16x16x32_bf16 v[20:23], a[8:11], a[68:71], v[20:23]
ds_read_b128 a[4:7], v225 offset:41984
v_mfma_f32_16x16x32_bf16 v[20:23], a[12:15], a[84:87], v[20:23]
s_add_u32 s12, s39, 94208
v_mfma_f32_16x16x32_bf16 v[16:19], a[12:15], a[80:83], v[16:19]
buffer_load_dwordx4 a[40:43], v224, s[20:23], s12 offen offset:0 sc1
v_mfma_f32_16x16x32_bf16 v[16:19], a[8:11], a[64:67], v[16:19]
s_waitcnt lgkmcnt(4)
v_mfma_f32_16x16x32_bf16 v[32:35], a[16:19], a[64:67], v[32:35]
ds_read_b128 a[8:11], v225 offset:43008
v_mfma_f32_16x16x32_bf16 v[32:35], a[20:23], a[80:83], v[32:35]
s_add_u32 s13, s39, 126976
v_mfma_f32_16x16x32_bf16 v[36:39], a[20:23], a[84:87], v[36:39]
buffer_load_dwordx4 a[44:47], v224, s[20:23], s13 offen offset:0 sc1
v_mfma_f32_16x16x32_bf16 v[36:39], a[16:19], a[68:71], v[36:39]
v_mfma_f32_16x16x32_bf16 v[40:43], a[16:19], a[72:75], v[40:43]
ds_read_b128 a[12:15], v225 offset:44032
v_mfma_f32_16x16x32_bf16 v[40:43], a[20:23], a[88:91], v[40:43]
buffer_load_dwordx4 a[48:51], v224, s[20:23], s10 offen offset:1024 sc1
v_mfma_f32_16x16x32_bf16 v[44:47], a[20:23], a[92:95], v[44:47]
v_mfma_f32_16x16x32_bf16 v[44:47], a[16:19], a[76:79], v[44:47]
s_waitcnt lgkmcnt(4)
v_mfma_f32_16x16x32_bf16 v[60:63], a[24:27], a[76:79], v[60:63]
ds_read_b128 a[16:19], v225 offset:45056
v_mfma_f32_16x16x32_bf16 v[60:63], a[28:31], a[92:95], v[60:63]
v_mfma_f32_16x16x32_bf16 v[56:59], a[28:31], a[88:91], v[56:59]
v_mfma_f32_16x16x32_bf16 v[56:59], a[24:27], a[72:75], v[56:59]
v_mfma_f32_16x16x32_bf16 v[52:55], a[24:27], a[68:71], v[52:55]
ds_read_b128 a[20:23], v225 offset:46080
v_mfma_f32_16x16x32_bf16 v[52:55], a[28:31], a[84:87], v[52:55]
buffer_load_dwordx4 a[52:55], v224, s[20:23], s11 offen offset:1024 sc1
v_mfma_f32_16x16x32_bf16 v[48:51], a[28:31], a[80:83], v[48:51]
v_mfma_f32_16x16x32_bf16 v[48:51], a[24:27], a[64:67], v[48:51]
s_waitcnt lgkmcnt(4)
v_mfma_f32_16x16x32_bf16 v[64:67], a[0:3], a[64:67], v[64:67]
ds_read_b128 a[24:27], v225 offset:47104
v_mfma_f32_16x16x32_bf16 v[64:67], a[4:7], a[80:83], v[64:67]
buffer_load_dwordx4 a[56:59], v224, s[20:23], s12 offen offset:1024 sc1
v_mfma_f32_16x16x32_bf16 v[68:71], a[4:7], a[84:87], v[68:71]
v_mfma_f32_16x16x32_bf16 v[68:71], a[0:3], a[68:71], v[68:71]
s_waitcnt vmcnt(44)
s_barrier
v_mfma_f32_16x16x32_bf16 v[72:75], a[0:3], a[72:75], v[72:75]
ds_read_b128 a[28:31], v225 offset:48128
v_mfma_f32_16x16x32_bf16 v[72:75], a[4:7], a[88:91], v[72:75]
buffer_load_dwordx4 a[60:63], v224, s[20:23], s13 offen offset:1024 sc1
v_mfma_f32_16x16x32_bf16 v[76:79], a[4:7], a[92:95], v[76:79]
v_mfma_f32_16x16x32_bf16 v[76:79], a[0:3], a[76:79], v[76:79]
s_waitcnt lgkmcnt(4)
v_mfma_f32_16x16x32_bf16 v[92:95], a[8:11], a[76:79], v[92:95]
ds_read_b128 a[0:3], v225 offset:49152
v_mfma_f32_16x16x32_bf16 v[92:95], a[12:15], a[92:95], v[92:95]
s_add_u32 m0, s36, 81920
v_mfma_f32_16x16x32_bf16 v[88:91], a[12:15], a[88:91], v[88:91]
s_add_u32 s57, s37, 311296
v_mfma_f32_16x16x32_bf16 v[88:91], a[8:11], a[72:75], v[88:91]
buffer_load_dwordx4 v226, s[20:23], s57 offen offset:0 sc1 lds
v_mfma_f32_16x16x32_bf16 v[84:87], a[8:11], a[68:71], v[84:87]
ds_read_b128 a[4:7], v225 offset:50176
v_mfma_f32_16x16x32_bf16 v[84:87], a[12:15], a[84:87], v[84:87]
v_mfma_f32_16x16x32_bf16 v[80:83], a[12:15], a[80:83], v[80:83]
v_mfma_f32_16x16x32_bf16 v[80:83], a[8:11], a[64:67], v[80:83]
s_waitcnt lgkmcnt(4)
v_mfma_f32_16x16x32_bf16 v[96:99], a[16:19], a[64:67], v[96:99]
ds_read_b128 a[8:11], v225 offset:51200
v_mfma_f32_16x16x32_bf16 v[96:99], a[20:23], a[80:83], v[96:99]
buffer_load_dwordx4 v226, s[20:23], s57 offen offset:1024 sc1 lds
v_mfma_f32_16x16x32_bf16 v[100:103], a[20:23], a[84:87], v[100:103]
v_mfma_f32_16x16x32_bf16 v[100:103], a[16:19], a[68:71], v[100:103]
v_mfma_f32_16x16x32_bf16 v[104:107], a[16:19], a[72:75], v[104:107]
ds_read_b128 a[12:15], v225 offset:52224
v_mfma_f32_16x16x32_bf16 v[104:107], a[20:23], a[88:91], v[104:107]
buffer_load_dwordx4 v226, s[20:23], s57 offen offset:2048 sc1 lds
v_mfma_f32_16x16x32_bf16 v[108:111], a[20:23], a[92:95], v[108:111]
v_mfma_f32_16x16x32_bf16 v[108:111], a[16:19], a[76:79], v[108:111]
s_waitcnt lgkmcnt(4)
v_mfma_f32_16x16x32_bf16 v[124:127], a[24:27], a[76:79], v[124:127]
ds_read_b128 a[16:19], v225 offset:53248
v_mfma_f32_16x16x32_bf16 v[124:127], a[28:31], a[92:95], v[124:127]
buffer_load_dwordx4 v226, s[20:23], s57 offen offset:3072 sc1 lds
v_mfma_f32_16x16x32_bf16 v[120:123], a[28:31], a[88:91], v[120:123]
v_mfma_f32_16x16x32_bf16 v[120:123], a[24:27], a[72:75], v[120:123]
v_mfma_f32_16x16x32_bf16 v[116:119], a[24:27], a[68:71], v[116:119]
ds_read_b128 a[20:23], v225 offset:54272
v_mfma_f32_16x16x32_bf16 v[116:119], a[28:31], a[84:87], v[116:119]
v_mfma_f32_16x16x32_bf16 v[112:115], a[28:31], a[80:83], v[112:115]
v_mfma_f32_16x16x32_bf16 v[112:115], a[24:27], a[64:67], v[112:115]
s_waitcnt lgkmcnt(4)
v_mfma_f32_16x16x32_bf16 v[128:131], a[0:3], a[64:67], v[128:131]
ds_read_b128 a[24:27], v225 offset:55296
v_mfma_f32_16x16x32_bf16 v[128:131], a[4:7], a[80:83], v[128:131]
v_mfma_f32_16x16x32_bf16 v[132:135], a[4:7], a[84:87], v[132:135]
v_mfma_f32_16x16x32_bf16 v[132:135], a[0:3], a[68:71], v[132:135]
v_mfma_f32_16x16x32_bf16 v[136:139], a[0:3], a[72:75], v[136:139]
ds_read_b128 a[28:31], v225 offset:56320
v_mfma_f32_16x16x32_bf16 v[136:139], a[4:7], a[88:91], v[136:139]
v_mfma_f32_16x16x32_bf16 v[140:143], a[4:7], a[92:95], v[140:143]
v_mfma_f32_16x16x32_bf16 v[140:143], a[0:3], a[76:79], v[140:143]
s_waitcnt lgkmcnt(4)
v_mfma_f32_16x16x32_bf16 v[156:159], a[8:11], a[76:79], v[156:159]
ds_read_b128 a[0:3], v225 offset:57344
v_mfma_f32_16x16x32_bf16 v[156:159], a[12:15], a[92:95], v[156:159]
v_mfma_f32_16x16x32_bf16 v[152:155], a[12:15], a[88:91], v[152:155]
v_mfma_f32_16x16x32_bf16 v[152:155], a[8:11], a[72:75], v[152:155]
v_mfma_f32_16x16x32_bf16 v[148:151], a[8:11], a[68:71], v[148:151]
ds_read_b128 a[4:7], v225 offset:58368
v_mfma_f32_16x16x32_bf16 v[148:151], a[12:15], a[84:87], v[148:151]
v_mfma_f32_16x16x32_bf16 v[144:147], a[12:15], a[80:83], v[144:147]
v_mfma_f32_16x16x32_bf16 v[144:147], a[8:11], a[64:67], v[144:147]
s_waitcnt lgkmcnt(4)
v_mfma_f32_16x16x32_bf16 v[160:163], a[16:19], a[64:67], v[160:163]
ds_read_b128 a[8:11], v225 offset:59392
v_mfma_f32_16x16x32_bf16 v[160:163], a[20:23], a[80:83], v[160:163]
v_mfma_f32_16x16x32_bf16 v[164:167], a[20:23], a[84:87], v[164:167]
v_mfma_f32_16x16x32_bf16 v[164:167], a[16:19], a[68:71], v[164:167]
v_mfma_f32_16x16x32_bf16 v[168:171], a[16:19], a[72:75], v[168:171]
ds_read_b128 a[12:15], v225 offset:60416
v_mfma_f32_16x16x32_bf16 v[168:171], a[20:23], a[88:91], v[168:171]
v_mfma_f32_16x16x32_bf16 v[172:175], a[20:23], a[92:95], v[172:175]
v_mfma_f32_16x16x32_bf16 v[172:175], a[16:19], a[76:79], v[172:175]
s_waitcnt lgkmcnt(4)
v_mfma_f32_16x16x32_bf16 v[188:191], a[24:27], a[76:79], v[188:191]
ds_read_b128 a[16:19], v225 offset:61440
v_mfma_f32_16x16x32_bf16 v[188:191], a[28:31], a[92:95], v[188:191]
v_mfma_f32_16x16x32_bf16 v[184:187], a[28:31], a[88:91], v[184:187]
v_mfma_f32_16x16x32_bf16 v[184:187], a[24:27], a[72:75], v[184:187]
v_mfma_f32_16x16x32_bf16 v[180:183], a[24:27], a[68:71], v[180:183]
ds_read_b128 a[20:23], v225 offset:62464
v_mfma_f32_16x16x32_bf16 v[180:183], a[28:31], a[84:87], v[180:183]
v_mfma_f32_16x16x32_bf16 v[176:179], a[28:31], a[80:83], v[176:179]
v_mfma_f32_16x16x32_bf16 v[176:179], a[24:27], a[64:67], v[176:179]
s_waitcnt lgkmcnt(4)
v_mfma_f32_16x16x32_bf16 v[192:195], a[0:3], a[64:67], v[192:195]
ds_read_b128 a[24:27], v225 offset:63488
v_mfma_f32_16x16x32_bf16 v[192:195], a[4:7], a[80:83], v[192:195]
v_mfma_f32_16x16x32_bf16 v[196:199], a[4:7], a[84:87], v[196:199]
v_mfma_f32_16x16x32_bf16 v[196:199], a[0:3], a[68:71], v[196:199]
s_waitcnt vmcnt(45)
s_barrier
v_mfma_f32_16x16x32_bf16 v[200:203], a[0:3], a[72:75], v[200:203]
ds_read_b128 a[28:31], v225 offset:64512
v_mfma_f32_16x16x32_bf16 v[200:203], a[4:7], a[88:91], v[200:203]
s_add_u32 m0, s36, 98304
v_mfma_f32_16x16x32_bf16 v[204:207], a[4:7], a[92:95], v[204:207]
s_add_u32 s57, s37, 327680
v_mfma_f32_16x16x32_bf16 v[204:207], a[0:3], a[76:79], v[204:207]
s_waitcnt lgkmcnt(4)
v_mfma_f32_16x16x32_bf16 v[220:223], a[8:11], a[76:79], v[220:223]
buffer_load_dwordx4 v226, s[20:23], s57 offen offset:0 sc1 lds
v_mfma_f32_16x16x32_bf16 v[220:223], a[12:15], a[92:95], v[220:223]
ds_read_b128 a[0:3], v224 offset:0
v_mfma_f32_16x16x32_bf16 v[216:219], a[12:15], a[88:91], v[216:219]
v_mfma_f32_16x16x32_bf16 v[216:219], a[8:11], a[72:75], v[216:219]
v_mfma_f32_16x16x32_bf16 v[212:215], a[8:11], a[68:71], v[212:215]
ds_read_b128 a[4:7], v224 offset:1024
v_mfma_f32_16x16x32_bf16 v[212:215], a[12:15], a[84:87], v[212:215]
buffer_load_dwordx4 v226, s[20:23], s57 offen offset:1024 sc1 lds
v_mfma_f32_16x16x32_bf16 v[208:211], a[12:15], a[80:83], v[208:211]
v_mfma_f32_16x16x32_bf16 v[208:211], a[8:11], a[64:67], v[208:211]
s_waitcnt lgkmcnt(4)
v_mfma_f32_16x16x32_bf16 v[0:3], a[16:19], a[96:99], v[0:3]
ds_read_b128 a[8:11], v224 offset:2048
v_mfma_f32_16x16x32_bf16 v[0:3], a[20:23], a[112:115], v[0:3]
buffer_load_dwordx4 v226, s[20:23], s57 offen offset:2048 sc1 lds
v_mfma_f32_16x16x32_bf16 v[4:7], a[20:23], a[116:119], v[4:7]
v_mfma_f32_16x16x32_bf16 v[4:7], a[16:19], a[100:103], v[4:7]
v_mfma_f32_16x16x32_bf16 v[8:11], a[16:19], a[104:107], v[8:11]
ds_read_b128 a[12:15], v224 offset:3072
v_mfma_f32_16x16x32_bf16 v[8:11], a[20:23], a[120:123], v[8:11]
buffer_load_dwordx4 v226, s[20:23], s57 offen offset:3072 sc1 lds
v_mfma_f32_16x16x32_bf16 v[12:15], a[20:23], a[124:127], v[12:15]
v_mfma_f32_16x16x32_bf16 v[12:15], a[16:19], a[108:111], v[12:15]
s_waitcnt lgkmcnt(4)
v_mfma_f32_16x16x32_bf16 v[124:127], a[24:27], a[108:111], v[124:127]
ds_read_b128 a[16:19], v224 offset:4096
v_mfma_f32_16x16x32_bf16 v[124:127], a[28:31], a[124:127], v[124:127]
buffer_load_dwordx4 a[64:67], v224, s[20:23], s10 offen offset:2048 sc1
v_mfma_f32_16x16x32_bf16 v[120:123], a[28:31], a[120:123], v[120:123]
v_mfma_f32_16x16x32_bf16 v[120:123], a[24:27], a[104:107], v[120:123]
v_mfma_f32_16x16x32_bf16 v[116:119], a[24:27], a[100:103], v[116:119]
ds_read_b128 a[20:23], v224 offset:5120
v_mfma_f32_16x16x32_bf16 v[116:119], a[28:31], a[116:119], v[116:119]
v_mfma_f32_16x16x32_bf16 v[112:115], a[28:31], a[112:115], v[112:115]
v_mfma_f32_16x16x32_bf16 v[112:115], a[24:27], a[96:99], v[112:115]
s_waitcnt lgkmcnt(4)
v_mfma_f32_16x16x32_bf16 v[0:3], a[0:3], a[128:131], v[0:3]
ds_read_b128 a[24:27], v224 offset:6144
v_mfma_f32_16x16x32_bf16 v[0:3], a[4:7], a[144:147], v[0:3]
buffer_load_dwordx4 a[68:71], v224, s[20:23], s11 offen offset:2048 sc1
v_mfma_f32_16x16x32_bf16 v[4:7], a[4:7], a[148:151], v[4:7]
v_mfma_f32_16x16x32_bf16 v[4:7], a[0:3], a[132:135], v[4:7]
v_mfma_f32_16x16x32_bf16 v[8:11], a[0:3], a[136:139], v[8:11]
ds_read_b128 a[28:31], v224 offset:7168
v_mfma_f32_16x16x32_bf16 v[8:11], a[4:7], a[152:155], v[8:11]
buffer_load_dwordx4 a[72:75], v224, s[20:23], s12 offen offset:2048 sc1
v_mfma_f32_16x16x32_bf16 v[12:15], a[4:7], a[156:159], v[12:15]
v_mfma_f32_16x16x32_bf16 v[12:15], a[0:3], a[140:143], v[12:15]
s_waitcnt lgkmcnt(4)
v_mfma_f32_16x16x32_bf16 v[124:127], a[8:11], a[140:143], v[124:127]
ds_read_b128 a[0:3], v224 offset:8192
v_mfma_f32_16x16x32_bf16 v[124:127], a[12:15], a[156:159], v[124:127]
buffer_load_dwordx4 a[76:79], v224, s[20:23], s13 offen offset:2048 sc1
v_mfma_f32_16x16x32_bf16 v[120:123], a[12:15], a[152:155], v[120:123]
s_waitcnt vmcnt(36)
ds_read_b64_tr_b16 v[244:245], v232 offset:16384
v_mfma_f32_16x16x32_bf16 v[120:123], a[8:11], a[136:139], v[120:123]
ds_read_b64_tr_b16 v[246:247], v232 offset:18432
v_mfma_f32_16x16x32_bf16 v[116:119], a[8:11], a[132:135], v[116:119]
ds_read_b64_tr_b16 v[248:249], v232 offset:16392
v_mfma_f32_16x16x32_bf16 v[116:119], a[12:15], a[148:151], v[116:119]
ds_read_b64_tr_b16 v[250:251], v232 offset:18440
v_mfma_f32_16x16x32_bf16 v[112:115], a[12:15], a[144:147], v[112:115]
ds_read_b128 a[4:7], v224 offset:9216
v_mfma_f32_16x16x32_bf16 v[112:115], a[8:11], a[128:131], v[112:115]
s_waitcnt lgkmcnt(8)
v_mfma_f32_16x16x32_bf16 v[0:3], a[16:19], a[160:163], v[0:3]
buffer_load_dwordx4 a[80:83], v224, s[20:23], s10 offen offset:3072 sc1
v_mfma_f32_16x16x32_bf16 v[0:3], a[20:23], a[176:179], v[0:3]
ds_read_b128 a[8:11], v224 offset:10240
v_mfma_f32_16x16x32_bf16 v[4:7], a[20:23], a[180:183], v[4:7]
s_mov_b32 s18, s55
v_mfma_f32_16x16x32_bf16 v[4:7], a[16:19], a[164:167], v[4:7]
s_waitcnt lgkmcnt(4)
buffer_store_dwordx4 v[244:247], v224, s[28:31], s18 offen offset:0 sc1
v_mfma_f32_16x16x32_bf16 v[8:11], a[16:19], a[168:171], v[8:11]
s_waitcnt lgkmcnt(2)
buffer_store_dwordx4 v[248:251], v224, s[28:31], s18 offen offset:2048 sc1
v_mfma_f32_16x16x32_bf16 v[8:11], a[20:23], a[184:187], v[8:11]
ds_read_b128 a[12:15], v224 offset:11264
v_mfma_f32_16x16x32_bf16 v[12:15], a[20:23], a[188:191], v[12:15]
buffer_load_dwordx4 a[84:87], v224, s[20:23], s11 offen offset:3072 sc1
v_mfma_f32_16x16x32_bf16 v[12:15], a[16:19], a[172:175], v[12:15]
v_mfma_f32_16x16x32_bf16 v[124:127], a[24:27], a[172:175], v[124:127]
ds_read_b128 a[16:19], v224 offset:12288
v_mfma_f32_16x16x32_bf16 v[124:127], a[28:31], a[188:191], v[124:127]
buffer_load_dwordx4 a[88:91], v224, s[20:23], s12 offen offset:3072 sc1
v_mfma_f32_16x16x32_bf16 v[120:123], a[28:31], a[184:187], v[120:123]
ds_read_b64_tr_b16 v[244:245], v232 offset:16448
v_mfma_f32_16x16x32_bf16 v[120:123], a[24:27], a[168:171], v[120:123]
ds_read_b64_tr_b16 v[246:247], v232 offset:18496
L_ct1:
v_mfma_f32_16x16x32_bf16 v[116:119], a[24:27], a[164:167], v[116:119]
ds_read_b64_tr_b16 v[248:249], v232 offset:16456
v_mfma_f32_16x16x32_bf16 v[116:119], a[28:31], a[180:183], v[116:119]
ds_read_b64_tr_b16 v[250:251], v232 offset:18504
v_mfma_f32_16x16x32_bf16 v[112:115], a[28:31], a[176:179], v[112:115]
ds_read_b128 a[20:23], v224 offset:13312
v_mfma_f32_16x16x32_bf16 v[112:115], a[24:27], a[160:163], v[112:115]
buffer_load_dwordx4 a[92:95], v224, s[20:23], s13 offen offset:3072 sc1
v_mfma_f32_16x16x32_bf16 v[0:3], a[0:3], a[192:195], v[0:3]
ds_read_b128 a[24:27], v224 offset:14336
s_waitcnt lgkmcnt(8)
v_mfma_f32_16x16x32_bf16 v[0:3], a[4:7], a[208:211], v[0:3]
s_add_u32 s18, s18, s60
v_mfma_f32_16x16x32_bf16 v[4:7], a[4:7], a[212:215], v[4:7]
s_waitcnt lgkmcnt(4)
buffer_store_dwordx4 v[244:247], v224, s[28:31], s18 offen offset:0 sc1
v_mfma_f32_16x16x32_bf16 v[4:7], a[0:3], a[196:199], v[4:7]
s_waitcnt vmcnt(31)
s_barrier
v_mfma_f32_16x16x32_bf16 v[8:11], a[0:3], a[200:203], v[8:11]
s_waitcnt lgkmcnt(2)
buffer_store_dwordx4 v[248:251], v224, s[28:31], s18 offen offset:2048 sc1
v_mfma_f32_16x16x32_bf16 v[8:11], a[4:7], a[216:219], v[8:11]
ds_read_b128 a[28:31], v224 offset:15360
v_mfma_f32_16x16x32_bf16 v[12:15], a[4:7], a[220:223], v[12:15]
s_add_u32 m0, s36, 114688
v_mfma_f32_16x16x32_bf16 v[12:15], a[0:3], a[204:207], v[12:15]
s_add_u32 s57, s37, 344064
v_mfma_f32_16x16x32_bf16 v[124:127], a[8:11], a[204:207], v[124:127]
buffer_load_dwordx4 v226, s[20:23], s57 offen offset:0 sc1 lds
v_mfma_f32_16x16x32_bf16 v[124:127], a[12:15], a[220:223], v[124:127]
ds_read_b128 a[0:3], v224 offset:49152
v_mfma_f32_16x16x32_bf16 v[120:123], a[12:15], a[216:219], v[120:123]
ds_read_b64_tr_b16 v[244:245], v232 offset:16512
v_mfma_f32_16x16x32_bf16 v[120:123], a[8:11], a[200:203], v[120:123]
ds_read_b64_tr_b16 v[246:247], v232 offset:18560
v_mfma_f32_16x16x32_bf16 v[116:119], a[8:11], a[196:199], v[116:119]
ds_read_b64_tr_b16 v[248:249], v232 offset:16520
v_mfma_f32_16x16x32_bf16 v[116:119], a[12:15], a[212:215], v[116:119]
ds_read_b64_tr_b16 v[250:251], v232 offset:18568
v_mfma_f32_16x16x32_bf16 v[112:115], a[12:15], a[208:211], v[112:115]
ds_read_b128 a[4:7], v224 offset:50176
v_mfma_f32_16x16x32_bf16 v[112:115], a[8:11], a[192:195], v[112:115]
buffer_load_dwordx4 v226, s[20:23], s57 offen offset:1024 sc1 lds
v_mfma_f32_16x16x32_bf16 v[0:3], a[16:19], a[224:227], v[0:3]
ds_read_b128 a[8:11], v224 offset:51200
s_waitcnt lgkmcnt(8)
v_mfma_f32_16x16x32_bf16 v[0:3], a[20:23], a[240:243], v[0:3]
buffer_load_dwordx4 v226, s[20:23], s57 offen offset:2048 sc1 lds
v_mfma_f32_16x16x32_bf16 v[4:7], a[20:23], a[244:247], v[4:7]
s_add_u32 s18, s18, s60
v_mfma_f32_16x16x32_bf16 v[4:7], a[16:19], a[228:231], v[4:7]
s_waitcnt lgkmcnt(4)
buffer_store_dwordx4 v[244:247], v224, s[28:31], s18 offen offset:0 sc1
v_mfma_f32_16x16x32_bf16 v[8:11], a[16:19], a[232:235], v[8:11]
s_waitcnt lgkmcnt(2)
buffer_store_dwordx4 v[248:251], v224, s[28:31], s18 offen offset:2048 sc1
v_mfma_f32_16x16x32_bf16 v[8:11], a[20:23], a[248:251], v[8:11]
ds_read_b128 a[12:15], v224 offset:52224
v_mfma_f32_16x16x32_bf16 v[12:15], a[20:23], a[252:255], v[12:15]
buffer_load_dwordx4 v226, s[20:23], s57 offen offset:3072 sc1 lds
v_mfma_f32_16x16x32_bf16 v[12:15], a[16:19], a[236:239], v[12:15]
v_mfma_f32_16x16x32_bf16 v[124:127], a[24:27], a[236:239], v[124:127]
ds_read_b128 a[16:19], v224 offset:53248
v_mfma_f32_16x16x32_bf16 v[124:127], a[28:31], a[252:255], v[124:127]
ds_read_b64_tr_b16 v[244:245], v232 offset:16576
v_mfma_f32_16x16x32_bf16 v[120:123], a[28:31], a[248:251], v[120:123]
ds_read_b64_tr_b16 v[246:247], v232 offset:18624
v_mfma_f32_16x16x32_bf16 v[120:123], a[24:27], a[232:235], v[120:123]
ds_read_b64_tr_b16 v[248:249], v232 offset:16584
v_mfma_f32_16x16x32_bf16 v[116:119], a[24:27], a[228:231], v[116:119]
ds_read_b64_tr_b16 v[250:251], v232 offset:18632
v_mfma_f32_16x16x32_bf16 v[116:119], a[28:31], a[244:247], v[116:119]
ds_read_b128 a[20:23], v224 offset:54272
v_mfma_f32_16x16x32_bf16 v[112:115], a[28:31], a[240:243], v[112:115]
v_mfma_f32_16x16x32_bf16 v[112:115], a[24:27], a[224:227], v[112:115]
s_waitcnt vmcnt(30)
v_mfma_f32_16x16x32_bf16 v[0:3], a[0:3], a[32:35], v[0:3]
ds_read_b128 a[24:27], v224 offset:55296
s_waitcnt vmcnt(26) lgkmcnt(8)
v_mfma_f32_16x16x32_bf16 v[0:3], a[4:7], a[48:51], v[0:3]
s_add_u32 s18, s18, s60
v_mfma_f32_16x16x32_bf16 v[4:7], a[4:7], a[52:55], v[4:7]
s_waitcnt lgkmcnt(4)
buffer_store_dwordx4 v[244:247], v224, s[28:31], s18 offen offset:0 sc1
v_mfma_f32_16x16x32_bf16 v[4:7], a[0:3], a[36:39], v[4:7]
s_waitcnt lgkmcnt(2)
buffer_store_dwordx4 v[248:251], v224, s[28:31], s18 offen offset:2048 sc1
v_mfma_f32_16x16x32_bf16 v[8:11], a[0:3], a[40:43], v[8:11]
ds_read_b128 a[28:31], v224 offset:56320
v_mfma_f32_16x16x32_bf16 v[8:11], a[4:7], a[56:59], v[8:11]
v_mfma_f32_16x16x32_bf16 v[12:15], a[4:7], a[60:63], v[12:15]
v_mfma_f32_16x16x32_bf16 v[12:15], a[0:3], a[44:47], v[12:15]
v_mfma_f32_16x16x32_bf16 v[124:127], a[8:11], a[44:47], v[124:127]
ds_read_b128 a[0:3], v224 offset:57344
v_mfma_f32_16x16x32_bf16 v[124:127], a[12:15], a[60:63], v[124:127]
v_mfma_f32_16x16x32_bf16 v[120:123], a[12:15], a[56:59], v[120:123]
v_mfma_f32_16x16x32_bf16 v[120:123], a[8:11], a[40:43], v[120:123]
v_mfma_f32_16x16x32_bf16 v[116:119], a[8:11], a[36:39], v[116:119]
ds_read_b128 a[4:7], v224 offset:58368
v_mfma_f32_16x16x32_bf16 v[116:119], a[12:15], a[52:55], v[116:119]
v_mfma_f32_16x16x32_bf16 v[112:115], a[12:15], a[48:51], v[112:115]
v_mfma_f32_16x16x32_bf16 v[112:115], a[8:11], a[32:35], v[112:115]
s_waitcnt vmcnt(16)
v_mfma_f32_16x16x32_bf16 v[0:3], a[16:19], a[64:67], v[0:3]
ds_read_b128 a[8:11], v224 offset:59392
s_waitcnt vmcnt(10) lgkmcnt(4)
v_mfma_f32_16x16x32_bf16 v[0:3], a[20:23], a[80:83], v[0:3]
v_mfma_f32_16x16x32_bf16 v[4:7], a[20:23], a[84:87], v[4:7]
v_mfma_f32_16x16x32_bf16 v[4:7], a[16:19], a[68:71], v[4:7]
v_mfma_f32_16x16x32_bf16 v[8:11], a[16:19], a[72:75], v[8:11]
ds_read_b128 a[12:15], v224 offset:60416
v_mfma_f32_16x16x32_bf16 v[8:11], a[20:23], a[88:91], v[8:11]
v_mfma_f32_16x16x32_bf16 v[12:15], a[20:23], a[92:95], v[12:15]
v_mfma_f32_16x16x32_bf16 v[12:15], a[16:19], a[76:79], v[12:15]
v_mfma_f32_16x16x32_bf16 v[124:127], a[24:27], a[76:79], v[124:127]
ds_read_b128 a[16:19], v224 offset:61440
s_waitcnt lgkmcnt(4)
v_mfma_f32_16x16x32_bf16 v[124:127], a[28:31], a[92:95], v[124:127]
v_mfma_f32_16x16x32_bf16 v[120:123], a[28:31], a[88:91], v[120:123]
v_mfma_f32_16x16x32_bf16 v[120:123], a[24:27], a[72:75], v[120:123]
v_mfma_f32_16x16x32_bf16 v[116:119], a[24:27], a[68:71], v[116:119]
ds_read_b128 a[20:23], v224 offset:62464
v_mfma_f32_16x16x32_bf16 v[116:119], a[28:31], a[84:87], v[116:119]
v_mfma_f32_16x16x32_bf16 v[112:115], a[28:31], a[80:83], v[112:115]
v_mfma_f32_16x16x32_bf16 v[112:115], a[24:27], a[64:67], v[112:115]
v_mfma_f32_16x16x32_bf16 v[16:19], a[0:3], a[96:99], v[16:19]
ds_read_b128 a[24:27], v224 offset:63488
s_waitcnt lgkmcnt(4)
v_mfma_f32_16x16x32_bf16 v[16:19], a[4:7], a[112:115], v[16:19]
v_mfma_f32_16x16x32_bf16 v[20:23], a[4:7], a[116:119], v[20:23]
v_mfma_f32_16x16x32_bf16 v[20:23], a[0:3], a[100:103], v[20:23]
s_barrier
v_mfma_f32_16x16x32_bf16 v[24:27], a[0:3], a[104:107], v[24:27]
ds_read_b128 a[28:31], v224 offset:64512
v_mul_f32 v236, v0, v0
v_mul_f32 v240, v8, v8
v_mfma_f32_16x16x32_bf16 v[24:27], a[4:7], a[120:123], v[24:27]
s_add_u32 m0, s36, 0
v_mul_f32 v237, v1, v1
v_mfma_f32_16x16x32_bf16 v[28:31], a[4:7], a[124:127], v[28:31]
s_add_u32 s57, s37, 360448
v_mul_f32 v241, v9, v9
v_mul_f32 v238, v2, v2
v_mfma_f32_16x16x32_bf16 v[28:31], a[0:3], a[108:111], v[28:31]
buffer_load_dwordx4 v226, s[20:23], s57 offen offset:0 sc1 lds
v_mfma_f32_16x16x32_bf16 v[140:143], a[8:11], a[108:111], v[140:143]
ds_read_b128 a[0:3], v225 offset:0
v_mul_f32 v242, v10, v10
s_waitcnt lgkmcnt(4)
v_mfma_f32_16x16x32_bf16 v[140:143], a[12:15], a[124:127], v[140:143]
v_mul_f32 v239, v3, v3
v_mul_f32 v243, v11, v11
v_mfma_f32_16x16x32_bf16 v[136:139], a[12:15], a[120:123], v[136:139]
v_fmaak_f32 v236, v228, v236, 0xc0135761
v_fmaak_f32 v240, v228, v240, 0xc0135761
v_fmaak_f32 v237, v228, v237, 0xc0135761
v_mfma_f32_16x16x32_bf16 v[136:139], a[8:11], a[104:107], v[136:139]
v_fmaak_f32 v241, v228, v241, 0xc0135761
v_fmaak_f32 v238, v228, v238, 0xc0135761
v_mfma_f32_16x16x32_bf16 v[132:135], a[8:11], a[100:103], v[132:135]
ds_read_b128 a[4:7], v225 offset:1024
v_fmaak_f32 v242, v228, v242, 0xc0135761
v_fmaak_f32 v239, v228, v239, 0xc0135761
v_mfma_f32_16x16x32_bf16 v[132:135], a[12:15], a[116:119], v[132:135]
buffer_load_dwordx4 v226, s[20:23], s57 offen offset:1024 sc1 lds
v_mfma_f32_16x16x32_bf16 v[128:131], a[12:15], a[112:115], v[128:131]
v_lshlrev_b32 v252, 3, v224
v_fmaak_f32 v243, v228, v243, 0xc0135761
v_mfma_f32_16x16x32_bf16 v[128:131], a[8:11], a[96:99], v[128:131]
s_mov_b32 s58, L_ct2-L_body
v_mul_f32 v236, v236, v0
v_mfma_f32_16x16x32_bf16 v[16:19], a[16:19], a[128:131], v[16:19]
v_mul_f32 v240, v240, v8
s_waitcnt lgkmcnt(3)
v_mfma_f32_16x16x32_bf16 v[16:19], a[20:23], a[144:147], v[16:19]
buffer_load_dword v252, v252, s[80:83], s58 offen
v_mfma_f32_16x16x32_bf16 v[20:23], a[20:23], a[148:151], v[20:23]
ds_read_b128 a[8:11], v225 offset:2048
v_mul_f32 v237, v237, v1
v_mfma_f32_16x16x32_bf16 v[20:23], a[16:19], a[132:135], v[20:23]
buffer_load_dwordx4 v226, s[20:23], s57 offen offset:2048 sc1 lds
v_mfma_f32_16x16x32_bf16 v[24:27], a[16:19], a[136:139], v[24:27]
ds_read_b128 a[12:15], v225 offset:3072
v_mul_f32 v241, v241, v9
v_mfma_f32_16x16x32_bf16 v[24:27], a[20:23], a[152:155], v[24:27]
buffer_load_dwordx4 v226, s[20:23], s57 offen offset:3072 sc1 lds
v_mfma_f32_16x16x32_bf16 v[28:31], a[20:23], a[156:159], v[28:31]
v_mul_f32 v238, v238, v2
v_mul_f32 v242, v242, v10
v_mfma_f32_16x16x32_bf16 v[28:31], a[16:19], a[140:143], v[28:31]
v_mul_f32 v239, v239, v3
v_mul_f32 v243, v243, v11
v_mfma_f32_16x16x32_bf16 v[140:143], a[24:27], a[140:143], v[140:143]
ds_read_b128 a[16:19], v225 offset:4096
s_waitcnt lgkmcnt(4)
v_mfma_f32_16x16x32_bf16 v[140:143], a[28:31], a[156:159], v[140:143]
v_exp_f32 v236, v236
v_mfma_f32_16x16x32_bf16 v[136:139], a[28:31], a[152:155], v[136:139]
v_exp_f32 v240, v240
v_mfma_f32_16x16x32_bf16 v[136:139], a[24:27], a[136:139], v[136:139]
v_mul_f32 v112, v112, v0
v_mul_f32 v120, v120, v8
v_mfma_f32_16x16x32_bf16 v[132:135], a[24:27], a[132:135], v[132:135]
ds_read_b128 a[20:23], v225 offset:5120
v_mfma_f32_16x16x32_bf16 v[132:135], a[28:31], a[148:151], v[132:135]
v_exp_f32 v237, v237
v_mfma_f32_16x16x32_bf16 v[128:131], a[28:31], a[144:147], v[128:131]
v_exp_f32 v241, v241
v_mfma_f32_16x16x32_bf16 v[128:131], a[24:27], a[128:131], v[128:131]
v_mul_f32 v113, v113, v1
v_mul_f32 v121, v121, v9
v_mfma_f32_16x16x32_bf16 v[16:19], a[0:3], a[160:163], v[16:19]
ds_read_b128 a[24:27], v225 offset:6144
s_waitcnt lgkmcnt(4)
v_mfma_f32_16x16x32_bf16 v[16:19], a[4:7], a[176:179], v[16:19]
v_exp_f32 v238, v238
v_mfma_f32_16x16x32_bf16 v[20:23], a[4:7], a[180:183], v[20:23]
v_exp_f32 v242, v242
v_mfma_f32_16x16x32_bf16 v[20:23], a[0:3], a[164:167], v[20:23]
v_mul_f32 v114, v114, v2
v_mul_f32 v122, v122, v10
v_mfma_f32_16x16x32_bf16 v[24:27], a[0:3], a[168:171], v[24:27]
ds_read_b128 a[28:31], v225 offset:7168
v_mfma_f32_16x16x32_bf16 v[24:27], a[4:7], a[184:187], v[24:27]
s_add_u32 m0, s36, 16384
v_mfma_f32_16x16x32_bf16 v[28:31], a[4:7], a[188:191], v[28:31]
s_add_u32 s57, s37, 376832
v_mfma_f32_16x16x32_bf16 v[28:31], a[0:3], a[172:175], v[28:31]
buffer_load_dwordx4 v226, s[20:23], s57 offen offset:0 sc1 lds
s_waitcnt vmcnt(6)
s_mov_b64 exec, 1
buffer_store_dword v253, off, s[28:31], s47 sc1
s_mov_b64 exec, -1
v_mfma_f32_16x16x32_bf16 v[140:143], a[8:11], a[172:175], v[140:143]
ds_read_b128 a[0:3], v225 offset:8192
s_waitcnt lgkmcnt(4)
v_mfma_f32_16x16x32_bf16 v[140:143], a[12:15], a[188:191], v[140:143]
v_exp_f32 v239, v239
v_mfma_f32_16x16x32_bf16 v[136:139], a[12:15], a[184:187], v[136:139]
v_exp_f32 v243, v243
v_mfma_f32_16x16x32_bf16 v[136:139], a[8:11], a[168:171], v[136:139]
v_mul_f32 v115, v115, v3
v_mul_f32 v123, v123, v11
v_mfma_f32_16x16x32_bf16 v[132:135], a[8:11], a[164:167], v[132:135]
ds_read_b128 a[4:7], v225 offset:9216
v_add_f32 v236, 1.0, v236
v_mfma_f32_16x16x32_bf16 v[132:135], a[12:15], a[180:183], v[132:135]
buffer_load_dwordx4 v226, s[20:23], s57 offen offset:1024 sc1 lds
v_mfma_f32_16x16x32_bf16 v[128:131], a[12:15], a[176:179], v[128:131]
v_add_f32 v240, 1.0, v240
v_add_f32 v237, 1.0, v237
v_mfma_f32_16x16x32_bf16 v[128:131], a[8:11], a[160:163], v[128:131]
v_add_f32 v241, 1.0, v241
v_add_f32 v238, 1.0, v238
v_mfma_f32_16x16x32_bf16 v[16:19], a[16:19], a[192:195], v[16:19]
ds_read_b128 a[8:11], v225 offset:10240
s_waitcnt lgkmcnt(4)
v_mfma_f32_16x16x32_bf16 v[16:19], a[20:23], a[208:211], v[16:19]
v_add_f32 v242, 1.0, v242
v_add_f32 v239, 1.0, v239
v_mfma_f32_16x16x32_bf16 v[20:23], a[20:23], a[212:215], v[20:23]
v_rcp_f32 v236, v236
v_mfma_f32_16x16x32_bf16 v[20:23], a[16:19], a[196:199], v[20:23]
v_rcp_f32 v237, v237
v_mfma_f32_16x16x32_bf16 v[24:27], a[16:19], a[200:203], v[24:27]
ds_read_b128 a[12:15], v225 offset:11264
v_add_f32 v243, 1.0, v243
v_mfma_f32_16x16x32_bf16 v[24:27], a[20:23], a[216:219], v[24:27]
buffer_load_dwordx4 v226, s[20:23], s57 offen offset:2048 sc1 lds
v_mfma_f32_16x16x32_bf16 v[28:31], a[20:23], a[220:223], v[28:31]
v_rcp_f32 v238, v238
v_mfma_f32_16x16x32_bf16 v[28:31], a[16:19], a[204:207], v[28:31]
v_rcp_f32 v240, v240
v_mfma_f32_16x16x32_bf16 v[140:143], a[24:27], a[204:207], v[140:143]
ds_read_b128 a[16:19], v225 offset:12288
s_waitcnt lgkmcnt(4)
v_mfma_f32_16x16x32_bf16 v[140:143], a[28:31], a[220:223], v[140:143]
v_rcp_f32 v239, v239
v_mfma_f32_16x16x32_bf16 v[136:139], a[28:31], a[216:219], v[136:139]
v_rcp_f32 v241, v241
v_mfma_f32_16x16x32_bf16 v[136:139], a[24:27], a[200:203], v[136:139]
v_rcp_f32 v242, v242
v_mfma_f32_16x16x32_bf16 v[132:135], a[24:27], a[196:199], v[132:135]
ds_read_b128 a[20:23], v225 offset:13312
v_mul_f32 v112, v112, v236
v_mfma_f32_16x16x32_bf16 v[132:135], a[28:31], a[212:215], v[132:135]
buffer_load_dwordx4 v226, s[20:23], s57 offen offset:3072 sc1 lds
v_mfma_f32_16x16x32_bf16 v[128:131], a[28:31], a[208:211], v[128:131]
v_rcp_f32 v243, v243
v_mfma_f32_16x16x32_bf16 v[128:131], a[24:27], a[192:195], v[128:131]
v_mul_f32 v113, v113, v237
v_mul_f32 v120, v120, v240
v_mfma_f32_16x16x32_bf16 v[16:19], a[0:3], a[224:227], v[16:19]
ds_read_b128 a[24:27], v225 offset:14336
s_waitcnt lgkmcnt(4)
v_mfma_f32_16x16x32_bf16 v[16:19], a[4:7], a[240:243], v[16:19]
v_mov_b32 v244, -1
v_mov_b32 v245, -1
v_mfma_f32_16x16x32_bf16 v[20:23], a[4:7], a[244:247], v[20:23]
v_mov_b32 v246, -1
v_mov_b32 v247, -1
v_mfma_f32_16x16x32_bf16 v[20:23], a[0:3], a[228:231], v[20:23]
s_add_u32 s18, s42, 2097152
s_barrier
v_mfma_f32_16x16x32_bf16 v[24:27], a[0:3], a[232:235], v[24:27]
buffer_store_dwordx4 v[244:247], v224, s[20:23], s18 offen sc1
v_mfma_f32_16x16x32_bf16 v[24:27], a[4:7], a[248:251], v[24:27]
ds_read_b128 a[28:31], v225 offset:15360
v_mul_f32 v114, v114, v238
v_mfma_f32_16x16x32_bf16 v[28:31], a[4:7], a[252:255], v[28:31]
s_add_u32 m0, s36, 32768
v_mul_f32 v121, v121, v241
v_mfma_f32_16x16x32_bf16 v[28:31], a[0:3], a[236:239], v[28:31]
s_add_u32 s57, s37, 393216
v_mul_f32 v115, v115, v239
v_mfma_f32_16x16x32_bf16 v[140:143], a[8:11], a[236:239], v[140:143]
v_mul_f32 v122, v122, v242
s_waitcnt lgkmcnt(3)
v_mfma_f32_16x16x32_bf16 v[140:143], a[12:15], a[252:255], v[140:143]
buffer_load_dwordx4 v226, s[20:23], s57 offen offset:0 sc1 lds
v_mfma_f32_16x16x32_bf16 v[136:139], a[12:15], a[248:251], v[136:139]
ds_read_b128 a[0:3], v225 offset:16384
v_cvt_pk_bf16_f32 v0, v112, v113
v_mfma_f32_16x16x32_bf16 v[136:139], a[8:11], a[232:235], v[136:139]
v_mul_f32 v123, v123, v243
v_cvt_pk_bf16_f32 v1, v114, v115
v_mfma_f32_16x16x32_bf16 v[132:135], a[8:11], a[228:231], v[132:135]
ds_read_b128 a[4:7], v225 offset:17408
v_cvt_pk_bf16_f32 v8, v120, v121
v_mfma_f32_16x16x32_bf16 v[132:135], a[12:15], a[244:247], v[132:135]
buffer_load_dwordx4 v226, s[20:23], s57 offen offset:1024 sc1 lds
v_mfma_f32_16x16x32_bf16 v[128:131], a[12:15], a[240:243], v[128:131]
v_mul_f32 v236, v4, v4
v_cvt_pk_bf16_f32 v9, v122, v123
v_mfma_f32_16x16x32_bf16 v[128:131], a[8:11], a[224:227], v[128:131]
v_mul_f32 v237, v5, v5
v_mul_f32 v240, v12, v12
v_mfma_f32_16x16x32_bf16 v[16:19], a[16:19], a[32:35], v[16:19]
ds_read_b128 a[8:11], v225 offset:18432
s_waitcnt lgkmcnt(4)
v_mfma_f32_16x16x32_bf16 v[16:19], a[20:23], a[48:51], v[16:19]
s_add_u32 s18, s42, 2105344
v_mul_f32 v238, v6, v6
v_mfma_f32_16x16x32_bf16 v[20:23], a[20:23], a[52:55], v[20:23]
buffer_store_dwordx4 v[244:247], v224, s[20:23], s18 offen sc1
v_mfma_f32_16x16x32_bf16 v[20:23], a[16:19], a[36:39], v[20:23]
v_mul_f32 v241, v13, v13
v_mul_f32 v239, v7, v7
v_mfma_f32_16x16x32_bf16 v[24:27], a[16:19], a[40:43], v[24:27]
ds_read_b128 a[12:15], v225 offset:19456
v_mul_f32 v242, v14, v14
v_mfma_f32_16x16x32_bf16 v[24:27], a[20:23], a[56:59], v[24:27]
buffer_load_dwordx4 v226, s[20:23], s57 offen offset:2048 sc1 lds
v_mfma_f32_16x16x32_bf16 v[28:31], a[20:23], a[60:63], v[28:31]
v_fmaak_f32 v236, v228, v236, 0xc0135761
v_mul_f32 v243, v15, v15
v_mfma_f32_16x16x32_bf16 v[28:31], a[16:19], a[44:47], v[28:31]
v_fmaak_f32 v237, v228, v237, 0xc0135761
v_fmaak_f32 v240, v228, v240, 0xc0135761
v_mfma_f32_16x16x32_bf16 v[140:143], a[24:27], a[44:47], v[140:143]
ds_read_b128 a[16:19], v225 offset:20480
s_waitcnt lgkmcnt(4)
v_mfma_f32_16x16x32_bf16 v[140:143], a[28:31], a[60:63], v[140:143]
v_fmaak_f32 v238, v228, v238, 0xc0135761
v_fmaak_f32 v241, v228, v241, 0xc0135761
v_mfma_f32_16x16x32_bf16 v[136:139], a[28:31], a[56:59], v[136:139]
v_fmaak_f32 v239, v228, v239, 0xc0135761
v_fmaak_f32 v242, v228, v242, 0xc0135761
v_mfma_f32_16x16x32_bf16 v[136:139], a[24:27], a[40:43], v[136:139]
v_mul_f32 v236, v236, v4
v_fmaak_f32 v243, v228, v243, 0xc0135761
v_mfma_f32_16x16x32_bf16 v[132:135], a[24:27], a[36:39], v[132:135]
ds_read_b128 a[20:23], v225 offset:21504
v_mul_f32 v237, v237, v5
v_mfma_f32_16x16x32_bf16 v[132:135], a[28:31], a[52:55], v[132:135]
buffer_load_dwordx4 v226, s[20:23], s57 offen offset:3072 sc1 lds
v_mfma_f32_16x16x32_bf16 v[128:131], a[28:31], a[48:51], v[128:131]
v_mul_f32 v240, v240, v12
v_mul_f32 v238, v238, v6
v_mfma_f32_16x16x32_bf16 v[128:131], a[24:27], a[32:35], v[128:131]
v_mul_f32 v241, v241, v13
v_mul_f32 v239, v239, v7
v_mfma_f32_16x16x32_bf16 v[16:19], a[0:3], a[64:67], v[16:19]
ds_read_b128 a[24:27], v225 offset:22528
s_waitcnt lgkmcnt(4)
v_mfma_f32_16x16x32_bf16 v[16:19], a[4:7], a[80:83], v[16:19]
s_add_u32 s18, s42, 3145728
v_mul_f32 v242, v242, v14
v_mfma_f32_16x16x32_bf16 v[20:23], a[4:7], a[84:87], v[20:23]
buffer_store_dwordx4 v[244:247], v224, s[20:23], s18 offen sc1
v_mfma_f32_16x16x32_bf16 v[20:23], a[0:3], a[68:71], v[20:23]
v_exp_f32 v236, v236
v_mfma_f32_16x16x32_bf16 v[24:27], a[0:3], a[72:75], v[24:27]
ds_read_b128 a[28:31], v225 offset:23552
v_mul_f32 v243, v243, v15
v_mfma_f32_16x16x32_bf16 v[24:27], a[4:7], a[88:91], v[24:27]
s_add_u32 m0, s36, 49152
v_mul_f32 v116, v116, v4
v_mfma_f32_16x16x32_bf16 v[28:31], a[4:7], a[92:95], v[28:31]
s_add_u32 s57, s37, 409600
v_mfma_f32_16x16x32_bf16 v[28:31], a[0:3], a[76:79], v[28:31]
buffer_load_dwordx4 v226, s[20:23], s57 offen offset:0 sc1 lds
v_mfma_f32_16x16x32_bf16 v[140:143], a[8:11], a[76:79], v[140:143]
ds_read_b128 a[0:3], v225 offset:24576
s_waitcnt lgkmcnt(4)
v_mfma_f32_16x16x32_bf16 v[140:143], a[12:15], a[92:95], v[140:143]
v_exp_f32 v240, v240
v_mfma_f32_16x16x32_bf16 v[136:139], a[12:15], a[88:91], v[136:139]
v_exp_f32 v237, v237
v_mfma_f32_16x16x32_bf16 v[136:139], a[8:11], a[72:75], v[136:139]
v_mul_f32 v124, v124, v12
v_mul_f32 v117, v117, v5
v_mfma_f32_16x16x32_bf16 v[132:135], a[8:11], a[68:71], v[132:135]
ds_read_b128 a[4:7], v225 offset:25600
v_mfma_f32_16x16x32_bf16 v[132:135], a[12:15], a[84:87], v[132:135]
buffer_load_dwordx4 v226, s[20:23], s57 offen offset:1024 sc1 lds
v_mfma_f32_16x16x32_bf16 v[128:131], a[12:15], a[80:83], v[128:131]
v_exp_f32 v241, v241
v_mfma_f32_16x16x32_bf16 v[128:131], a[8:11], a[64:67], v[128:131]
v_exp_f32 v238, v238
v_mfma_f32_16x16x32_bf16 v[32:35], a[16:19], a[96:99], v[32:35]
ds_read_b128 a[8:11], v225 offset:26624
v_mul_f32 v125, v125, v13
s_waitcnt lgkmcnt(4)
v_mfma_f32_16x16x32_bf16 v[32:35], a[20:23], a[112:115], v[32:35]
s_add_u32 s18, s42, 3153920
v_mul_f32 v118, v118, v6
v_mfma_f32_16x16x32_bf16 v[36:39], a[20:23], a[116:119], v[36:39]
buffer_store_dwordx4 v[244:247], v224, s[20:23], s18 offen sc1
v_mfma_f32_16x16x32_bf16 v[36:39], a[16:19], a[100:103], v[36:39]
v_exp_f32 v242, v242
v_mfma_f32_16x16x32_bf16 v[40:43], a[16:19], a[104:107], v[40:43]
ds_read_b128 a[12:15], v225 offset:27648
v_exp_f32 v239, v239
v_mfma_f32_16x16x32_bf16 v[40:43], a[20:23], a[120:123], v[40:43]
buffer_load_dwordx4 v226, s[20:23], s57 offen offset:2048 sc1 lds
v_mfma_f32_16x16x32_bf16 v[44:47], a[20:23], a[124:127], v[44:47]
v_mul_f32 v126, v126, v14
v_exp_f32 v243, v243
v_mfma_f32_16x16x32_bf16 v[44:47], a[16:19], a[108:111], v[44:47]
v_mul_f32 v119, v119, v7
v_mul_f32 v127, v127, v15
v_mfma_f32_16x16x32_bf16 v[156:159], a[24:27], a[108:111], v[156:159]
ds_read_b128 a[16:19], v225 offset:28672
v_add_f32 v236, 1.0, v236
s_waitcnt lgkmcnt(4)
v_mfma_f32_16x16x32_bf16 v[156:159], a[28:31], a[124:127], v[156:159]
v_add_f32 v240, 1.0, v240
v_add_f32 v237, 1.0, v237
v_mfma_f32_16x16x32_bf16 v[152:155], a[28:31], a[120:123], v[152:155]
v_add_f32 v241, 1.0, v241
v_add_f32 v238, 1.0, v238
v_add_f32 v242, 1.0, v242
v_mfma_f32_16x16x32_bf16 v[152:155], a[24:27], a[104:107], v[152:155]
v_add_f32 v239, 1.0, v239
v_add_f32 v243, 1.0, v243
v_mfma_f32_16x16x32_bf16 v[148:151], a[24:27], a[100:103], v[148:151]
ds_read_b128 a[20:23], v225 offset:29696
v_rcp_f32 v236, v236
v_mfma_f32_16x16x32_bf16 v[148:151], a[28:31], a[116:119], v[148:151]
buffer_load_dwordx4 v226, s[20:23], s57 offen offset:3072 sc1 lds
v_mfma_f32_16x16x32_bf16 v[144:147], a[28:31], a[112:115], v[144:147]
v_rcp_f32 v240, v240
v_mfma_f32_16x16x32_bf16 v[144:147], a[24:27], a[96:99], v[144:147]
v_rcp_f32 v237, v237
v_mfma_f32_16x16x32_bf16 v[32:35], a[0:3], a[128:131], v[32:35]
ds_read_b128 a[24:27], v225 offset:30720
s_waitcnt lgkmcnt(4)
v_mfma_f32_16x16x32_bf16 v[32:35], a[4:7], a[144:147], v[32:35]
v_rcp_f32 v241, v241
v_mfma_f32_16x16x32_bf16 v[36:39], a[4:7], a[148:151], v[36:39]
v_rcp_f32 v238, v238
v_mfma_f32_16x16x32_bf16 v[36:39], a[0:3], a[132:135], v[36:39]
s_barrier
v_mfma_f32_16x16x32_bf16 v[40:43], a[0:3], a[136:139], v[40:43]
ds_read_b128 a[28:31], v225 offset:31744
v_rcp_f32 v242, v242
v_mfma_f32_16x16x32_bf16 v[40:43], a[4:7], a[152:155], v[40:43]
v_rcp_f32 v239, v239
v_mfma_f32_16x16x32_bf16 v[44:47], a[4:7], a[156:159], v[44:47]
v_rcp_f32 v243, v243
v_mul_f32 v116, v116, v236
v_mfma_f32_16x16x32_bf16 v[44:47], a[0:3], a[140:143], v[44:47]
v_mul_f32 v124, v124, v240
v_mul_f32 v117, v117, v237
v_mfma_f32_16x16x32_bf16 v[156:159], a[8:11], a[140:143], v[156:159]
ds_read_b128 a[0:3], v225 offset:32768
v_mul_f32 v125, v125, v241
s_waitcnt lgkmcnt(4)
v_mfma_f32_16x16x32_bf16 v[156:159], a[12:15], a[156:159], v[156:159]
v_mul_f32 v118, v118, v238
v_mul_f32 v126, v126, v242
v_mfma_f32_16x16x32_bf16 v[152:155], a[12:15], a[152:155], v[152:155]
v_mul_f32 v119, v119, v239
v_mul_f32 v127, v127, v243
v_cvt_pk_bf16_f32 v2, v116, v117
v_mfma_f32_16x16x32_bf16 v[152:155], a[8:11], a[136:139], v[152:155]
v_cvt_pk_bf16_f32 v10, v124, v125
v_cvt_pk_bf16_f32 v3, v118, v119
v_mfma_f32_16x16x32_bf16 v[148:151], a[8:11], a[132:135], v[148:151]
ds_read_b128 a[4:7], v225 offset:33792
v_cvt_pk_bf16_f32 v11, v126, v127
s_add_u32 s16, s41, 0
v_mfma_f32_16x16x32_bf16 v[148:151], a[12:15], a[148:151], v[148:151]
v_permlane32_swap_b32 v0, v2
v_mfma_f32_16x16x32_bf16 v[144:147], a[12:15], a[144:147], v[144:147]
v_permlane32_swap_b32 v1, v3
s_add_u32 s59, s41, 229376
v_mfma_f32_16x16x32_bf16 v[144:147], a[8:11], a[128:131], v[144:147]
buffer_store_dwordx4 v[0:3], v227, s[20:23], s16 offen sc1
v_mfma_f32_16x16x32_bf16 v[32:35], a[16:19], a[160:163], v[32:35]
ds_read_b128 a[8:11], v225 offset:34816
v_mul_f32 v236, v16, v16
s_waitcnt lgkmcnt(4)
v_mfma_f32_16x16x32_bf16 v[32:35], a[20:23], a[176:179], v[32:35]
v_permlane32_swap_b32 v8, v10
v_mfma_f32_16x16x32_bf16 v[36:39], a[20:23], a[180:183], v[36:39]
v_permlane32_swap_b32 v9, v11
v_mul_f32 v237, v17, v17
v_mfma_f32_16x16x32_bf16 v[36:39], a[16:19], a[164:167], v[36:39]
buffer_store_dwordx4 v[8:11], v227, s[20:23], s59 offen sc1
v_mfma_f32_16x16x32_bf16 v[40:43], a[16:19], a[168:171], v[40:43]
ds_read_b128 a[12:15], v225 offset:35840
v_mul_f32 v238, v18, v18
v_mul_f32 v240, v24, v24
v_mfma_f32_16x16x32_bf16 v[40:43], a[20:23], a[184:187], v[40:43]
v_mul_f32 v239, v19, v19
v_mul_f32 v241, v25, v25
v_mfma_f32_16x16x32_bf16 v[44:47], a[20:23], a[188:191], v[44:47]
v_fmaak_f32 v236, v228, v236, 0xc0135761
v_mul_f32 v242, v26, v26
v_fmaak_f32 v237, v228, v237, 0xc0135761
v_mfma_f32_16x16x32_bf16 v[44:47], a[16:19], a[172:175], v[44:47]
v_mul_f32 v243, v27, v27
v_fmaak_f32 v238, v228, v238, 0xc0135761
v_mfma_f32_16x16x32_bf16 v[156:159], a[24:27], a[172:175], v[156:159]
ds_read_b128 a[16:19], v225 offset:36864
v_fmaak_f32 v240, v228, v240, 0xc0135761
s_waitcnt lgkmcnt(4)
v_mfma_f32_16x16x32_bf16 v[156:159], a[28:31], a[188:191], v[156:159]
v_fmaak_f32 v239, v228, v239, 0xc0135761
v_fmaak_f32 v241, v228, v241, 0xc0135761
v_mfma_f32_16x16x32_bf16 v[152:155], a[28:31], a[184:187], v[152:155]
v_mul_f32 v236, v236, v16
v_fmaak_f32 v242, v228, v242, 0xc0135761
v_mfma_f32_16x16x32_bf16 v[152:155], a[24:27], a[168:171], v[152:155]
v_mul_f32 v237, v237, v17
v_fmaak_f32 v243, v228, v243, 0xc0135761
v_mfma_f32_16x16x32_bf16 v[148:151], a[24:27], a[164:167], v[148:151]
ds_read_b128 a[20:23], v225 offset:37888
v_mul_f32 v238, v238, v18
v_mfma_f32_16x16x32_bf16 v[148:151], a[28:31], a[180:183], v[148:151]
v_mul_f32 v240, v240, v24
v_mul_f32 v239, v239, v19
v_mfma_f32_16x16x32_bf16 v[144:147], a[28:31], a[176:179], v[144:147]
v_exp_f32 v236, v236
v_mfma_f32_16x16x32_bf16 v[144:147], a[24:27], a[160:163], v[144:147]
v_mul_f32 v241, v241, v25
v_mul_f32 v128, v128, v16
v_mfma_f32_16x16x32_bf16 v[32:35], a[0:3], a[192:195], v[32:35]
ds_read_b128 a[24:27], v225 offset:38912
s_waitcnt lgkmcnt(4)
v_mfma_f32_16x16x32_bf16 v[32:35], a[4:7], a[208:211], v[32:35]
v_exp_f32 v237, v237
v_mfma_f32_16x16x32_bf16 v[36:39], a[4:7], a[212:215], v[36:39]
v_mul_f32 v242, v242, v26
v_mul_f32 v129, v129, v17
v_mfma_f32_16x16x32_bf16 v[36:39], a[0:3], a[196:199], v[36:39]
v_exp_f32 v238, v238
v_mfma_f32_16x16x32_bf16 v[40:43], a[0:3], a[200:203], v[40:43]
ds_read_b128 a[28:31], v225 offset:39936
v_mul_f32 v243, v243, v27
v_mfma_f32_16x16x32_bf16 v[40:43], a[4:7], a[216:219], v[40:43]
v_exp_f32 v240, v240
v_mfma_f32_16x16x32_bf16 v[44:47], a[4:7], a[220:223], v[44:47]
v_mul_f32 v130, v130, v18
v_mul_f32 v136, v136, v24
v_mfma_f32_16x16x32_bf16 v[44:47], a[0:3], a[204:207], v[44:47]
v_exp_f32 v239, v239
v_mfma_f32_16x16x32_bf16 v[156:159], a[8:11], a[204:207], v[156:159]
ds_read_b128 a[0:3], v225 offset:40960
s_waitcnt lgkmcnt(4)
v_mfma_f32_16x16x32_bf16 v[156:159], a[12:15], a[220:223], v[156:159]
v_exp_f32 v241, v241
v_mfma_f32_16x16x32_bf16 v[152:155], a[12:15], a[216:219], v[152:155]
v_mul_f32 v131, v131, v19
v_mul_f32 v137, v137, v25
v_mfma_f32_16x16x32_bf16 v[152:155], a[8:11], a[200:203], v[152:155]
v_exp_f32 v242, v242
v_mfma_f32_16x16x32_bf16 v[148:151], a[8:11], a[196:199], v[148:151]
ds_read_b128 a[4:7], v225 offset:41984
v_add_f32 v236, 1.0, v236
v_mfma_f32_16x16x32_bf16 v[148:151], a[12:15], a[212:215], v[148:151]
v_mul_f32 v138, v138, v26
v_add_f32 v237, 1.0, v237
v_mfma_f32_16x16x32_bf16 v[144:147], a[12:15], a[208:211], v[144:147]
v_exp_f32 v243, v243
v_mfma_f32_16x16x32_bf16 v[144:147], a[8:11], a[192:195], v[144:147]
v_add_f32 v238, 1.0, v238
v_mul_f32 v139, v139, v27
v_mfma_f32_16x16x32_bf16 v[32:35], a[16:19], a[224:227], v[32:35]
ds_read_b128 a[8:11], v225 offset:43008
s_waitcnt lgkmcnt(4)
v_mfma_f32_16x16x32_bf16 v[32:35], a[20:23], a[240:243], v[32:35]
v_add_f32 v239, 1.0, v239
v_add_f32 v240, 1.0, v240
v_mfma_f32_16x16x32_bf16 v[36:39], a[20:23], a[244:247], v[36:39]
v_rcp_f32 v236, v236
v_mfma_f32_16x16x32_bf16 v[36:39], a[16:19], a[228:231], v[36:39]
v_rcp_f32 v237, v237
v_mfma_f32_16x16x32_bf16 v[40:43], a[16:19], a[232:235], v[40:43]
ds_read_b128 a[12:15], v225 offset:44032
v_add_f32 v241, 1.0, v241
v_mfma_f32_16x16x32_bf16 v[40:43], a[20:23], a[248:251], v[40:43]
v_rcp_f32 v238, v238
v_mfma_f32_16x16x32_bf16 v[44:47], a[20:23], a[252:255], v[44:47]
v_rcp_f32 v239, v239
v_mfma_f32_16x16x32_bf16 v[44:47], a[16:19], a[236:239], v[44:47]
v_add_f32 v242, 1.0, v242
v_mul_f32 v128, v128, v236
v_mfma_f32_16x16x32_bf16 v[156:159], a[24:27], a[236:239], v[156:159]
ds_read_b128 a[16:19], v225 offset:45056
s_waitcnt lgkmcnt(4)
v_mfma_f32_16x16x32_bf16 v[156:159], a[28:31], a[252:255], v[156:159]
v_add_f32 v243, 1.0, v243
v_mul_f32 v129, v129, v237
v_mfma_f32_16x16x32_bf16 v[152:155], a[28:31], a[248:251], v[152:155]
v_rcp_f32 v240, v240
v_mfma_f32_16x16x32_bf16 v[152:155], a[24:27], a[232:235], v[152:155]
v_rcp_f32 v241, v241
v_mfma_f32_16x16x32_bf16 v[148:151], a[24:27], a[228:231], v[148:151]
ds_read_b128 a[20:23], v225 offset:46080
v_mul_f32 v130, v130, v238
v_mfma_f32_16x16x32_bf16 v[148:151], a[28:31], a[244:247], v[148:151]
v_rcp_f32 v242, v242
v_mfma_f32_16x16x32_bf16 v[144:147], a[28:31], a[240:243], v[144:147]
v_rcp_f32 v243, v243
v_mfma_f32_16x16x32_bf16 v[144:147], a[24:27], a[224:227], v[144:147]
v_mul_f32 v131, v131, v239
v_mul_f32 v136, v136, v240
v_mfma_f32_16x16x32_bf16 v[32:35], a[0:3], a[32:35], v[32:35]
ds_read_b128 a[24:27], v225 offset:47104
s_waitcnt lgkmcnt(4)
v_mfma_f32_16x16x32_bf16 v[32:35], a[4:7], a[48:51], v[32:35]
v_cvt_pk_bf16_f32 v16, v128, v129
v_mul_f32 v137, v137, v241
v_mfma_f32_16x16x32_bf16 v[36:39], a[4:7], a[52:55], v[36:39]
v_cvt_pk_bf16_f32 v17, v130, v131
v_mul_f32 v138, v138, v242
v_mfma_f32_16x16x32_bf16 v[36:39], a[0:3], a[36:39], v[36:39]
v_mul_f32 v236, v20, v20
s_barrier
v_mfma_f32_16x16x32_bf16 v[40:43], a[0:3], a[40:43], v[40:43]
ds_read_b128 a[28:31], v225 offset:48128
v_mul_f32 v139, v139, v243
v_mfma_f32_16x16x32_bf16 v[40:43], a[4:7], a[56:59], v[40:43]
v_mul_f32 v237, v21, v21
v_cvt_pk_bf16_f32 v24, v136, v137
v_mfma_f32_16x16x32_bf16 v[44:47], a[4:7], a[60:63], v[44:47]
v_mul_f32 v238, v22, v22
v_cvt_pk_bf16_f32 v25, v138, v139
v_mfma_f32_16x16x32_bf16 v[44:47], a[0:3], a[44:47], v[44:47]
v_mul_f32 v239, v23, v23
v_mul_f32 v240, v28, v28
buffer_load_dword v234, v229, s[20:23], s48 offen sc1
v_mfma_f32_16x16x32_bf16 v[156:159], a[8:11], a[44:47], v[156:159]
ds_read_b128 a[0:3], v225 offset:49152
s_waitcnt lgkmcnt(4)
v_mfma_f32_16x16x32_bf16 v[156:159], a[12:15], a[60:63], v[156:159]
v_fmaak_f32 v236, v228, v236, 0xc0135761
v_mul_f32 v241, v29, v29
v_mfma_f32_16x16x32_bf16 v[152:155], a[12:15], a[56:59], v[152:155]
v_fmaak_f32 v237, v228, v237, 0xc0135761
v_mul_f32 v242, v30, v30
v_mfma_f32_16x16x32_bf16 v[152:155], a[8:11], a[40:43], v[152:155]
v_fmaak_f32 v238, v228, v238, 0xc0135761
v_mul_f32 v243, v31, v31
v_mfma_f32_16x16x32_bf16 v[148:151], a[8:11], a[36:39], v[148:151]
ds_read_b128 a[4:7], v225 offset:50176
v_fmaak_f32 v239, v228, v239, 0xc0135761
v_mfma_f32_16x16x32_bf16 v[148:151], a[12:15], a[52:55], v[148:151]
v_fmaak_f32 v240, v228, v240, 0xc0135761
v_mul_f32 v236, v236, v20
v_mfma_f32_16x16x32_bf16 v[144:147], a[12:15], a[48:51], v[144:147]
v_fmaak_f32 v241, v228, v241, 0xc0135761
v_mul_f32 v237, v237, v21
v_mfma_f32_16x16x32_bf16 v[144:147], a[8:11], a[32:35], v[144:147]
v_fmaak_f32 v242, v228, v242, 0xc0135761
v_mul_f32 v238, v238, v22
v_mfma_f32_16x16x32_bf16 v[32:35], a[16:19], a[64:67], v[32:35]
ds_read_b128 a[8:11], v225 offset:51200
s_waitcnt lgkmcnt(4)
v_mfma_f32_16x16x32_bf16 v[32:35], a[20:23], a[80:83], v[32:35]
v_fmaak_f32 v243, v228, v243, 0xc0135761
v_mul_f32 v239, v239, v23
v_mfma_f32_16x16x32_bf16 v[36:39], a[20:23], a[84:87], v[36:39]
v_exp_f32 v236, v236
v_mfma_f32_16x16x32_bf16 v[36:39], a[16:19], a[68:71], v[36:39]
v_mul_f32 v240, v240, v28
v_mul_f32 v132, v132, v20
v_mfma_f32_16x16x32_bf16 v[40:43], a[16:19], a[72:75], v[40:43]
ds_read_b128 a[12:15], v225 offset:52224
v_mul_f32 v241, v241, v29
v_mfma_f32_16x16x32_bf16 v[40:43], a[20:23], a[88:91], v[40:43]
v_exp_f32 v237, v237
v_mfma_f32_16x16x32_bf16 v[44:47], a[20:23], a[92:95], v[44:47]
v_mul_f32 v242, v242, v30
v_mul_f32 v133, v133, v21
v_mfma_f32_16x16x32_bf16 v[44:47], a[16:19], a[76:79], v[44:47]
v_exp_f32 v238, v238
v_mfma_f32_16x16x32_bf16 v[156:159], a[24:27], a[76:79], v[156:159]
ds_read_b128 a[16:19], v225 offset:53248
s_waitcnt lgkmcnt(4)
v_mfma_f32_16x16x32_bf16 v[156:159], a[28:31], a[92:95], v[156:159]
v_mul_f32 v243, v243, v31
v_mul_f32 v134, v134, v22
v_mfma_f32_16x16x32_bf16 v[152:155], a[28:31], a[88:91], v[152:155]
v_exp_f32 v240, v240
v_mfma_f32_16x16x32_bf16 v[152:155], a[24:27], a[72:75], v[152:155]
v_exp_f32 v239, v239
v_mfma_f32_16x16x32_bf16 v[148:151], a[24:27], a[68:71], v[148:151]
ds_read_b128 a[20:23], v225 offset:54272
v_mul_f32 v140, v140, v28
v_mfma_f32_16x16x32_bf16 v[148:151], a[28:31], a[84:87], v[148:151]
v_exp_f32 v241, v241
v_mfma_f32_16x16x32_bf16 v[144:147], a[28:31], a[80:83], v[144:147]
v_mul_f32 v135, v135, v23
v_mul_f32 v141, v141, v29
v_mfma_f32_16x16x32_bf16 v[144:147], a[24:27], a[64:67], v[144:147]
v_exp_f32 v242, v242
v_mfma_f32_16x16x32_bf16 v[48:51], a[0:3], a[96:99], v[48:51]
ds_read_b128 a[24:27], v225 offset:55296
v_add_f32 v236, 1.0, v236
s_waitcnt lgkmcnt(4)
v_mfma_f32_16x16x32_bf16 v[48:51], a[4:7], a[112:115], v[48:51]
v_mul_f32 v142, v142, v30
v_add_f32 v237, 1.0, v237
v_mfma_f32_16x16x32_bf16 v[52:55], a[4:7], a[116:119], v[52:55]
v_exp_f32 v243, v243
v_add_f32 v238, 1.0, v238
v_mfma_f32_16x16x32_bf16 v[52:55], a[0:3], a[100:103], v[52:55]
v_mul_f32 v143, v143, v31
v_add_f32 v239, 1.0, v239
v_mfma_f32_16x16x32_bf16 v[56:59], a[0:3], a[104:107], v[56:59]
ds_read_b128 a[28:31], v225 offset:56320
v_rcp_f32 v236, v236
v_mfma_f32_16x16x32_bf16 v[56:59], a[4:7], a[120:123], v[56:59]
v_rcp_f32 v237, v237
v_mfma_f32_16x16x32_bf16 v[60:63], a[4:7], a[124:127], v[60:63]
v_rcp_f32 v238, v238
v_add_f32 v240, 1.0, v240
v_mfma_f32_16x16x32_bf16 v[60:63], a[0:3], a[108:111], v[60:63]
v_rcp_f32 v239, v239
v_mfma_f32_16x16x32_bf16 v[172:175], a[8:11], a[108:111], v[172:175]
ds_read_b128 a[0:3], v225 offset:57344
v_add_f32 v241, 1.0, v241
s_waitcnt lgkmcnt(4)
v_mfma_f32_16x16x32_bf16 v[172:175], a[12:15], a[124:127], v[172:175]
v_mul_f32 v132, v132, v236
v_add_f32 v242, 1.0, v242
v_mfma_f32_16x16x32_bf16 v[168:171], a[12:15], a[120:123], v[168:171]
v_mul_f32 v133, v133, v237
v_add_f32 v243, 1.0, v243
v_mul_f32 v134, v134, v238
v_mfma_f32_16x16x32_bf16 v[168:171], a[8:11], a[104:107], v[168:171]
v_rcp_f32 v240, v240
v_mfma_f32_16x16x32_bf16 v[164:167], a[8:11], a[100:103], v[164:167]
ds_read_b128 a[4:7], v225 offset:58368
v_rcp_f32 v241, v241
v_mfma_f32_16x16x32_bf16 v[164:167], a[12:15], a[116:119], v[164:167]
v_rcp_f32 v242, v242
v_mfma_f32_16x16x32_bf16 v[160:163], a[12:15], a[112:115], v[160:163]
v_rcp_f32 v243, v243
v_mul_f32 v135, v135, v239
v_mfma_f32_16x16x32_bf16 v[160:163], a[8:11], a[96:99], v[160:163]
v_mul_f32 v140, v140, v240
v_cvt_pk_bf16_f32 v18, v132, v133
s_waitcnt vmcnt(0)
v_cmp_ne_u32 vcc, v253, v234
s_nop 0
s_and_b32 s14, vcc_hi, 0xffffff
s_or_b32 s14, s14, vcc_lo
s_cbranch_scc1 L_poll6
L_poll6_ok:
v_mfma_f32_16x16x32_bf16 v[48:51], a[16:19], a[128:131], v[48:51]
ds_read_b128 a[8:11], v225 offset:59392
v_mul_f32 v141, v141, v241
s_waitcnt lgkmcnt(4)
v_mfma_f32_16x16x32_bf16 v[48:51], a[20:23], a[144:147], v[48:51]
v_cvt_pk_bf16_f32 v19, v134, v135
v_mul_f32 v142, v142, v242
v_mfma_f32_16x16x32_bf16 v[52:55], a[20:23], a[148:151], v[52:55]
s_add_u32 s16, s41, 8192
v_permlane32_swap_b32 v16, v18
v_mfma_f32_16x16x32_bf16 v[52:55], a[16:19], a[132:135], v[52:55]
v_permlane32_swap_b32 v17, v19
v_mfma_f32_16x16x32_bf16 v[56:59], a[16:19], a[136:139], v[56:59]
ds_read_b128 a[12:15], v225 offset:60416
buffer_store_dwordx4 v[16:19], v227, s[20:23], s16 offen sc1
v_mfma_f32_16x16x32_bf16 v[56:59], a[20:23], a[152:155], v[56:59]
s_add_u32 m0, s36, 65536
v_mul_f32 v143, v143, v243
v_mfma_f32_16x16x32_bf16 v[60:63], a[20:23], a[156:159], v[60:63]
s_add_u32 s57, s92, 0
v_mul_f32 v236, v32, v32
v_cvt_pk_bf16_f32 v26, v140, v141
v_mfma_f32_16x16x32_bf16 v[60:63], a[16:19], a[140:143], v[60:63]
buffer_load_dwordx4 v226, s[20:23], s57 offen offset:0 sc1 lds
v_mfma_f32_16x16x32_bf16 v[172:175], a[24:27], a[140:143], v[172:175]
ds_read_b128 a[16:19], v225 offset:61440
v_mul_f32 v237, v33, v33
s_waitcnt lgkmcnt(4)
v_mfma_f32_16x16x32_bf16 v[172:175], a[28:31], a[156:159], v[172:175]
v_cvt_pk_bf16_f32 v27, v142, v143
v_mul_f32 v238, v34, v34
v_mfma_f32_16x16x32_bf16 v[168:171], a[28:31], a[152:155], v[168:171]
s_add_u32 s59, s41, 237568
v_permlane32_swap_b32 v24, v26
v_mfma_f32_16x16x32_bf16 v[168:171], a[24:27], a[136:139], v[168:171]
v_permlane32_swap_b32 v25, v27
v_mfma_f32_16x16x32_bf16 v[164:167], a[24:27], a[132:135], v[164:167]
ds_read_b128 a[20:23], v225 offset:62464
buffer_store_dwordx4 v[24:27], v227, s[20:23], s59 offen sc1
v_mfma_f32_16x16x32_bf16 v[164:167], a[28:31], a[148:151], v[164:167]
buffer_load_dwordx4 v226, s[20:23], s57 offen offset:1024 sc1 lds
v_mfma_f32_16x16x32_bf16 v[160:163], a[28:31], a[144:147], v[160:163]
v_mul_f32 v239, v35, v35
v_mul_f32 v240, v40, v40
v_fmaak_f32 v236, v228, v236, 0xc0135761
v_mfma_f32_16x16x32_bf16 v[160:163], a[24:27], a[128:131], v[160:163]
v_mul_f32 v241, v41, v41
v_fmaak_f32 v237, v228, v237, 0xc0135761
v_mfma_f32_16x16x32_bf16 v[48:51], a[0:3], a[160:163], v[48:51]
ds_read_b128 a[24:27], v225 offset:63488
v_mul_f32 v242, v42, v42
s_waitcnt lgkmcnt(4)
v_mfma_f32_16x16x32_bf16 v[48:51], a[4:7], a[176:179], v[48:51]
buffer_load_dwordx4 v226, s[20:23], s57 offen offset:2048 sc1 lds
v_mfma_f32_16x16x32_bf16 v[52:55], a[4:7], a[180:183], v[52:55]
v_fmaak_f32 v238, v228, v238, 0xc0135761
v_mul_f32 v243, v43, v43
v_fmaak_f32 v239, v228, v239, 0xc0135761
v_mfma_f32_16x16x32_bf16 v[52:55], a[0:3], a[164:167], v[52:55]
v_fmaak_f32 v240, v228, v240, 0xc0135761
s_barrier
v_mfma_f32_16x16x32_bf16 v[56:59], a[0:3], a[168:171], v[56:59]
ds_read_b128 a[28:31], v225 offset:64512
v_mul_f32 v236, v236, v32
v_fmaak_f32 v241, v228, v241, 0xc0135761
v_mfma_f32_16x16x32_bf16 v[56:59], a[4:7], a[184:187], v[56:59]
buffer_load_dwordx4 v226, s[20:23], s57 offen offset:3072 sc1 lds
v_mfma_f32_16x16x32_bf16 v[60:63], a[4:7], a[188:191], v[60:63]
v_mul_f32 v237, v237, v33
v_fmaak_f32 v242, v228, v242, 0xc0135761
v_mfma_f32_16x16x32_bf16 v[60:63], a[0:3], a[172:175], v[60:63]
v_mul_f32 v238, v238, v34
v_fmaak_f32 v243, v228, v243, 0xc0135761
v_mfma_f32_16x16x32_bf16 v[172:175], a[8:11], a[172:175], v[172:175]
ds_read_b128 a[0:3], v224 offset:0
s_waitcnt lgkmcnt(4)
v_mfma_f32_16x16x32_bf16 v[172:175], a[12:15], a[188:191], v[172:175]
s_add_u32 m0, s36, 81920
v_mul_f32 v239, v239, v35
v_mfma_f32_16x16x32_bf16 v[168:171], a[12:15], a[184:187], v[168:171]
s_add_u32 s57, s92, 16384
v_mul_f32 v240, v240, v40
v_mfma_f32_16x16x32_bf16 v[168:171], a[8:11], a[168:171], v[168:171]
buffer_load_dwordx4 v226, s[20:23], s57 offen offset:0 sc1 lds
v_mfma_f32_16x16x32_bf16 v[164:167], a[8:11], a[164:167], v[164:167]
ds_read_b128 a[4:7], v224 offset:1024
v_mul_f32 v241, v241, v41
v_mfma_f32_16x16x32_bf16 v[164:167], a[12:15], a[180:183], v[164:167]
v_exp_f32 v236, v236
v_mfma_f32_16x16x32_bf16 v[160:163], a[12:15], a[176:179], v[160:163]
v_mul_f32 v242, v242, v42
v_mul_f32 v144, v144, v32
v_mfma_f32_16x16x32_bf16 v[160:163], a[8:11], a[160:163], v[160:163]
v_exp_f32 v237, v237
v_mfma_f32_16x16x32_bf16 v[48:51], a[16:19], a[192:195], v[48:51]
ds_read_b128 a[8:11], v224 offset:2048
s_waitcnt lgkmcnt(4)
v_mfma_f32_16x16x32_bf16 v[48:51], a[20:23], a[208:211], v[48:51]
buffer_load_dwordx4 v226, s[20:23], s57 offen offset:1024 sc1 lds
v_mfma_f32_16x16x32_bf16 v[52:55], a[20:23], a[212:215], v[52:55]
v_mul_f32 v243, v243, v43
v_mul_f32 v145, v145, v33
v_mfma_f32_16x16x32_bf16 v[52:55], a[16:19], a[196:199], v[52:55]
v_exp_f32 v240, v240
v_mfma_f32_16x16x32_bf16 v[56:59], a[16:19], a[200:203], v[56:59]
ds_read_b128 a[12:15], v224 offset:3072
v_mul_f32 v152, v152, v40
v_mfma_f32_16x16x32_bf16 v[56:59], a[20:23], a[216:219], v[56:59]
buffer_load_dwordx4 v226, s[20:23], s57 offen offset:2048 sc1 lds
v_mfma_f32_16x16x32_bf16 v[60:63], a[20:23], a[220:223], v[60:63]
v_exp_f32 v238, v238
v_mfma_f32_16x16x32_bf16 v[60:63], a[16:19], a[204:207], v[60:63]
v_exp_f32 v241, v241
v_mfma_f32_16x16x32_bf16 v[172:175], a[24:27], a[204:207], v[172:175]
ds_read_b128 a[16:19], v224 offset:4096
s_waitcnt lgkmcnt(4)
v_mfma_f32_16x16x32_bf16 v[172:175], a[28:31], a[220:223], v[172:175]
buffer_load_dwordx4 v226, s[20:23], s57 offen offset:3072 sc1 lds
v_mfma_f32_16x16x32_bf16 v[168:171], a[28:31], a[216:219], v[168:171]
v_mul_f32 v146, v146, v34
v_mul_f32 v153, v153, v41
v_mfma_f32_16x16x32_bf16 v[168:171], a[24:27], a[200:203], v[168:171]
v_exp_f32 v239, v239
v_mfma_f32_16x16x32_bf16 v[164:167], a[24:27], a[196:199], v[164:167]
ds_read_b128 a[20:23], v224 offset:5120
v_mul_f32 v147, v147, v35
v_mfma_f32_16x16x32_bf16 v[164:167], a[28:31], a[212:215], v[164:167]
s_add_u32 m0, s36, 98304
v_add_f32 v236, 1.0, v236
v_mfma_f32_16x16x32_bf16 v[160:163], a[28:31], a[208:211], v[160:163]
s_add_u32 s57, s93, 32768
v_add_f32 v237, 1.0, v237
v_mfma_f32_16x16x32_bf16 v[160:163], a[24:27], a[192:195], v[160:163]
buffer_load_dwordx4 v226, s[20:23], s57 offen offset:0 sc1 lds
v_mfma_f32_16x16x32_bf16 v[48:51], a[0:3], a[224:227], v[48:51]
ds_read_b128 a[24:27], v224 offset:6144
s_waitcnt lgkmcnt(4)
v_mfma_f32_16x16x32_bf16 v[48:51], a[4:7], a[240:243], v[48:51]
v_exp_f32 v242, v242
v_mfma_f32_16x16x32_bf16 v[52:55], a[4:7], a[244:247], v[52:55]
v_add_f32 v238, 1.0, v238
v_mul_f32 v154, v154, v42
v_mfma_f32_16x16x32_bf16 v[52:55], a[0:3], a[228:231], v[52:55]
v_exp_f32 v243, v243
v_mfma_f32_16x16x32_bf16 v[56:59], a[0:3], a[232:235], v[56:59]
ds_read_b128 a[28:31], v224 offset:7168
v_add_f32 v239, 1.0, v239
v_mfma_f32_16x16x32_bf16 v[56:59], a[4:7], a[248:251], v[56:59]
buffer_load_dwordx4 v226, s[20:23], s57 offen offset:1024 sc1 lds
v_mfma_f32_16x16x32_bf16 v[60:63], a[4:7], a[252:255], v[60:63]
v_rcp_f32 v236, v236
v_mfma_f32_16x16x32_bf16 v[60:63], a[0:3], a[236:239], v[60:63]
v_rcp_f32 v237, v237
v_mfma_f32_16x16x32_bf16 v[172:175], a[8:11], a[236:239], v[172:175]
ds_read_b128 a[0:3], v224 offset:8192
s_waitcnt lgkmcnt(4)
v_mfma_f32_16x16x32_bf16 v[172:175], a[12:15], a[252:255], v[172:175]
buffer_load_dwordx4 v226, s[20:23], s57 offen offset:2048 sc1 lds
v_mfma_f32_16x16x32_bf16 v[168:171], a[12:15], a[248:251], v[168:171]
v_rcp_f32 v238, v238
v_mfma_f32_16x16x32_bf16 v[168:171], a[8:11], a[232:235], v[168:171]
v_rcp_f32 v239, v239
s_waitcnt vmcnt(10)
s_mov_b64 exec, 1
buffer_store_dword v253, off, s[20:23], s45 sc1
s_mov_b64 exec, -1
s_add_u32 s45, s45, 0x4000
v_mfma_f32_16x16x32_bf16 v[164:167], a[8:11], a[228:231], v[164:167]
ds_read_b128 a[4:7], v224 offset:9216
v_mul_f32 v155, v155, v43
v_mfma_f32_16x16x32_bf16 v[164:167], a[12:15], a[244:247], v[164:167]
buffer_load_dwordx4 v226, s[20:23], s57 offen offset:3072 sc1 lds
v_mfma_f32_16x16x32_bf16 v[160:163], a[12:15], a[240:243], v[160:163]
v_mul_f32 v144, v144, v236
v_add_f32 v240, 1.0, v240
v_mfma_f32_16x16x32_bf16 v[160:163], a[8:11], a[224:227], v[160:163]
v_mul_f32 v145, v145, v237
v_add_f32 v241, 1.0, v241
v_mfma_f32_16x16x32_bf16 v[48:51], a[16:19], a[32:35], v[48:51]
ds_read_b128 a[8:11], v224 offset:10240
s_waitcnt lgkmcnt(4)
v_mfma_f32_16x16x32_bf16 v[48:51], a[20:23], a[48:51], v[48:51]
v_mul_f32 v146, v146, v238
v_add_f32 v242, 1.0, v242
v_mfma_f32_16x16x32_bf16 v[52:55], a[20:23], a[52:55], v[52:55]
v_mul_f32 v147, v147, v239
v_add_f32 v243, 1.0, v243
v_mfma_f32_16x16x32_bf16 v[52:55], a[16:19], a[36:39], v[52:55]
v_rcp_f32 v240, v240
v_mfma_f32_16x16x32_bf16 v[56:59], a[16:19], a[40:43], v[56:59]
ds_read_b128 a[12:15], v224 offset:11264
v_cvt_pk_bf16_f32 v32, v144, v145
v_mfma_f32_16x16x32_bf16 v[56:59], a[20:23], a[56:59], v[56:59]
v_rcp_f32 v241, v241
v_mfma_f32_16x16x32_bf16 v[60:63], a[20:23], a[60:63], v[60:63]
v_rcp_f32 v242, v242
v_mfma_f32_16x16x32_bf16 v[60:63], a[16:19], a[44:47], v[60:63]
v_rcp_f32 v243, v243
s_mov_b32 exec_hi, 0
buffer_store_dword v253, v235, s[20:23], s49 offen sc1
s_mov_b32 exec_hi, -1
s_add_u32 s49, s49, 0x20000
v_mfma_f32_16x16x32_bf16 v[172:175], a[24:27], a[44:47], v[172:175]
ds_read_b128 a[16:19], v224 offset:12288
s_waitcnt lgkmcnt(4)
v_mfma_f32_16x16x32_bf16 v[172:175], a[28:31], a[60:63], v[172:175]
v_cvt_pk_bf16_f32 v33, v146, v147
v_mul_f32 v152, v152, v240
v_mfma_f32_16x16x32_bf16 v[168:171], a[28:31], a[56:59], v[168:171]
v_mul_f32 v236, v36, v36
v_mul_f32 v153, v153, v241
v_mfma_f32_16x16x32_bf16 v[168:171], a[24:27], a[40:43], v[168:171]
v_mul_f32 v237, v37, v37
v_mul_f32 v154, v154, v242
v_mfma_f32_16x16x32_bf16 v[164:167], a[24:27], a[36:39], v[164:167]
ds_read_b128 a[20:23], v224 offset:13312
v_mul_f32 v238, v38, v38
v_mfma_f32_16x16x32_bf16 v[164:167], a[28:31], a[52:55], v[164:167]
v_mul_f32 v155, v155, v243
v_mul_f32 v239, v39, v39
v_mfma_f32_16x16x32_bf16 v[160:163], a[28:31], a[48:51], v[160:163]
v_cvt_pk_bf16_f32 v40, v152, v153
v_fmaak_f32 v236, v228, v236, 0xc0135761
v_mfma_f32_16x16x32_bf16 v[160:163], a[24:27], a[32:35], v[160:163]
v_cvt_pk_bf16_f32 v41, v154, v155
v_fmaak_f32 v237, v228, v237, 0xc0135761
v_mfma_f32_16x16x32_bf16 v[48:51], a[0:3], a[64:67], v[48:51]
ds_read_b128 a[24:27], v224 offset:14336
s_waitcnt lgkmcnt(4)
v_mfma_f32_16x16x32_bf16 v[48:51], a[4:7], a[80:83], v[48:51]
v_mul_f32 v240, v44, v44
v_fmaak_f32 v238, v228, v238, 0xc0135761
v_mfma_f32_16x16x32_bf16 v[52:55], a[4:7], a[84:87], v[52:55]
v_mul_f32 v241, v45, v45
v_fmaak_f32 v239, v228, v239, 0xc0135761
v_mfma_f32_16x16x32_bf16 v[52:55], a[0:3], a[68:71], v[52:55]
v_mul_f32 v242, v46, v46
s_barrier
v_mfma_f32_16x16x32_bf16 v[56:59], a[0:3], a[72:75], v[56:59]
ds_read_b128 a[28:31], v224 offset:15360
v_mul_f32 v236, v236, v36
v_mfma_f32_16x16x32_bf16 v[56:59], a[4:7], a[88:91], v[56:59]
s_add_u32 m0, s36, 114688
v_mul_f32 v243, v47, v47
v_mfma_f32_16x16x32_bf16 v[60:63], a[4:7], a[92:95], v[60:63]
s_add_u32 s57, s37, 425984
v_mul_f32 v237, v237, v37
v_mfma_f32_16x16x32_bf16 v[60:63], a[0:3], a[76:79], v[60:63]
buffer_load_dwordx4 v226, s[20:23], s57 offen offset:0 sc1 lds
v_mfma_f32_16x16x32_bf16 v[172:175], a[8:11], a[76:79], v[172:175]
ds_read_b128 a[0:3], v224 offset:16384
s_waitcnt lgkmcnt(4)
v_mfma_f32_16x16x32_bf16 v[172:175], a[12:15], a[92:95], v[172:175]
v_fmaak_f32 v240, v228, v240, 0xc0135761
v_mul_f32 v238, v238, v38
v_mfma_f32_16x16x32_bf16 v[168:171], a[12:15], a[88:91], v[168:171]
v_fmaak_f32 v241, v228, v241, 0xc0135761
v_mul_f32 v239, v239, v39
v_mfma_f32_16x16x32_bf16 v[168:171], a[8:11], a[72:75], v[168:171]
v_exp_f32 v236, v236
v_mfma_f32_16x16x32_bf16 v[164:167], a[8:11], a[68:71], v[164:167]
ds_read_b128 a[4:7], v224 offset:17408
v_fmaak_f32 v242, v228, v242, 0xc0135761
v_mfma_f32_16x16x32_bf16 v[164:167], a[12:15], a[84:87], v[164:167]
buffer_load_dwordx4 v226, s[20:23], s57 offen offset:1024 sc1 lds
v_mfma_f32_16x16x32_bf16 v[160:163], a[12:15], a[80:83], v[160:163]
v_mul_f32 v148, v148, v36
v_fmaak_f32 v243, v228, v243, 0xc0135761
v_mfma_f32_16x16x32_bf16 v[160:163], a[8:11], a[64:67], v[160:163]
v_exp_f32 v237, v237
v_mfma_f32_16x16x32_bf16 v[64:67], a[16:19], a[96:99], v[64:67]
ds_read_b128 a[8:11], v224 offset:18432
v_mul_f32 v240, v240, v44
s_waitcnt lgkmcnt(4)
v_mfma_f32_16x16x32_bf16 v[64:67], a[20:23], a[112:115], v[64:67]
buffer_load_dwordx4 v226, s[20:23], s57 offen offset:2048 sc1 lds
v_mfma_f32_16x16x32_bf16 v[68:71], a[20:23], a[116:119], v[68:71]
v_mul_f32 v149, v149, v37
v_exp_f32 v238, v238
v_mfma_f32_16x16x32_bf16 v[68:71], a[16:19], a[100:103], v[68:71]
v_mul_f32 v241, v241, v45
v_mul_f32 v150, v150, v38
L_ct2:
v_mfma_f32_16x16x32_bf16 v[72:75], a[16:19], a[104:107], v[72:75]
ds_read_b128 a[12:15], v224 offset:19456
v_exp_f32 v239, v239
v_mfma_f32_16x16x32_bf16 v[72:75], a[20:23], a[120:123], v[72:75]
buffer_load_dwordx4 v226, s[20:23], s57 offen offset:3072 sc1 lds
v_mfma_f32_16x16x32_bf16 v[76:79], a[20:23], a[124:127], v[76:79]
v_mul_f32 v242, v242, v46
v_mul_f32 v151, v151, v39
v_mul_f32 v243, v243, v47
v_mfma_f32_16x16x32_bf16 v[76:79], a[16:19], a[108:111], v[76:79]
v_exp_f32 v240, v240
v_mfma_f32_16x16x32_bf16 v[188:191], a[24:27], a[108:111], v[188:191]
ds_read_b128 a[16:19], v224 offset:20480
v_add_f32 v236, 1.0, v236
s_waitcnt lgkmcnt(4)
v_mfma_f32_16x16x32_bf16 v[188:191], a[28:31], a[124:127], v[188:191]
v_mul_f32 v156, v156, v44
v_add_f32 v237, 1.0, v237
v_mfma_f32_16x16x32_bf16 v[184:187], a[28:31], a[120:123], v[184:187]
v_exp_f32 v241, v241
v_add_f32 v238, 1.0, v238
v_mfma_f32_16x16x32_bf16 v[184:187], a[24:27], a[104:107], v[184:187]
v_mul_f32 v157, v157, v45
v_add_f32 v239, 1.0, v239
v_mfma_f32_16x16x32_bf16 v[180:183], a[24:27], a[100:103], v[180:183]
ds_read_b128 a[20:23], v224 offset:21504
v_exp_f32 v242, v242
v_mfma_f32_16x16x32_bf16 v[180:183], a[28:31], a[116:119], v[180:183]
v_rcp_f32 v236, v236
v_mfma_f32_16x16x32_bf16 v[176:179], a[28:31], a[112:115], v[176:179]
v_rcp_f32 v237, v237
v_mul_f32 v158, v158, v46
v_mfma_f32_16x16x32_bf16 v[176:179], a[24:27], a[96:99], v[176:179]
v_rcp_f32 v238, v238
v_mfma_f32_16x16x32_bf16 v[64:67], a[0:3], a[128:131], v[64:67]
ds_read_b128 a[24:27], v224 offset:22528
s_waitcnt lgkmcnt(4)
v_mfma_f32_16x16x32_bf16 v[64:67], a[4:7], a[144:147], v[64:67]
v_exp_f32 v243, v243
v_mfma_f32_16x16x32_bf16 v[68:71], a[4:7], a[148:151], v[68:71]
v_rcp_f32 v239, v239
v_mul_f32 v159, v159, v47
v_mfma_f32_16x16x32_bf16 v[68:71], a[0:3], a[132:135], v[68:71]
v_mul_f32 v148, v148, v236
v_add_f32 v240, 1.0, v240
v_mfma_f32_16x16x32_bf16 v[72:75], a[0:3], a[136:139], v[72:75]
ds_read_b128 a[28:31], v224 offset:23552
v_mul_f32 v149, v149, v237
v_add_f32 v241, 1.0, v241
v_mfma_f32_16x16x32_bf16 v[72:75], a[4:7], a[152:155], v[72:75]
v_mul_f32 v150, v150, v238
v_add_f32 v242, 1.0, v242
v_mfma_f32_16x16x32_bf16 v[76:79], a[4:7], a[156:159], v[76:79]
v_mul_f32 v151, v151, v239
v_add_f32 v243, 1.0, v243
v_cvt_pk_bf16_f32 v34, v148, v149
v_mfma_f32_16x16x32_bf16 v[76:79], a[0:3], a[140:143], v[76:79]
v_rcp_f32 v240, v240
v_mfma_f32_16x16x32_bf16 v[188:191], a[8:11], a[140:143], v[188:191]
ds_read_b128 a[0:3], v224 offset:24576
v_cvt_pk_bf16_f32 v35, v150, v151
s_waitcnt lgkmcnt(4)
v_mfma_f32_16x16x32_bf16 v[188:191], a[12:15], a[156:159], v[188:191]
v_rcp_f32 v241, v241
v_mfma_f32_16x16x32_bf16 v[184:187], a[12:15], a[152:155], v[184:187]
v_rcp_f32 v242, v242
s_add_u32 s16, s41, 16384
v_mfma_f32_16x16x32_bf16 v[184:187], a[8:11], a[136:139], v[184:187]
v_rcp_f32 v243, v243
v_mfma_f32_16x16x32_bf16 v[180:183], a[8:11], a[132:135], v[180:183]
ds_read_b128 a[4:7], v224 offset:25600
v_permlane32_swap_b32 v32, v34
v_mfma_f32_16x16x32_bf16 v[180:183], a[12:15], a[148:151], v[180:183]
v_permlane32_swap_b32 v33, v35
v_mfma_f32_16x16x32_bf16 v[176:179], a[12:15], a[144:147], v[176:179]
buffer_store_dwordx4 v[32:35], v227, s[20:23], s16 offen sc1
v_mul_f32 v156, v156, v240
v_mfma_f32_16x16x32_bf16 v[176:179], a[8:11], a[128:131], v[176:179]
v_mul_f32 v236, v48, v48
v_mul_f32 v157, v157, v241
v_mfma_f32_16x16x32_bf16 v[64:67], a[16:19], a[160:163], v[64:67]
ds_read_b128 a[8:11], v224 offset:26624
v_mul_f32 v237, v49, v49
s_waitcnt lgkmcnt(4)
v_mfma_f32_16x16x32_bf16 v[64:67], a[20:23], a[176:179], v[64:67]
v_mul_f32 v158, v158, v242
v_mul_f32 v238, v50, v50
v_mfma_f32_16x16x32_bf16 v[68:71], a[20:23], a[180:183], v[68:71]
v_mul_f32 v159, v159, v243
v_mul_f32 v239, v51, v51
v_cvt_pk_bf16_f32 v42, v156, v157
v_mfma_f32_16x16x32_bf16 v[68:71], a[16:19], a[164:167], v[68:71]
v_fmaak_f32 v236, v228, v236, 0xc0135761
v_cvt_pk_bf16_f32 v43, v158, v159
v_mfma_f32_16x16x32_bf16 v[72:75], a[16:19], a[168:171], v[72:75]
ds_read_b128 a[12:15], v224 offset:27648
v_fmaak_f32 v237, v228, v237, 0xc0135761
s_add_u32 s59, s41, 245760
v_mfma_f32_16x16x32_bf16 v[72:75], a[20:23], a[184:187], v[72:75]
v_permlane32_swap_b32 v40, v42
v_mfma_f32_16x16x32_bf16 v[76:79], a[20:23], a[188:191], v[76:79]
v_permlane32_swap_b32 v41, v43
v_fmaak_f32 v238, v228, v238, 0xc0135761
v_mfma_f32_16x16x32_bf16 v[76:79], a[16:19], a[172:175], v[76:79]
buffer_store_dwordx4 v[40:43], v227, s[20:23], s59 offen sc1
v_mfma_f32_16x16x32_bf16 v[188:191], a[24:27], a[172:175], v[188:191]
ds_read_b128 a[16:19], v224 offset:28672
v_fmaak_f32 v239, v228, v239, 0xc0135761
s_waitcnt lgkmcnt(4)
v_mfma_f32_16x16x32_bf16 v[188:191], a[28:31], a[188:191], v[188:191]
v_mul_f32 v240, v56, v56
v_mul_f32 v236, v236, v48
v_mfma_f32_16x16x32_bf16 v[184:187], a[28:31], a[184:187], v[184:187]
v_mul_f32 v241, v57, v57
v_mul_f32 v237, v237, v49
v_mul_f32 v242, v58, v58
v_mfma_f32_16x16x32_bf16 v[184:187], a[24:27], a[168:171], v[184:187]
v_mul_f32 v238, v238, v50
v_mul_f32 v243, v59, v59
v_mfma_f32_16x16x32_bf16 v[180:183], a[24:27], a[164:167], v[180:183]
ds_read_b128 a[20:23], v224 offset:29696
v_mul_f32 v239, v239, v51
v_mfma_f32_16x16x32_bf16 v[180:183], a[28:31], a[180:183], v[180:183]
v_exp_f32 v236, v236
v_mfma_f32_16x16x32_bf16 v[176:179], a[28:31], a[176:179], v[176:179]
v_fmaak_f32 v240, v228, v240, 0xc0135761
v_mul_f32 v160, v160, v48
v_mfma_f32_16x16x32_bf16 v[176:179], a[24:27], a[160:163], v[176:179]
v_exp_f32 v237, v237
v_mfma_f32_16x16x32_bf16 v[64:67], a[0:3], a[192:195], v[64:67]
ds_read_b128 a[24:27], v224 offset:30720
s_waitcnt lgkmcnt(4)
v_mfma_f32_16x16x32_bf16 v[64:67], a[4:7], a[208:211], v[64:67]
v_fmaak_f32 v241, v228, v241, 0xc0135761
v_mul_f32 v161, v161, v49
v_mfma_f32_16x16x32_bf16 v[68:71], a[4:7], a[212:215], v[68:71]
v_exp_f32 v238, v238
v_mfma_f32_16x16x32_bf16 v[68:71], a[0:3], a[196:199], v[68:71]
v_fmaak_f32 v242, v228, v242, 0xc0135761
s_barrier
v_mfma_f32_16x16x32_bf16 v[72:75], a[0:3], a[200:203], v[72:75]
ds_read_b128 a[28:31], v224 offset:31744
v_mul_f32 v162, v162, v50
v_mfma_f32_16x16x32_bf16 v[72:75], a[4:7], a[216:219], v[72:75]
s_add_u32 m0, s36, 0
v_fmaak_f32 v243, v228, v243, 0xc0135761
v_mfma_f32_16x16x32_bf16 v[76:79], a[4:7], a[220:223], v[76:79]
s_add_u32 s57, s93, 49152
v_mul_f32 v240, v240, v56
v_mfma_f32_16x16x32_bf16 v[76:79], a[0:3], a[204:207], v[76:79]
buffer_load_dwordx4 v226, s[20:23], s57 offen offset:0 sc1 lds
v_mfma_f32_16x16x32_bf16 v[188:191], a[8:11], a[204:207], v[188:191]
ds_read_b128 a[0:3], v224 offset:32768
s_waitcnt lgkmcnt(4)
v_mfma_f32_16x16x32_bf16 v[188:191], a[12:15], a[220:223], v[188:191]
v_exp_f32 v239, v239
v_mfma_f32_16x16x32_bf16 v[184:187], a[12:15], a[216:219], v[184:187]
v_mul_f32 v241, v241, v57
v_mul_f32 v163, v163, v51
v_mfma_f32_16x16x32_bf16 v[184:187], a[8:11], a[200:203], v[184:187]
v_mul_f32 v242, v242, v58
v_add_f32 v236, 1.0, v236
v_mfma_f32_16x16x32_bf16 v[180:183], a[8:11], a[196:199], v[180:183]
ds_read_b128 a[4:7], v224 offset:33792
v_mul_f32 v243, v243, v59
v_mfma_f32_16x16x32_bf16 v[180:183], a[12:15], a[212:215], v[180:183]
buffer_load_dwordx4 v226, s[20:23], s57 offen offset:1024 sc1 lds
v_mfma_f32_16x16x32_bf16 v[176:179], a[12:15], a[208:211], v[176:179]
v_exp_f32 v240, v240
v_mfma_f32_16x16x32_bf16 v[176:179], a[8:11], a[192:195], v[176:179]
v_add_f32 v237, 1.0, v237
v_mul_f32 v168, v168, v56
v_mfma_f32_16x16x32_bf16 v[64:67], a[16:19], a[224:227], v[64:67]
ds_read_b128 a[8:11], v224 offset:34816
s_waitcnt lgkmcnt(4)
v_mfma_f32_16x16x32_bf16 v[64:67], a[20:23], a[240:243], v[64:67]
buffer_load_dwordx4 v226, s[20:23], s57 offen offset:2048 sc1 lds
v_mfma_f32_16x16x32_bf16 v[68:71], a[20:23], a[244:247], v[68:71]
v_lshlrev_b32 v252, 3, v224
v_add_f32 v238, 1.0, v238
v_mfma_f32_16x16x32_bf16 v[68:71], a[16:19], a[228:231], v[68:71]
s_mov_b32 s58, L_ct3-L_body
v_add_f32 v239, 1.0, v239
v_mfma_f32_16x16x32_bf16 v[72:75], a[16:19], a[232:235], v[72:75]
buffer_load_dword v252, v252, s[80:83], s58 offen
v_mfma_f32_16x16x32_bf16 v[72:75], a[20:23], a[248:251], v[72:75]
ds_read_b128 a[12:15], v224 offset:35840
v_mfma_f32_16x16x32_bf16 v[76:79], a[20:23], a[252:255], v[76:79]
buffer_load_dwordx4 v226, s[20:23], s57 offen offset:3072 sc1 lds
v_mfma_f32_16x16x32_bf16 v[76:79], a[16:19], a[236:239], v[76:79]
v_exp_f32 v241, v241
v_mfma_f32_16x16x32_bf16 v[188:191], a[24:27], a[236:239], v[188:191]
ds_read_b128 a[16:19], v224 offset:36864
s_waitcnt lgkmcnt(4)
v_mfma_f32_16x16x32_bf16 v[188:191], a[28:31], a[252:255], v[188:191]
v_rcp_f32 v236, v236
v_mfma_f32_16x16x32_bf16 v[184:187], a[28:31], a[248:251], v[184:187]
v_rcp_f32 v237, v237
v_mfma_f32_16x16x32_bf16 v[184:187], a[24:27], a[232:235], v[184:187]
v_rcp_f32 v238, v238
v_mfma_f32_16x16x32_bf16 v[180:183], a[24:27], a[228:231], v[180:183]
ds_read_b128 a[20:23], v224 offset:37888
v_mul_f32 v169, v169, v57
v_mfma_f32_16x16x32_bf16 v[180:183], a[28:31], a[244:247], v[180:183]
v_rcp_f32 v239, v239
v_mfma_f32_16x16x32_bf16 v[176:179], a[28:31], a[240:243], v[176:179]
v_exp_f32 v242, v242
v_mfma_f32_16x16x32_bf16 v[176:179], a[24:27], a[224:227], v[176:179]
v_mul_f32 v160, v160, v236
v_mul_f32 v170, v170, v58
buffer_load_dword v234, v235, s[20:23], s46 offen sc1
v_mfma_f32_16x16x32_bf16 v[64:67], a[0:3], a[32:35], v[64:67]
ds_read_b128 a[24:27], v224 offset:38912
s_waitcnt lgkmcnt(4)
v_mfma_f32_16x16x32_bf16 v[64:67], a[4:7], a[48:51], v[64:67]
v_exp_f32 v243, v243
v_mfma_f32_16x16x32_bf16 v[68:71], a[4:7], a[52:55], v[68:71]
v_mul_f32 v161, v161, v237
v_mul_f32 v171, v171, v59
v_mfma_f32_16x16x32_bf16 v[68:71], a[0:3], a[36:39], v[68:71]
v_mul_f32 v162, v162, v238
v_add_f32 v240, 1.0, v240
v_mfma_f32_16x16x32_bf16 v[72:75], a[0:3], a[40:43], v[72:75]
ds_read_b128 a[28:31], v224 offset:39936
v_mul_f32 v163, v163, v239
v_mfma_f32_16x16x32_bf16 v[72:75], a[4:7], a[56:59], v[72:75]
v_add_f32 v241, 1.0, v241
v_cvt_pk_bf16_f32 v48, v160, v161
v_mfma_f32_16x16x32_bf16 v[76:79], a[4:7], a[60:63], v[76:79]
v_add_f32 v242, 1.0, v242
v_cvt_pk_bf16_f32 v49, v162, v163
v_mfma_f32_16x16x32_bf16 v[76:79], a[0:3], a[44:47], v[76:79]
v_add_f32 v243, 1.0, v243
v_mul_f32 v236, v52, v52
v_mfma_f32_16x16x32_bf16 v[188:191], a[8:11], a[44:47], v[188:191]
ds_read_b128 a[0:3], v224 offset:40960
s_waitcnt lgkmcnt(4)
v_mfma_f32_16x16x32_bf16 v[188:191], a[12:15], a[60:63], v[188:191]
v_rcp_f32 v240, v240
v_mfma_f32_16x16x32_bf16 v[184:187], a[12:15], a[56:59], v[184:187]
v_rcp_f32 v241, v241
v_mfma_f32_16x16x32_bf16 v[184:187], a[8:11], a[40:43], v[184:187]
v_rcp_f32 v242, v242
v_mfma_f32_16x16x32_bf16 v[180:183], a[8:11], a[36:39], v[180:183]
ds_read_b128 a[4:7], v224 offset:41984
v_mul_f32 v237, v53, v53
v_mfma_f32_16x16x32_bf16 v[180:183], a[12:15], a[52:55], v[180:183]
v_rcp_f32 v243, v243
v_mfma_f32_16x16x32_bf16 v[176:179], a[12:15], a[48:51], v[176:179]
v_mul_f32 v238, v54, v54
v_mul_f32 v168, v168, v240
v_mfma_f32_16x16x32_bf16 v[176:179], a[8:11], a[32:35], v[176:179]
v_mul_f32 v239, v55, v55
v_mul_f32 v169, v169, v241
v_mfma_f32_16x16x32_bf16 v[64:67], a[16:19], a[64:67], v[64:67]
ds_read_b128 a[8:11], v224 offset:43008
s_waitcnt lgkmcnt(4)
v_mfma_f32_16x16x32_bf16 v[64:67], a[20:23], a[80:83], v[64:67]
v_fmaak_f32 v236, v228, v236, 0xc0135761
v_mul_f32 v170, v170, v242
v_mfma_f32_16x16x32_bf16 v[68:71], a[20:23], a[84:87], v[68:71]
v_fmaak_f32 v237, v228, v237, 0xc0135761
v_mul_f32 v171, v171, v243
v_mfma_f32_16x16x32_bf16 v[68:71], a[16:19], a[68:71], v[68:71]
v_fmaak_f32 v238, v228, v238, 0xc0135761
v_cvt_pk_bf16_f32 v56, v168, v169
v_mfma_f32_16x16x32_bf16 v[72:75], a[16:19], a[72:75], v[72:75]
ds_read_b128 a[12:15], v224 offset:44032
v_fmaak_f32 v239, v228, v239, 0xc0135761
v_mfma_f32_16x16x32_bf16 v[72:75], a[20:23], a[88:91], v[72:75]
v_cvt_pk_bf16_f32 v57, v170, v171
v_mul_f32 v236, v236, v52
v_mfma_f32_16x16x32_bf16 v[76:79], a[20:23], a[92:95], v[76:79]
v_mul_f32 v240, v60, v60
v_mul_f32 v237, v237, v53
v_mfma_f32_16x16x32_bf16 v[76:79], a[16:19], a[76:79], v[76:79]
v_mul_f32 v241, v61, v61
v_mul_f32 v238, v238, v54
v_mfma_f32_16x16x32_bf16 v[188:191], a[24:27], a[76:79], v[188:191]
ds_read_b128 a[16:19], v224 offset:45056
s_waitcnt lgkmcnt(4)
v_mfma_f32_16x16x32_bf16 v[188:191], a[28:31], a[92:95], v[188:191]
v_mul_f32 v242, v62, v62
v_mul_f32 v239, v239, v55
v_mfma_f32_16x16x32_bf16 v[184:187], a[28:31], a[88:91], v[184:187]
v_exp_f32 v236, v236
v_mfma_f32_16x16x32_bf16 v[184:187], a[24:27], a[72:75], v[184:187]
v_mul_f32 v243, v63, v63
v_mul_f32 v164, v164, v52
v_mfma_f32_16x16x32_bf16 v[180:183], a[24:27], a[68:71], v[180:183]
ds_read_b128 a[20:23], v224 offset:46080
v_fmaak_f32 v240, v228, v240, 0xc0135761
v_mfma_f32_16x16x32_bf16 v[180:183], a[28:31], a[84:87], v[180:183]
v_exp_f32 v237, v237
v_mfma_f32_16x16x32_bf16 v[176:179], a[28:31], a[80:83], v[176:179]
v_fmaak_f32 v241, v228, v241, 0xc0135761
v_mul_f32 v165, v165, v53
v_mfma_f32_16x16x32_bf16 v[176:179], a[24:27], a[64:67], v[176:179]
v_exp_f32 v238, v238
v_mfma_f32_16x16x32_bf16 v[80:83], a[0:3], a[96:99], v[80:83]
ds_read_b128 a[24:27], v224 offset:47104
v_fmaak_f32 v242, v228, v242, 0xc0135761
s_waitcnt lgkmcnt(4)
v_mfma_f32_16x16x32_bf16 v[80:83], a[4:7], a[112:115], v[80:83]
v_mul_f32 v166, v166, v54
v_fmaak_f32 v243, v228, v243, 0xc0135761
v_mfma_f32_16x16x32_bf16 v[84:87], a[4:7], a[116:119], v[84:87]
v_exp_f32 v239, v239
v_mul_f32 v240, v240, v60
v_mfma_f32_16x16x32_bf16 v[84:87], a[0:3], a[100:103], v[84:87]
v_mul_f32 v167, v167, v55
s_barrier
v_mfma_f32_16x16x32_bf16 v[88:91], a[0:3], a[104:107], v[88:91]
ds_read_b128 a[28:31], v224 offset:48128
v_mul_f32 v241, v241, v61
v_add_f32 v236, 1.0, v236
v_mfma_f32_16x16x32_bf16 v[88:91], a[4:7], a[120:123], v[88:91]
s_add_u32 m0, s36, 16384
v_mul_f32 v242, v242, v62
v_mfma_f32_16x16x32_bf16 v[92:95], a[4:7], a[124:127], v[92:95]
s_add_u32 s57, s92, 65536
v_add_f32 v237, 1.0, v237
v_mul_f32 v243, v243, v63
v_mfma_f32_16x16x32_bf16 v[92:95], a[0:3], a[108:111], v[92:95]
buffer_load_dwordx4 v226, s[20:23], s57 offen offset:0 sc1 lds
s_waitcnt vmcnt(1)
v_cmp_ne_u32 vcc, v253, v234
s_nop 0
s_and_b32 s14, vcc_lo, 0xffff
s_cbranch_scc1 L_poll7
L_poll7_ok:
s_add_u32 s46, s46, 0x4000
v_mfma_f32_16x16x32_bf16 v[204:207], a[8:11], a[108:111], v[204:207]
ds_read_b128 a[0:3], v224 offset:49152
v_add_f32 v238, 1.0, v238
s_waitcnt lgkmcnt(4)
v_mfma_f32_16x16x32_bf16 v[204:207], a[12:15], a[124:127], v[204:207]
v_exp_f32 v240, v240
v_mfma_f32_16x16x32_bf16 v[200:203], a[12:15], a[120:123], v[200:203]
v_add_f32 v239, 1.0, v239
v_rcp_f32 v236, v236
v_mfma_f32_16x16x32_bf16 v[200:203], a[8:11], a[104:107], v[200:203]
v_rcp_f32 v237, v237
v_mfma_f32_16x16x32_bf16 v[196:199], a[8:11], a[100:103], v[196:199]
ds_read_b128 a[4:7], v224 offset:50176
v_rcp_f32 v238, v238
v_mfma_f32_16x16x32_bf16 v[196:199], a[12:15], a[116:119], v[196:199]
buffer_load_dwordx4 v226, s[20:23], s57 offen offset:1024 sc1 lds
v_mfma_f32_16x16x32_bf16 v[192:195], a[12:15], a[112:115], v[192:195]
v_rcp_f32 v239, v239
v_mul_f32 v172, v172, v60
v_mfma_f32_16x16x32_bf16 v[192:195], a[8:11], a[96:99], v[192:195]
v_exp_f32 v241, v241
v_mfma_f32_16x16x32_bf16 v[80:83], a[16:19], a[128:131], v[80:83]
ds_read_b128 a[8:11], v224 offset:51200
v_mul_f32 v164, v164, v236
s_waitcnt lgkmcnt(4)
v_mfma_f32_16x16x32_bf16 v[80:83], a[20:23], a[144:147], v[80:83]
buffer_load_dwordx4 v226, s[20:23], s57 offen offset:2048 sc1 lds
v_mfma_f32_16x16x32_bf16 v[84:87], a[20:23], a[148:151], v[84:87]
v_mul_f32 v173, v173, v61
v_exp_f32 v242, v242
v_mfma_f32_16x16x32_bf16 v[84:87], a[16:19], a[132:135], v[84:87]
v_mul_f32 v165, v165, v237
v_mul_f32 v174, v174, v62
v_mfma_f32_16x16x32_bf16 v[88:91], a[16:19], a[136:139], v[88:91]
ds_read_b128 a[12:15], v224 offset:52224
v_exp_f32 v243, v243
v_mfma_f32_16x16x32_bf16 v[88:91], a[20:23], a[152:155], v[88:91]
buffer_load_dwordx4 v226, s[20:23], s57 offen offset:3072 sc1 lds
v_mfma_f32_16x16x32_bf16 v[92:95], a[20:23], a[156:159], v[92:95]
v_mul_f32 v166, v166, v238
v_mul_f32 v175, v175, v63
v_mul_f32 v167, v167, v239
v_mfma_f32_16x16x32_bf16 v[92:95], a[16:19], a[140:143], v[92:95]
v_add_f32 v240, 1.0, v240
v_cvt_pk_bf16_f32 v50, v164, v165
v_mfma_f32_16x16x32_bf16 v[204:207], a[24:27], a[140:143], v[204:207]
ds_read_b128 a[16:19], v224 offset:53248
v_add_f32 v241, 1.0, v241
s_waitcnt lgkmcnt(4)
v_mfma_f32_16x16x32_bf16 v[204:207], a[28:31], a[156:159], v[204:207]
s_add_u32 s10, s84, 0
v_cvt_pk_bf16_f32 v51, v166, v167
v_mfma_f32_16x16x32_bf16 v[200:203], a[28:31], a[152:155], v[200:203]
buffer_load_dwordx4 v[32:35], v224, s[20:23], s10 offen offset:0 sc1
v_add_f32 v242, 1.0, v242
v_mfma_f32_16x16x32_bf16 v[200:203], a[24:27], a[136:139], v[200:203]
s_add_u32 s16, s41, 24576
v_add_f32 v243, 1.0, v243
v_mfma_f32_16x16x32_bf16 v[196:199], a[24:27], a[132:135], v[196:199]
ds_read_b128 a[20:23], v224 offset:54272
v_permlane32_swap_b32 v48, v50
v_mfma_f32_16x16x32_bf16 v[196:199], a[28:31], a[148:151], v[196:199]
v_rcp_f32 v240, v240
v_mfma_f32_16x16x32_bf16 v[192:195], a[28:31], a[144:147], v[192:195]
v_permlane32_swap_b32 v49, v51
v_mfma_f32_16x16x32_bf16 v[192:195], a[24:27], a[128:131], v[192:195]
v_rcp_f32 v241, v241
v_mfma_f32_16x16x32_bf16 v[80:83], a[0:3], a[160:163], v[80:83]
ds_read_b128 a[24:27], v224 offset:55296
s_waitcnt lgkmcnt(4)
v_mfma_f32_16x16x32_bf16 v[80:83], a[4:7], a[176:179], v[80:83]
s_add_u32 s11, s84, 114688
v_mfma_f32_16x16x32_bf16 v[84:87], a[4:7], a[180:183], v[84:87]
buffer_load_dwordx4 v[36:39], v224, s[20:23], s11 offen offset:0 sc1
v_mfma_f32_16x16x32_bf16 v[84:87], a[0:3], a[164:167], v[84:87]
buffer_store_dwordx4 v[48:51], v227, s[20:23], s16 offen sc1
v_mfma_f32_16x16x32_bf16 v[88:91], a[0:3], a[168:171], v[88:91]
ds_read_b128 a[28:31], v224 offset:56320
v_rcp_f32 v242, v242
v_mfma_f32_16x16x32_bf16 v[88:91], a[4:7], a[184:187], v[88:91]
buffer_load_dwordx4 v[40:43], v224, s[20:23], s10 offen offset:1024 sc1
v_mfma_f32_16x16x32_bf16 v[92:95], a[4:7], a[188:191], v[92:95]
v_rcp_f32 v243, v243
v_mul_f32 v236, v64, v64
v_mfma_f32_16x16x32_bf16 v[92:95], a[0:3], a[172:175], v[92:95]
v_mul_f32 v172, v172, v240
v_mul_f32 v237, v65, v65
v_mfma_f32_16x16x32_bf16 v[204:207], a[8:11], a[172:175], v[204:207]
ds_read_b128 a[0:3], v224 offset:57344
v_mul_f32 v173, v173, v241
s_waitcnt lgkmcnt(4)
v_mfma_f32_16x16x32_bf16 v[204:207], a[12:15], a[188:191], v[204:207]
buffer_load_dwordx4 v[44:47], v224, s[20:23], s11 offen offset:1024 sc1
v_mfma_f32_16x16x32_bf16 v[200:203], a[12:15], a[184:187], v[200:203]
v_mul_f32 v238, v66, v66
v_mul_f32 v174, v174, v242
v_mul_f32 v239, v67, v67
v_mfma_f32_16x16x32_bf16 v[200:203], a[8:11], a[168:171], v[200:203]
v_mul_f32 v175, v175, v243
v_fmaak_f32 v236, v228, v236, 0xc0135761
v_mfma_f32_16x16x32_bf16 v[196:199], a[8:11], a[164:167], v[196:199]
ds_read_b128 a[4:7], v224 offset:58368
v_cvt_pk_bf16_f32 v58, v172, v173
v_fmaak_f32 v237, v228, v237, 0xc0135761
v_mfma_f32_16x16x32_bf16 v[196:199], a[12:15], a[180:183], v[196:199]
buffer_load_dwordx4 v[144:147], v224, s[20:23], s10 offen offset:2048 sc1
v_mfma_f32_16x16x32_bf16 v[192:195], a[12:15], a[176:179], v[192:195]
v_cvt_pk_bf16_f32 v59, v174, v175
v_fmaak_f32 v238, v228, v238, 0xc0135761
s_add_u32 s59, s41, 253952
v_mfma_f32_16x16x32_bf16 v[192:195], a[8:11], a[160:163], v[192:195]
v_permlane32_swap_b32 v56, v58
v_mfma_f32_16x16x32_bf16 v[80:83], a[16:19], a[192:195], v[80:83]
ds_read_b128 a[8:11], v224 offset:59392
v_fmaak_f32 v239, v228, v239, 0xc0135761
s_waitcnt lgkmcnt(4)
v_mfma_f32_16x16x32_bf16 v[80:83], a[20:23], a[208:211], v[80:83]
v_permlane32_swap_b32 v57, v59
v_mfma_f32_16x16x32_bf16 v[84:87], a[20:23], a[212:215], v[84:87]
buffer_store_dwordx4 v[56:59], v227, s[20:23], s59 offen sc1
v_mul_f32 v236, v236, v64
v_mfma_f32_16x16x32_bf16 v[84:87], a[16:19], a[196:199], v[84:87]
v_mul_f32 v240, v72, v72
v_mul_f32 v237, v237, v65
v_mfma_f32_16x16x32_bf16 v[88:91], a[16:19], a[200:203], v[88:91]
ds_read_b128 a[12:15], v224 offset:60416
v_mul_f32 v241, v73, v73
v_mul_f32 v238, v238, v66
v_mfma_f32_16x16x32_bf16 v[88:91], a[20:23], a[216:219], v[88:91]
buffer_load_dwordx4 v[148:151], v224, s[20:23], s11 offen offset:2048 sc1
v_mfma_f32_16x16x32_bf16 v[92:95], a[20:23], a[220:223], v[92:95]
v_mul_f32 v242, v74, v74
v_mul_f32 v239, v239, v67
v_mul_f32 v243, v75, v75
v_mfma_f32_16x16x32_bf16 v[92:95], a[16:19], a[204:207], v[92:95]
v_exp_f32 v236, v236
v_mfma_f32_16x16x32_bf16 v[204:207], a[24:27], a[204:207], v[204:207]
ds_read_b128 a[16:19], v224 offset:61440
s_waitcnt lgkmcnt(4)
v_mfma_f32_16x16x32_bf16 v[204:207], a[28:31], a[220:223], v[204:207]
buffer_load_dwordx4 v[152:155], v224, s[20:23], s10 offen offset:3072 sc1
v_mfma_f32_16x16x32_bf16 v[200:203], a[28:31], a[216:219], v[200:203]
v_fmaak_f32 v240, v228, v240, 0xc0135761
v_mul_f32 v176, v176, v64
v_mfma_f32_16x16x32_bf16 v[200:203], a[24:27], a[200:203], v[200:203]
v_exp_f32 v237, v237
v_mfma_f32_16x16x32_bf16 v[196:199], a[24:27], a[196:199], v[196:199]
ds_read_b128 a[20:23], v224 offset:62464
v_fmaak_f32 v241, v228, v241, 0xc0135761
v_mfma_f32_16x16x32_bf16 v[196:199], a[28:31], a[212:215], v[196:199]
buffer_load_dwordx4 v[156:159], v224, s[20:23], s11 offen offset:3072 sc1
v_mfma_f32_16x16x32_bf16 v[192:195], a[28:31], a[208:211], v[192:195]
v_mul_f32 v177, v177, v65
v_fmaak_f32 v242, v228, v242, 0xc0135761
v_mfma_f32_16x16x32_bf16 v[192:195], a[24:27], a[192:195], v[192:195]
v_exp_f32 v238, v238
v_mfma_f32_16x16x32_bf16 v[80:83], a[0:3], a[224:227], v[80:83]
ds_read_b128 a[24:27], v224 offset:63488
s_waitcnt lgkmcnt(4)
v_mfma_f32_16x16x32_bf16 v[80:83], a[4:7], a[240:243], v[80:83]
s_add_u32 s10, s85, 4096
v_fmaak_f32 v243, v228, v243, 0xc0135761
v_mfma_f32_16x16x32_bf16 v[84:87], a[4:7], a[244:247], v[84:87]
buffer_load_dwordx4 v[48:51], v224, s[20:23], s10 offen offset:0 sc1
v_mfma_f32_16x16x32_bf16 v[84:87], a[0:3], a[228:231], v[84:87]
v_mul_f32 v178, v178, v66
s_barrier
v_mfma_f32_16x16x32_bf16 v[88:91], a[0:3], a[232:235], v[88:91]
ds_read_b128 a[28:31], v224 offset:64512
v_mul_f32 v240, v240, v72
v_mfma_f32_16x16x32_bf16 v[88:91], a[4:7], a[248:251], v[88:91]
v_exp_f32 v239, v239
v_mfma_f32_16x16x32_bf16 v[92:95], a[4:7], a[252:255], v[92:95]
v_mul_f32 v241, v241, v73
v_mul_f32 v179, v179, v67
v_mfma_f32_16x16x32_bf16 v[92:95], a[0:3], a[236:239], v[92:95]
v_mul_f32 v242, v242, v74
v_add_f32 v236, 1.0, v236
v_mfma_f32_16x16x32_bf16 v[204:207], a[8:11], a[236:239], v[204:207]
ds_read_b128 a[0:3], v225 offset:0
s_waitcnt lgkmcnt(4)
v_mfma_f32_16x16x32_bf16 v[204:207], a[12:15], a[252:255], v[204:207]
s_add_u32 s11, s85, 118784
v_mul_f32 v243, v243, v75
v_mfma_f32_16x16x32_bf16 v[200:203], a[12:15], a[248:251], v[200:203]
buffer_load_dwordx4 v[52:55], v224, s[20:23], s11 offen offset:0 sc1
v_mfma_f32_16x16x32_bf16 v[200:203], a[8:11], a[232:235], v[200:203]
v_exp_f32 v240, v240
v_mfma_f32_16x16x32_bf16 v[196:199], a[8:11], a[228:231], v[196:199]
ds_read_b128 a[4:7], v225 offset:1024
v_add_f32 v237, 1.0, v237
v_mfma_f32_16x16x32_bf16 v[196:199], a[12:15], a[244:247], v[196:199]
buffer_load_dwordx4 v[56:59], v224, s[20:23], s10 offen offset:1024 sc1
v_mfma_f32_16x16x32_bf16 v[192:195], a[12:15], a[240:243], v[192:195]
v_mul_f32 v184, v184, v72
v_add_f32 v238, 1.0, v238
v_mfma_f32_16x16x32_bf16 v[192:195], a[8:11], a[224:227], v[192:195]
v_exp_f32 v241, v241
v_mfma_f32_16x16x32_bf16 v[80:83], a[16:19], a[32:35], v[80:83]
ds_read_b128 a[8:11], v225 offset:2048
s_waitcnt lgkmcnt(4)
v_mfma_f32_16x16x32_bf16 v[80:83], a[20:23], a[48:51], v[80:83]
buffer_load_dwordx4 v[60:63], v224, s[20:23], s11 offen offset:1024 sc1
v_mfma_f32_16x16x32_bf16 v[84:87], a[20:23], a[52:55], v[84:87]
v_add_f32 v239, 1.0, v239
v_mul_f32 v185, v185, v73
v_mfma_f32_16x16x32_bf16 v[84:87], a[16:19], a[36:39], v[84:87]
v_rcp_f32 v236, v236
v_mfma_f32_16x16x32_bf16 v[88:91], a[16:19], a[40:43], v[88:91]
ds_read_b128 a[12:15], v225 offset:3072
v_mfma_f32_16x16x32_bf16 v[88:91], a[20:23], a[56:59], v[88:91]
buffer_load_dwordx4 v[160:163], v224, s[20:23], s10 offen offset:2048 sc1
v_mfma_f32_16x16x32_bf16 v[92:95], a[20:23], a[60:63], v[92:95]
v_exp_f32 v242, v242
v_mfma_f32_16x16x32_bf16 v[92:95], a[16:19], a[44:47], v[92:95]
v_rcp_f32 v237, v237
v_mfma_f32_16x16x32_bf16 v[204:207], a[24:27], a[44:47], v[204:207]
ds_read_b128 a[16:19], v225 offset:4096
s_waitcnt lgkmcnt(4)
v_mfma_f32_16x16x32_bf16 v[204:207], a[28:31], a[60:63], v[204:207]
v_rcp_f32 v238, v238
v_mfma_f32_16x16x32_bf16 v[200:203], a[28:31], a[56:59], v[200:203]
v_rcp_f32 v239, v239
v_mfma_f32_16x16x32_bf16 v[200:203], a[24:27], a[40:43], v[200:203]
v_mul_f32 v186, v186, v74
v_mul_f32 v176, v176, v236
v_mfma_f32_16x16x32_bf16 v[196:199], a[24:27], a[36:39], v[196:199]
ds_read_b128 a[20:23], v225 offset:5120
v_mul_f32 v177, v177, v237
v_mfma_f32_16x16x32_bf16 v[196:199], a[28:31], a[52:55], v[196:199]
buffer_load_dwordx4 v[164:167], v224, s[20:23], s11 offen offset:2048 sc1
v_mfma_f32_16x16x32_bf16 v[192:195], a[28:31], a[48:51], v[192:195]
v_exp_f32 v243, v243
v_mfma_f32_16x16x32_bf16 v[192:195], a[24:27], a[32:35], v[192:195]
v_mul_f32 v178, v178, v238
s_waitcnt vmcnt(14)
v_mfma_f32_16x16x32_bf16 v[0:3], a[0:3], v[32:35], 0
ds_read_b128 a[24:27], v225 offset:6144
s_waitcnt vmcnt(11) lgkmcnt(4)
v_mfma_f32_16x16x32_bf16 v[0:3], a[4:7], v[40:43], v[0:3]
buffer_load_dwordx4 v[168:171], v224, s[20:23], s10 offen offset:3072 sc1
s_waitcnt vmcnt(10)
s_mov_b64 exec, 1
buffer_store_dword v253, off, s[20:23], s45 sc1
s_mov_b64 exec, -1
s_add_u32 s45, s45, 0x4000
v_mfma_f32_16x16x32_bf16 v[4:7], a[4:7], v[44:47], 0
ds_read_b128 a[28:31], v225 offset:7168
v_mul_f32 v187, v187, v75
v_mfma_f32_16x16x32_bf16 v[4:7], a[0:3], v[36:39], v[4:7]
v_mul_f32 v179, v179, v239
v_add_f32 v240, 1.0, v240
v_mfma_f32_16x16x32_bf16 v[12:15], a[8:11], v[36:39], 0
ds_read_b128 a[0:3], v225 offset:8192
s_waitcnt lgkmcnt(4)
v_mfma_f32_16x16x32_bf16 v[12:15], a[12:15], v[44:47], v[12:15]
buffer_load_dwordx4 v[172:175], v224, s[20:23], s11 offen offset:3072 sc1
v_mfma_f32_16x16x32_bf16 v[8:11], a[12:15], v[40:43], 0
ds_read_b128 a[4:7], v225 offset:9216
v_cvt_pk_bf16_f32 v64, v176, v177
v_mfma_f32_16x16x32_bf16 v[8:11], a[8:11], v[32:35], v[8:11]
v_add_f32 v241, 1.0, v241
v_cvt_pk_bf16_f32 v65, v178, v179
v_mfma_f32_16x16x32_bf16 v[16:19], a[16:19], v[32:35], 0
ds_read_b128 a[8:11], v225 offset:10240
s_waitcnt lgkmcnt(4)
v_mfma_f32_16x16x32_bf16 v[16:19], a[20:23], v[40:43], v[16:19]
s_add_u32 m0, s36, 32768
s_add_u32 s57, s92, 81920
v_mfma_f32_16x16x32_bf16 v[20:23], a[20:23], v[44:47], 0
buffer_load_dwordx4 v226, s[20:23], s57 offen offset:0 sc1 lds
v_mfma_f32_16x16x32_bf16 v[20:23], a[16:19], v[36:39], v[20:23]
ds_read_b128 a[12:15], v225 offset:11264
v_add_f32 v242, 1.0, v242
v_mfma_f32_16x16x32_bf16 v[28:31], a[24:27], v[36:39], 0
ds_read_b128 a[16:19], v225 offset:12288
s_waitcnt lgkmcnt(4)
v_mfma_f32_16x16x32_bf16 v[28:31], a[28:31], v[44:47], v[28:31]
v_mul_f32 v236, v68, v68
v_add_f32 v243, 1.0, v243
v_mfma_f32_16x16x32_bf16 v[24:27], a[28:31], v[40:43], 0
ds_read_b128 a[20:23], v225 offset:13312
v_mul_f32 v237, v69, v69
v_mfma_f32_16x16x32_bf16 v[24:27], a[24:27], v[32:35], v[24:27]
buffer_load_dwordx4 v226, s[20:23], s57 offen offset:1024 sc1 lds
v_mfma_f32_16x16x32_bf16 v[112:115], a[0:3], v[32:35], 0
ds_read_b128 a[24:27], v225 offset:14336
s_waitcnt lgkmcnt(4)
v_mfma_f32_16x16x32_bf16 v[112:115], a[4:7], v[40:43], v[112:115]
v_mul_f32 v238, v70, v70
s_barrier
v_mfma_f32_16x16x32_bf16 v[116:119], a[4:7], v[44:47], 0
ds_read_b128 a[28:31], v225 offset:15360
v_mul_f32 v239, v71, v71
v_mfma_f32_16x16x32_bf16 v[116:119], a[0:3], v[36:39], v[116:119]
buffer_load_dwordx4 v226, s[20:23], s57 offen offset:2048 sc1 lds
v_mfma_f32_16x16x32_bf16 v[124:127], a[8:11], v[36:39], 0
ds_read_b128 a[0:3], v225 offset:16384
s_waitcnt lgkmcnt(4)
v_mfma_f32_16x16x32_bf16 v[124:127], a[12:15], v[44:47], v[124:127]
v_rcp_f32 v240, v240
v_mfma_f32_16x16x32_bf16 v[120:123], a[12:15], v[40:43], 0
ds_read_b128 a[4:7], v225 offset:17408
v_fmaak_f32 v236, v228, v236, 0xc0135761
v_mfma_f32_16x16x32_bf16 v[120:123], a[8:11], v[32:35], v[120:123]
v_rcp_f32 v241, v241
v_mfma_f32_16x16x32_bf16 v[128:131], a[16:19], v[32:35], 0
ds_read_b128 a[8:11], v225 offset:18432
s_waitcnt lgkmcnt(4)
v_mfma_f32_16x16x32_bf16 v[128:131], a[20:23], v[40:43], v[128:131]
buffer_load_dwordx4 v226, s[20:23], s57 offen offset:3072 sc1 lds
v_mfma_f32_16x16x32_bf16 v[132:135], a[20:23], v[44:47], 0
ds_read_b128 a[12:15], v225 offset:19456
v_fmaak_f32 v237, v228, v237, 0xc0135761
v_mfma_f32_16x16x32_bf16 v[132:135], a[16:19], v[36:39], v[132:135]
v_rcp_f32 v242, v242
v_mfma_f32_16x16x32_bf16 v[140:143], a[24:27], v[36:39], 0
ds_read_b128 a[16:19], v225 offset:20480
s_waitcnt lgkmcnt(4)
v_mfma_f32_16x16x32_bf16 v[140:143], a[28:31], v[44:47], v[140:143]
s_add_u32 m0, s36, 49152
s_add_u32 s57, s37, 442368
v_mfma_f32_16x16x32_bf16 v[136:139], a[28:31], v[40:43], 0
buffer_load_dwordx4 v226, s[20:23], s57 offen offset:0 sc1 lds
v_mfma_f32_16x16x32_bf16 v[136:139], a[24:27], v[32:35], v[136:139]
ds_read_b128 a[20:23], v225 offset:21504
v_fmaak_f32 v238, v228, v238, 0xc0135761
v_mfma_f32_16x16x32_bf16 v[0:3], a[0:3], v[144:147], v[0:3]
ds_read_b128 a[24:27], v225 offset:22528
s_waitcnt vmcnt(14) lgkmcnt(4)
v_mfma_f32_16x16x32_bf16 v[0:3], a[4:7], v[152:155], v[0:3]
v_rcp_f32 v243, v243
v_mfma_f32_16x16x32_bf16 v[4:7], a[4:7], v[156:159], v[4:7]
ds_read_b128 a[28:31], v225 offset:23552
v_fmaak_f32 v239, v228, v239, 0xc0135761
v_mfma_f32_16x16x32_bf16 v[4:7], a[0:3], v[148:151], v[4:7]
buffer_load_dwordx4 v226, s[20:23], s57 offen offset:1024 sc1 lds
v_mfma_f32_16x16x32_bf16 v[12:15], a[8:11], v[148:151], v[12:15]
ds_read_b128 a[0:3], v225 offset:24576
s_waitcnt lgkmcnt(4)
v_mfma_f32_16x16x32_bf16 v[12:15], a[12:15], v[156:159], v[12:15]
v_mul_f32 v184, v184, v240
v_mul_f32 v236, v236, v68
v_mfma_f32_16x16x32_bf16 v[8:11], a[12:15], v[152:155], v[8:11]
ds_read_b128 a[4:7], v225 offset:25600
v_mul_f32 v185, v185, v241
v_mfma_f32_16x16x32_bf16 v[8:11], a[8:11], v[144:147], v[8:11]
buffer_load_dwordx4 v226, s[20:23], s57 offen offset:2048 sc1 lds
v_mfma_f32_16x16x32_bf16 v[16:19], a[16:19], v[144:147], v[16:19]
ds_read_b128 a[8:11], v225 offset:26624
s_waitcnt lgkmcnt(4)
v_mfma_f32_16x16x32_bf16 v[16:19], a[20:23], v[152:155], v[16:19]
v_mul_f32 v237, v237, v69
v_mul_f32 v186, v186, v242
v_mfma_f32_16x16x32_bf16 v[20:23], a[20:23], v[156:159], v[20:23]
ds_read_b128 a[12:15], v225 offset:27648
v_mul_f32 v238, v238, v70
v_mfma_f32_16x16x32_bf16 v[20:23], a[16:19], v[148:151], v[20:23]
v_mul_f32 v187, v187, v243
v_mul_f32 v239, v239, v71
v_mfma_f32_16x16x32_bf16 v[28:31], a[24:27], v[148:151], v[28:31]
ds_read_b128 a[16:19], v225 offset:28672
s_waitcnt lgkmcnt(4)
v_mfma_f32_16x16x32_bf16 v[28:31], a[28:31], v[156:159], v[28:31]
buffer_load_dwordx4 v226, s[20:23], s57 offen offset:3072 sc1 lds
v_mfma_f32_16x16x32_bf16 v[24:27], a[28:31], v[152:155], v[24:27]
ds_read_b128 a[20:23], v225 offset:29696
v_cvt_pk_bf16_f32 v72, v184, v185
v_mfma_f32_16x16x32_bf16 v[24:27], a[24:27], v[144:147], v[24:27]
v_exp_f32 v236, v236
v_mfma_f32_16x16x32_bf16 v[112:115], a[0:3], v[144:147], v[112:115]
ds_read_b128 a[24:27], v225 offset:30720
s_waitcnt lgkmcnt(4)
v_mfma_f32_16x16x32_bf16 v[112:115], a[4:7], v[152:155], v[112:115]
s_add_u32 s10, s84, 8192
s_barrier
v_mfma_f32_16x16x32_bf16 v[116:119], a[4:7], v[156:159], v[116:119]
buffer_load_dwordx4 v[32:35], v224, s[20:23], s10 offen offset:0 sc1
v_mfma_f32_16x16x32_bf16 v[116:119], a[0:3], v[148:151], v[116:119]
ds_read_b128 a[28:31], v225 offset:31744
v_cvt_pk_bf16_f32 v73, v186, v187
v_mfma_f32_16x16x32_bf16 v[124:127], a[8:11], v[148:151], v[124:127]
ds_read_b128 a[0:3], v225 offset:32768
s_waitcnt lgkmcnt(4)
v_mfma_f32_16x16x32_bf16 v[124:127], a[12:15], v[156:159], v[124:127]
v_mul_f32 v180, v180, v68
v_mul_f32 v240, v76, v76
v_mfma_f32_16x16x32_bf16 v[120:123], a[12:15], v[152:155], v[120:123]
ds_read_b128 a[4:7], v225 offset:33792
v_mul_f32 v241, v77, v77
v_mfma_f32_16x16x32_bf16 v[120:123], a[8:11], v[144:147], v[120:123]
s_add_u32 s11, s84, 122880
v_mul_f32 v242, v78, v78
v_mfma_f32_16x16x32_bf16 v[128:131], a[16:19], v[144:147], v[128:131]
v_mul_f32 v243, v79, v79
s_waitcnt lgkmcnt(3)
v_mfma_f32_16x16x32_bf16 v[128:131], a[20:23], v[152:155], v[128:131]
buffer_load_dwordx4 v[36:39], v224, s[20:23], s11 offen offset:0 sc1
v_mfma_f32_16x16x32_bf16 v[132:135], a[20:23], v[156:159], v[132:135]
ds_read_b128 a[8:11], v225 offset:34816
v_fmaak_f32 v240, v228, v240, 0xc0135761
v_mfma_f32_16x16x32_bf16 v[132:135], a[16:19], v[148:151], v[132:135]
ds_read_b128 a[12:15], v225 offset:35840
v_fmaak_f32 v241, v228, v241, 0xc0135761
v_mfma_f32_16x16x32_bf16 v[140:143], a[24:27], v[148:151], v[140:143]
v_fmaak_f32 v242, v228, v242, 0xc0135761
s_waitcnt lgkmcnt(3)
v_mfma_f32_16x16x32_bf16 v[140:143], a[28:31], v[156:159], v[140:143]
buffer_load_dwordx4 v[40:43], v224, s[20:23], s10 offen offset:1024 sc1
v_mfma_f32_16x16x32_bf16 v[136:139], a[28:31], v[152:155], v[136:139]
ds_read_b128 a[16:19], v225 offset:36864
v_fmaak_f32 v243, v228, v243, 0xc0135761
v_mfma_f32_16x16x32_bf16 v[136:139], a[24:27], v[144:147], v[136:139]
ds_read_b128 a[20:23], v225 offset:37888
s_waitcnt vmcnt(18)
v_mfma_f32_16x16x32_bf16 v[0:3], a[0:3], v[48:51], v[0:3]
ds_read_b128 a[24:27], v225 offset:38912
s_waitcnt vmcnt(16) lgkmcnt(4)
v_mfma_f32_16x16x32_bf16 v[0:3], a[4:7], v[56:59], v[0:3]
buffer_load_dwordx4 v[44:47], v224, s[20:23], s11 offen offset:1024 sc1
v_mfma_f32_16x16x32_bf16 v[4:7], a[4:7], v[60:63], v[4:7]
ds_read_b128 a[28:31], v225 offset:39936
v_mul_f32 v240, v240, v76
v_mfma_f32_16x16x32_bf16 v[4:7], a[0:3], v[52:55], v[4:7]
v_exp_f32 v237, v237
v_mfma_f32_16x16x32_bf16 v[12:15], a[8:11], v[52:55], v[12:15]
ds_read_b128 a[0:3], v225 offset:40960
s_waitcnt lgkmcnt(4)
v_mfma_f32_16x16x32_bf16 v[12:15], a[12:15], v[60:63], v[12:15]
s_add_u32 m0, s36, 65536
s_add_u32 s57, s93, 98304
v_mfma_f32_16x16x32_bf16 v[8:11], a[12:15], v[56:59], v[8:11]
buffer_load_dwordx4 v226, s[20:23], s57 offen offset:0 sc1 lds
v_mfma_f32_16x16x32_bf16 v[8:11], a[8:11], v[48:51], v[8:11]
ds_read_b128 a[4:7], v225 offset:41984
v_mul_f32 v241, v241, v77
v_mfma_f32_16x16x32_bf16 v[16:19], a[16:19], v[48:51], v[16:19]
ds_read_b128 a[8:11], v225 offset:43008
s_waitcnt lgkmcnt(4)
v_mfma_f32_16x16x32_bf16 v[16:19], a[20:23], v[56:59], v[16:19]
v_mul_f32 v181, v181, v69
v_mul_f32 v242, v242, v78
v_mfma_f32_16x16x32_bf16 v[20:23], a[20:23], v[60:63], v[20:23]
ds_read_b128 a[12:15], v225 offset:44032
v_mul_f32 v243, v243, v79
v_mfma_f32_16x16x32_bf16 v[20:23], a[16:19], v[52:55], v[20:23]
buffer_load_dwordx4 v226, s[20:23], s57 offen offset:1024 sc1 lds
v_mfma_f32_16x16x32_bf16 v[28:31], a[24:27], v[52:55], v[28:31]
ds_read_b128 a[16:19], v225 offset:45056
s_waitcnt lgkmcnt(4)
v_mfma_f32_16x16x32_bf16 v[28:31], a[28:31], v[60:63], v[28:31]
v_exp_f32 v238, v238
v_mfma_f32_16x16x32_bf16 v[24:27], a[28:31], v[56:59], v[24:27]
ds_read_b128 a[20:23], v225 offset:46080
v_mul_f32 v182, v182, v70
v_mfma_f32_16x16x32_bf16 v[24:27], a[24:27], v[48:51], v[24:27]
buffer_load_dwordx4 v226, s[20:23], s57 offen offset:2048 sc1 lds
v_mfma_f32_16x16x32_bf16 v[112:115], a[0:3], v[48:51], v[112:115]
ds_read_b128 a[24:27], v225 offset:47104
s_waitcnt lgkmcnt(4)
v_mfma_f32_16x16x32_bf16 v[112:115], a[4:7], v[56:59], v[112:115]
s_barrier
v_mfma_f32_16x16x32_bf16 v[116:119], a[4:7], v[60:63], v[116:119]
ds_read_b128 a[28:31], v225 offset:48128
v_mfma_f32_16x16x32_bf16 v[116:119], a[0:3], v[52:55], v[116:119]
v_exp_f32 v240, v240
v_mfma_f32_16x16x32_bf16 v[124:127], a[8:11], v[52:55], v[124:127]
ds_read_b128 a[0:3], v225 offset:49152
s_waitcnt lgkmcnt(4)
v_mfma_f32_16x16x32_bf16 v[124:127], a[12:15], v[60:63], v[124:127]
buffer_load_dwordx4 v226, s[20:23], s57 offen offset:3072 sc1 lds
v_mfma_f32_16x16x32_bf16 v[120:123], a[12:15], v[56:59], v[120:123]
ds_read_b128 a[4:7], v225 offset:50176
v_mul_f32 v188, v188, v76
v_mfma_f32_16x16x32_bf16 v[120:123], a[8:11], v[48:51], v[120:123]
v_exp_f32 v239, v239
v_mfma_f32_16x16x32_bf16 v[128:131], a[16:19], v[48:51], v[128:131]
ds_read_b128 a[8:11], v225 offset:51200
s_waitcnt lgkmcnt(4)
v_mfma_f32_16x16x32_bf16 v[128:131], a[20:23], v[56:59], v[128:131]
buffer_load_dwordx4 v[144:147], v224, s[20:23], s10 offen offset:2048 sc1
v_mfma_f32_16x16x32_bf16 v[132:135], a[20:23], v[60:63], v[132:135]
ds_read_b128 a[12:15], v225 offset:52224
v_mul_f32 v183, v183, v71
v_mfma_f32_16x16x32_bf16 v[132:135], a[16:19], v[52:55], v[132:135]
v_exp_f32 v241, v241
v_mfma_f32_16x16x32_bf16 v[140:143], a[24:27], v[52:55], v[140:143]
ds_read_b128 a[16:19], v225 offset:53248
s_waitcnt lgkmcnt(4)
v_mfma_f32_16x16x32_bf16 v[140:143], a[28:31], v[60:63], v[140:143]
v_add_f32 v236, 1.0, v236
v_mul_f32 v189, v189, v77
v_mfma_f32_16x16x32_bf16 v[136:139], a[28:31], v[56:59], v[136:139]
ds_read_b128 a[20:23], v225 offset:54272
v_add_f32 v237, 1.0, v237
v_mfma_f32_16x16x32_bf16 v[136:139], a[24:27], v[48:51], v[136:139]
buffer_load_dwordx4 v[148:151], v224, s[20:23], s11 offen offset:2048 sc1
v_mfma_f32_16x16x32_bf16 v[80:83], a[0:3], a[64:67], v[80:83]
ds_read_b128 a[24:27], v225 offset:55296
s_waitcnt lgkmcnt(4)
v_mfma_f32_16x16x32_bf16 v[80:83], a[4:7], a[80:83], v[80:83]
v_exp_f32 v242, v242
v_mfma_f32_16x16x32_bf16 v[84:87], a[4:7], a[84:87], v[84:87]
v_add_f32 v238, 1.0, v238
v_mul_f32 v190, v190, v78
v_mfma_f32_16x16x32_bf16 v[84:87], a[0:3], a[68:71], v[84:87]
v_exp_f32 v243, v243
v_mfma_f32_16x16x32_bf16 v[88:91], a[0:3], a[72:75], v[88:91]
ds_read_b128 a[28:31], v225 offset:56320
v_add_f32 v239, 1.0, v239
v_mfma_f32_16x16x32_bf16 v[88:91], a[4:7], a[88:91], v[88:91]
buffer_load_dwordx4 v[152:155], v224, s[20:23], s10 offen offset:3072 sc1
v_mfma_f32_16x16x32_bf16 v[92:95], a[4:7], a[92:95], v[92:95]
v_rcp_f32 v236, v236
v_mfma_f32_16x16x32_bf16 v[92:95], a[0:3], a[76:79], v[92:95]
v_rcp_f32 v237, v237
v_mfma_f32_16x16x32_bf16 v[204:207], a[8:11], a[76:79], v[204:207]
ds_read_b128 a[0:3], v225 offset:57344
s_waitcnt lgkmcnt(4)
v_mfma_f32_16x16x32_bf16 v[204:207], a[12:15], a[92:95], v[204:207]
buffer_load_dwordx4 v[156:159], v224, s[20:23], s11 offen offset:3072 sc1
v_mfma_f32_16x16x32_bf16 v[200:203], a[12:15], a[88:91], v[200:203]
v_rcp_f32 v238, v238
v_mfma_f32_16x16x32_bf16 v[200:203], a[8:11], a[72:75], v[200:203]
v_rcp_f32 v239, v239
v_mfma_f32_16x16x32_bf16 v[196:199], a[8:11], a[68:71], v[196:199]
ds_read_b128 a[4:7], v225 offset:58368
v_mul_f32 v191, v191, v79
v_mfma_f32_16x16x32_bf16 v[196:199], a[12:15], a[84:87], v[196:199]
s_add_u32 m0, s36, 81920
v_mul_f32 v180, v180, v236
v_mfma_f32_16x16x32_bf16 v[192:195], a[12:15], a[80:83], v[192:195]
s_add_u32 s57, s93, 114688
v_add_f32 v240, 1.0, v240
v_mfma_f32_16x16x32_bf16 v[192:195], a[8:11], a[64:67], v[192:195]
buffer_load_dwordx4 v226, s[20:23], s57 offen offset:0 sc1 lds
v_mfma_f32_16x16x32_bf16 v[96:99], a[16:19], a[96:99], v[96:99]
ds_read_b128 a[8:11], v225 offset:59392
v_mul_f32 v181, v181, v237
s_waitcnt lgkmcnt(4)
v_mfma_f32_16x16x32_bf16 v[96:99], a[20:23], a[112:115], v[96:99]
v_add_f32 v241, 1.0, v241
v_mul_f32 v182, v182, v238
v_mfma_f32_16x16x32_bf16 v[100:103], a[20:23], a[116:119], v[100:103]
v_add_f32 v242, 1.0, v242
v_mul_f32 v183, v183, v239
v_add_f32 v243, 1.0, v243
v_mfma_f32_16x16x32_bf16 v[100:103], a[16:19], a[100:103], v[100:103]
v_rcp_f32 v240, v240
v_mfma_f32_16x16x32_bf16 v[104:107], a[16:19], a[104:107], v[104:107]
ds_read_b128 a[12:15], v225 offset:60416
v_rcp_f32 v241, v241
v_mfma_f32_16x16x32_bf16 v[104:107], a[20:23], a[120:123], v[104:107]
buffer_load_dwordx4 v226, s[20:23], s57 offen offset:1024 sc1 lds
v_mfma_f32_16x16x32_bf16 v[108:111], a[20:23], a[124:127], v[108:111]
v_rcp_f32 v242, v242
v_cvt_pk_bf16_f32 v66, v180, v181
v_mfma_f32_16x16x32_bf16 v[108:111], a[16:19], a[108:111], v[108:111]
v_rcp_f32 v243, v243
v_mfma_f32_16x16x32_bf16 v[220:223], a[24:27], a[108:111], v[220:223]
ds_read_b128 a[16:19], v225 offset:61440
v_cvt_pk_bf16_f32 v67, v182, v183
s_waitcnt lgkmcnt(4)
v_mfma_f32_16x16x32_bf16 v[220:223], a[28:31], a[124:127], v[220:223]
buffer_load_dwordx4 v226, s[20:23], s57 offen offset:2048 sc1 lds
v_mfma_f32_16x16x32_bf16 v[216:219], a[28:31], a[120:123], v[216:219]
v_mul_f32 v188, v188, v240
s_add_u32 s16, s41, 32768
v_mul_f32 v189, v189, v241
v_mfma_f32_16x16x32_bf16 v[216:219], a[24:27], a[104:107], v[216:219]
v_permlane32_swap_b32 v64, v66
buffer_load_dword v234, v235, s[20:23], s46 offen sc1
v_mfma_f32_16x16x32_bf16 v[212:215], a[24:27], a[100:103], v[212:215]
ds_read_b128 a[20:23], v225 offset:62464
v_permlane32_swap_b32 v65, v67
v_mfma_f32_16x16x32_bf16 v[212:215], a[28:31], a[116:119], v[212:215]
buffer_load_dwordx4 v226, s[20:23], s57 offen offset:3072 sc1 lds
v_mfma_f32_16x16x32_bf16 v[208:211], a[28:31], a[112:115], v[208:211]
buffer_store_dwordx4 v[64:67], v227, s[20:23], s16 offen sc1
v_mul_f32 v190, v190, v242
v_mfma_f32_16x16x32_bf16 v[208:211], a[24:27], a[96:99], v[208:211]
v_mul_f32 v236, v80, v80
v_mul_f32 v191, v191, v243
v_mfma_f32_16x16x32_bf16 v[96:99], a[0:3], a[128:131], v[96:99]
ds_read_b128 a[24:27], v225 offset:63488
v_mul_f32 v237, v81, v81
s_waitcnt lgkmcnt(4)
v_mfma_f32_16x16x32_bf16 v[96:99], a[4:7], a[144:147], v[96:99]
s_add_u32 s10, s85, 12288
v_cvt_pk_bf16_f32 v74, v188, v189
v_mfma_f32_16x16x32_bf16 v[100:103], a[4:7], a[148:151], v[100:103]
buffer_load_dwordx4 v[48:51], v224, s[20:23], s10 offen offset:0 sc1
v_mul_f32 v238, v82, v82
v_mfma_f32_16x16x32_bf16 v[100:103], a[0:3], a[132:135], v[100:103]
v_cvt_pk_bf16_f32 v75, v190, v191
s_barrier
v_mfma_f32_16x16x32_bf16 v[104:107], a[0:3], a[136:139], v[104:107]
ds_read_b128 a[28:31], v225 offset:64512
v_mul_f32 v239, v83, v83
s_add_u32 s59, s41, 262144
v_mfma_f32_16x16x32_bf16 v[104:107], a[4:7], a[152:155], v[104:107]
v_permlane32_swap_b32 v72, v74
v_mfma_f32_16x16x32_bf16 v[108:111], a[4:7], a[156:159], v[108:111]
v_permlane32_swap_b32 v73, v75
v_fmaak_f32 v236, v228, v236, 0xc0135761
v_mfma_f32_16x16x32_bf16 v[108:111], a[0:3], a[140:143], v[108:111]
buffer_store_dwordx4 v[72:75], v227, s[20:23], s59 offen sc1
v_mfma_f32_16x16x32_bf16 v[220:223], a[8:11], a[140:143], v[220:223]
ds_read_b128 a[0:3], v224 offset:0
v_fmaak_f32 v237, v228, v237, 0xc0135761
s_waitcnt lgkmcnt(4)
v_mfma_f32_16x16x32_bf16 v[220:223], a[12:15], a[156:159], v[220:223]
s_add_u32 s11, s85, 126976
v_mul_f32 v240, v88, v88
v_mfma_f32_16x16x32_bf16 v[216:219], a[12:15], a[152:155], v[216:219]
buffer_load_dwordx4 v[52:55], v224, s[20:23], s11 offen offset:0 sc1
v_fmaak_f32 v238, v228, v238, 0xc0135761
v_mfma_f32_16x16x32_bf16 v[216:219], a[8:11], a[136:139], v[216:219]
v_mul_f32 v241, v89, v89
v_fmaak_f32 v239, v228, v239, 0xc0135761
v_mfma_f32_16x16x32_bf16 v[212:215], a[8:11], a[132:135], v[212:215]
ds_read_b128 a[4:7], v224 offset:1024
v_mul_f32 v242, v90, v90
v_mul_f32 v236, v236, v80
v_mfma_f32_16x16x32_bf16 v[212:215], a[12:15], a[148:151], v[212:215]
buffer_load_dwordx4 v[56:59], v224, s[20:23], s10 offen offset:1024 sc1
v_mfma_f32_16x16x32_bf16 v[208:211], a[12:15], a[144:147], v[208:211]
v_mul_f32 v243, v91, v91
v_mul_f32 v237, v237, v81
v_fmaak_f32 v240, v228, v240, 0xc0135761
v_mfma_f32_16x16x32_bf16 v[208:211], a[8:11], a[128:131], v[208:211]
v_mul_f32 v238, v238, v82
v_fmaak_f32 v241, v228, v241, 0xc0135761
v_mfma_f32_16x16x32_bf16 v[96:99], a[16:19], a[160:163], v[96:99]
ds_read_b128 a[8:11], v224 offset:2048
s_waitcnt lgkmcnt(4)
v_mfma_f32_16x16x32_bf16 v[96:99], a[20:23], a[176:179], v[96:99]
buffer_load_dwordx4 v[60:63], v224, s[20:23], s11 offen offset:1024 sc1
v_mfma_f32_16x16x32_bf16 v[100:103], a[20:23], a[180:183], v[100:103]
v_mul_f32 v239, v239, v83
v_fmaak_f32 v242, v228, v242, 0xc0135761
v_mfma_f32_16x16x32_bf16 v[100:103], a[16:19], a[164:167], v[100:103]
v_exp_f32 v236, v236
v_mfma_f32_16x16x32_bf16 v[104:107], a[16:19], a[168:171], v[104:107]
ds_read_b128 a[12:15], v224 offset:3072
v_fmaak_f32 v243, v228, v243, 0xc0135761
v_mfma_f32_16x16x32_bf16 v[104:107], a[20:23], a[184:187], v[104:107]
buffer_load_dwordx4 a[96:99], v224, s[20:23], s10 offen offset:2048 sc1
v_mfma_f32_16x16x32_bf16 v[108:111], a[20:23], a[188:191], v[108:111]
v_mul_f32 v192, v192, v80
v_mul_f32 v240, v240, v88
v_mfma_f32_16x16x32_bf16 v[108:111], a[16:19], a[172:175], v[108:111]
v_exp_f32 v237, v237
v_mfma_f32_16x16x32_bf16 v[220:223], a[24:27], a[172:175], v[220:223]
ds_read_b128 a[16:19], v224 offset:4096
s_waitcnt lgkmcnt(4)
v_mfma_f32_16x16x32_bf16 v[220:223], a[28:31], a[188:191], v[220:223]
v_mul_f32 v241, v241, v89
v_mul_f32 v193, v193, v81
v_mfma_f32_16x16x32_bf16 v[216:219], a[28:31], a[184:187], v[216:219]
v_exp_f32 v238, v238
v_mfma_f32_16x16x32_bf16 v[216:219], a[24:27], a[168:171], v[216:219]
v_mul_f32 v242, v242, v90
v_mul_f32 v194, v194, v82
v_mfma_f32_16x16x32_bf16 v[212:215], a[24:27], a[164:167], v[212:215]
ds_read_b128 a[20:23], v224 offset:5120
v_mul_f32 v243, v243, v91
v_mfma_f32_16x16x32_bf16 v[212:215], a[28:31], a[180:183], v[212:215]
buffer_load_dwordx4 a[100:103], v224, s[20:23], s11 offen offset:2048 sc1
v_mfma_f32_16x16x32_bf16 v[208:211], a[28:31], a[176:179], v[208:211]
v_exp_f32 v239, v239
v_mfma_f32_16x16x32_bf16 v[208:211], a[24:27], a[160:163], v[208:211]
v_mul_f32 v195, v195, v83
s_waitcnt vmcnt(36)
v_mfma_f32_16x16x32_bf16 v[0:3], a[0:3], v[160:163], v[0:3]
ds_read_b128 a[24:27], v224 offset:6144
s_waitcnt vmcnt(33) lgkmcnt(4)
v_mfma_f32_16x16x32_bf16 v[0:3], a[4:7], v[168:171], v[0:3]
buffer_load_dwordx4 a[104:107], v224, s[20:23], s10 offen offset:3072 sc1
v_mfma_f32_16x16x32_bf16 v[4:7], a[4:7], v[172:175], v[4:7]
ds_read_b128 a[28:31], v224 offset:7168
v_add_f32 v236, 1.0, v236
v_mfma_f32_16x16x32_bf16 v[4:7], a[0:3], v[164:167], v[4:7]
v_exp_f32 v240, v240
s_waitcnt vmcnt(10)
v_cmp_ne_u32 vcc, v253, v234
s_nop 0
s_and_b32 s14, vcc_lo, 0xffff
s_cbranch_scc1 L_poll8
L_poll8_ok:
s_add_u32 s46, s46, 0x4000
v_mfma_f32_16x16x32_bf16 v[12:15], a[8:11], v[164:167], v[12:15]
ds_read_b128 a[0:3], v224 offset:8192
s_waitcnt lgkmcnt(4)
v_mfma_f32_16x16x32_bf16 v[12:15], a[12:15], v[172:175], v[12:15]
buffer_load_dwordx4 a[108:111], v224, s[20:23], s11 offen offset:3072 sc1
v_mfma_f32_16x16x32_bf16 v[8:11], a[12:15], v[168:171], v[8:11]
ds_read_b128 a[4:7], v224 offset:9216
v_add_f32 v237, 1.0, v237
v_mfma_f32_16x16x32_bf16 v[8:11], a[8:11], v[160:163], v[8:11]
v_mul_f32 v200, v200, v88
v_add_f32 v238, 1.0, v238
v_mfma_f32_16x16x32_bf16 v[16:19], a[16:19], v[160:163], v[16:19]
ds_read_b128 a[8:11], v224 offset:10240
s_waitcnt lgkmcnt(4)
v_mfma_f32_16x16x32_bf16 v[16:19], a[20:23], v[168:171], v[16:19]
s_add_u32 m0, s36, 98304
s_add_u32 s57, s92, 131072
v_mfma_f32_16x16x32_bf16 v[20:23], a[20:23], v[172:175], v[20:23]
buffer_load_dwordx4 v226, s[20:23], s57 offen offset:0 sc1 lds
v_mfma_f32_16x16x32_bf16 v[20:23], a[16:19], v[164:167], v[20:23]
ds_read_b128 a[12:15], v224 offset:11264
v_add_f32 v239, 1.0, v239
v_mfma_f32_16x16x32_bf16 v[28:31], a[24:27], v[164:167], v[28:31]
ds_read_b128 a[16:19], v224 offset:12288
s_waitcnt lgkmcnt(4)
v_mfma_f32_16x16x32_bf16 v[28:31], a[28:31], v[172:175], v[28:31]
v_exp_f32 v241, v241
v_mfma_f32_16x16x32_bf16 v[24:27], a[28:31], v[168:171], v[24:27]
ds_read_b128 a[20:23], v224 offset:13312
v_mul_f32 v201, v201, v89
v_mfma_f32_16x16x32_bf16 v[24:27], a[24:27], v[160:163], v[24:27]
buffer_load_dwordx4 v226, s[20:23], s57 offen offset:1024 sc1 lds
v_mfma_f32_16x16x32_bf16 v[112:115], a[0:3], v[160:163], v[112:115]
ds_read_b128 a[24:27], v224 offset:14336
s_waitcnt lgkmcnt(4)
v_mfma_f32_16x16x32_bf16 v[112:115], a[4:7], v[168:171], v[112:115]
s_barrier
v_mfma_f32_16x16x32_bf16 v[116:119], a[4:7], v[172:175], v[116:119]
ds_read_b128 a[28:31], v224 offset:15360
v_mfma_f32_16x16x32_bf16 v[116:119], a[0:3], v[164:167], v[116:119]
buffer_load_dwordx4 v226, s[20:23], s57 offen offset:2048 sc1 lds
v_mfma_f32_16x16x32_bf16 v[124:127], a[8:11], v[164:167], v[124:127]
ds_read_b128 a[0:3], v224 offset:16384
s_waitcnt lgkmcnt(4)
v_mfma_f32_16x16x32_bf16 v[124:127], a[12:15], v[172:175], v[124:127]
v_rcp_f32 v236, v236
v_mfma_f32_16x16x32_bf16 v[120:123], a[12:15], v[168:171], v[120:123]
ds_read_b128 a[4:7], v224 offset:17408
v_mfma_f32_16x16x32_bf16 v[120:123], a[8:11], v[160:163], v[120:123]
v_exp_f32 v242, v242
L_ct3:
s_waitcnt vmcnt(10)
s_mov_b64 exec, 1
buffer_store_dword v253, off, s[20:23], s45 sc1
s_mov_b64 exec, -1
s_add_u32 s45, s45, 0x4000
v_mfma_f32_16x16x32_bf16 v[128:131], a[16:19], v[160:163], v[128:131]
ds_read_b128 a[8:11], v224 offset:18432
s_waitcnt lgkmcnt(4)
v_mfma_f32_16x16x32_bf16 v[128:131], a[20:23], v[168:171], v[128:131]
buffer_load_dwordx4 v226, s[20:23], s57 offen offset:3072 sc1 lds
v_mfma_f32_16x16x32_bf16 v[132:135], a[20:23], v[172:175], v[132:135]
ds_read_b128 a[12:15], v224 offset:19456
v_mul_f32 v202, v202, v90
v_mfma_f32_16x16x32_bf16 v[132:135], a[16:19], v[164:167], v[132:135]
v_rcp_f32 v237, v237
v_mfma_f32_16x16x32_bf16 v[140:143], a[24:27], v[164:167], v[140:143]
ds_read_b128 a[16:19], v224 offset:20480
s_waitcnt lgkmcnt(4)
v_mfma_f32_16x16x32_bf16 v[140:143], a[28:31], v[172:175], v[140:143]
s_add_u32 s10, s84, 16384
v_mfma_f32_16x16x32_bf16 v[136:139], a[28:31], v[168:171], v[136:139]
buffer_load_dwordx4 a[112:115], v224, s[20:23], s10 offen offset:0 sc1
v_mfma_f32_16x16x32_bf16 v[136:139], a[24:27], v[160:163], v[136:139]
ds_read_b128 a[20:23], v224 offset:21504
v_mfma_f32_16x16x32_bf16 v[0:3], a[0:3], v[32:35], v[0:3]
ds_read_b128 a[24:27], v224 offset:22528
s_waitcnt lgkmcnt(4)
v_mfma_f32_16x16x32_bf16 v[0:3], a[4:7], v[40:43], v[0:3]
v_exp_f32 v243, v243
v_mfma_f32_16x16x32_bf16 v[4:7], a[4:7], v[44:47], v[4:7]
ds_read_b128 a[28:31], v224 offset:23552
v_mul_f32 v203, v203, v91
v_mfma_f32_16x16x32_bf16 v[4:7], a[0:3], v[36:39], v[4:7]
s_add_u32 s11, s84, 131072
v_add_f32 v240, 1.0, v240
v_mfma_f32_16x16x32_bf16 v[12:15], a[8:11], v[36:39], v[12:15]
v_add_f32 v241, 1.0, v241
s_waitcnt lgkmcnt(3)
v_mfma_f32_16x16x32_bf16 v[12:15], a[12:15], v[44:47], v[12:15]
buffer_load_dwordx4 a[116:119], v224, s[20:23], s11 offen offset:0 sc1
v_mfma_f32_16x16x32_bf16 v[8:11], a[12:15], v[40:43], v[8:11]
ds_read_b128 a[0:3], v224 offset:24576
v_add_f32 v242, 1.0, v242
v_mfma_f32_16x16x32_bf16 v[8:11], a[8:11], v[32:35], v[8:11]
ds_read_b128 a[4:7], v224 offset:25600
v_add_f32 v243, 1.0, v243
v_mfma_f32_16x16x32_bf16 v[16:19], a[16:19], v[32:35], v[16:19]
s_waitcnt lgkmcnt(3)
v_mfma_f32_16x16x32_bf16 v[16:19], a[20:23], v[40:43], v[16:19]
buffer_load_dwordx4 a[120:123], v224, s[20:23], s10 offen offset:1024 sc1
v_mfma_f32_16x16x32_bf16 v[20:23], a[20:23], v[44:47], v[20:23]
ds_read_b128 a[8:11], v224 offset:26624
v_mfma_f32_16x16x32_bf16 v[20:23], a[16:19], v[36:39], v[20:23]
ds_read_b128 a[12:15], v224 offset:27648
v_mfma_f32_16x16x32_bf16 v[28:31], a[24:27], v[36:39], v[28:31]
ds_read_b128 a[16:19], v224 offset:28672
s_waitcnt lgkmcnt(4)
v_mfma_f32_16x16x32_bf16 v[28:31], a[28:31], v[44:47], v[28:31]
buffer_load_dwordx4 a[124:127], v224, s[20:23], s11 offen offset:1024 sc1
v_mfma_f32_16x16x32_bf16 v[24:27], a[28:31], v[40:43], v[24:27]
ds_read_b128 a[20:23], v224 offset:29696
v_mfma_f32_16x16x32_bf16 v[24:27], a[24:27], v[32:35], v[24:27]
v_rcp_f32 v238, v238
v_mfma_f32_16x16x32_bf16 v[112:115], a[0:3], v[32:35], v[112:115]
ds_read_b128 a[24:27], v224 offset:30720
s_waitcnt lgkmcnt(4)
v_mfma_f32_16x16x32_bf16 v[112:115], a[4:7], v[40:43], v[112:115]
s_barrier
v_mfma_f32_16x16x32_bf16 v[116:119], a[4:7], v[44:47], v[116:119]
buffer_load_dwordx4 v[64:67], v224, s[20:23], s10 offen offset:2048 sc1
v_mfma_f32_16x16x32_bf16 v[116:119], a[0:3], v[36:39], v[116:119]
ds_read_b128 a[28:31], v224 offset:31744
v_mfma_f32_16x16x32_bf16 v[124:127], a[8:11], v[36:39], v[124:127]
ds_read_b128 a[0:3], v224 offset:32768
s_waitcnt lgkmcnt(4)
v_mfma_f32_16x16x32_bf16 v[124:127], a[12:15], v[44:47], v[124:127]
v_rcp_f32 v240, v240
v_mfma_f32_16x16x32_bf16 v[120:123], a[12:15], v[40:43], v[120:123]
ds_read_b128 a[4:7], v224 offset:33792
v_mfma_f32_16x16x32_bf16 v[120:123], a[8:11], v[32:35], v[120:123]
buffer_load_dwordx4 v[68:71], v224, s[20:23], s11 offen offset:2048 sc1
v_mfma_f32_16x16x32_bf16 v[128:131], a[16:19], v[32:35], v[128:131]
ds_read_b128 a[8:11], v224 offset:34816
s_waitcnt lgkmcnt(4)
v_mfma_f32_16x16x32_bf16 v[128:131], a[20:23], v[40:43], v[128:131]
v_rcp_f32 v239, v239
v_mfma_f32_16x16x32_bf16 v[132:135], a[20:23], v[44:47], v[132:135]
ds_read_b128 a[12:15], v224 offset:35840
v_mul_f32 v192, v192, v236
v_mfma_f32_16x16x32_bf16 v[132:135], a[16:19], v[36:39], v[132:135]
buffer_load_dwordx4 v[72:75], v224, s[20:23], s10 offen offset:3072 sc1
v_mfma_f32_16x16x32_bf16 v[140:143], a[24:27], v[36:39], v[140:143]
ds_read_b128 a[16:19], v224 offset:36864
s_waitcnt lgkmcnt(4)
v_mfma_f32_16x16x32_bf16 v[140:143], a[28:31], v[44:47], v[140:143]
v_rcp_f32 v241, v241
v_mfma_f32_16x16x32_bf16 v[136:139], a[28:31], v[40:43], v[136:139]
ds_read_b128 a[20:23], v224 offset:37888
v_mul_f32 v193, v193, v237
v_mfma_f32_16x16x32_bf16 v[136:139], a[24:27], v[32:35], v[136:139]
v_rcp_f32 v242, v242
v_mfma_f32_16x16x32_bf16 v[0:3], a[0:3], v[144:147], v[0:3]
ds_read_b128 a[24:27], v224 offset:38912
s_waitcnt lgkmcnt(4)
v_mfma_f32_16x16x32_bf16 v[0:3], a[4:7], v[152:155], v[0:3]
buffer_load_dwordx4 v[76:79], v224, s[20:23], s11 offen offset:3072 sc1
v_mfma_f32_16x16x32_bf16 v[4:7], a[4:7], v[156:159], v[4:7]
ds_read_b128 a[28:31], v224 offset:39936
v_mul_f32 v194, v194, v238
v_mfma_f32_16x16x32_bf16 v[4:7], a[0:3], v[148:151], v[4:7]
v_rcp_f32 v243, v243
v_mfma_f32_16x16x32_bf16 v[12:15], a[8:11], v[148:151], v[12:15]
ds_read_b128 a[0:3], v224 offset:40960
s_waitcnt lgkmcnt(4)
v_mfma_f32_16x16x32_bf16 v[12:15], a[12:15], v[156:159], v[12:15]
s_add_u32 s10, s85, 20480
v_mul_f32 v195, v195, v239
v_mfma_f32_16x16x32_bf16 v[8:11], a[12:15], v[152:155], v[8:11]
buffer_load_dwordx4 v[176:179], v224, s[20:23], s10 offen offset:0 sc1
v_mfma_f32_16x16x32_bf16 v[8:11], a[8:11], v[144:147], v[8:11]
v_lshlrev_b32 v252, 3, v224
s_mov_b32 s58, L_ct4-L_body
v_mfma_f32_16x16x32_bf16 v[16:19], a[16:19], v[144:147], v[16:19]
v_mul_f32 v200, v200, v240
s_waitcnt lgkmcnt(2)
v_mfma_f32_16x16x32_bf16 v[16:19], a[20:23], v[152:155], v[16:19]
buffer_load_dword v252, v252, s[80:83], s58 offen
v_mfma_f32_16x16x32_bf16 v[20:23], a[20:23], v[156:159], v[20:23]
ds_read_b128 a[4:7], v224 offset:41984
v_cvt_pk_bf16_f32 v80, v192, v193
v_mfma_f32_16x16x32_bf16 v[20:23], a[16:19], v[148:151], v[20:23]
ds_read_b128 a[8:11], v224 offset:43008
v_mul_f32 v201, v201, v241
v_mfma_f32_16x16x32_bf16 v[28:31], a[24:27], v[148:151], v[28:31]
ds_read_b128 a[12:15], v224 offset:44032
s_waitcnt lgkmcnt(3)
v_mfma_f32_16x16x32_bf16 v[28:31], a[28:31], v[156:159], v[28:31]
s_add_u32 s11, s85, 135168
v_cvt_pk_bf16_f32 v81, v194, v195
v_mfma_f32_16x16x32_bf16 v[24:27], a[28:31], v[152:155], v[24:27]
buffer_load_dwordx4 v[180:183], v224, s[20:23], s11 offen offset:0 sc1
v_mfma_f32_16x16x32_bf16 v[24:27], a[24:27], v[144:147], v[24:27]
ds_read_b128 a[16:19], v224 offset:45056
v_mul_f32 v202, v202, v242
v_mfma_f32_16x16x32_bf16 v[112:115], a[0:3], v[144:147], v[112:115]
ds_read_b128 a[20:23], v224 offset:46080
s_waitcnt lgkmcnt(3)
v_mfma_f32_16x16x32_bf16 v[112:115], a[4:7], v[152:155], v[112:115]
v_mul_f32 v236, v84, v84
s_barrier
v_mfma_f32_16x16x32_bf16 v[116:119], a[4:7], v[156:159], v[116:119]
buffer_load_dwordx4 v[184:187], v224, s[20:23], s10 offen offset:1024 sc1
v_mfma_f32_16x16x32_bf16 v[116:119], a[0:3], v[148:151], v[116:119]
ds_read_b128 a[24:27], v224 offset:47104
v_mul_f32 v203, v203, v243
v_mfma_f32_16x16x32_bf16 v[124:127], a[8:11], v[148:151], v[124:127]
ds_read_b128 a[28:31], v224 offset:48128
s_waitcnt lgkmcnt(3)
v_mfma_f32_16x16x32_bf16 v[124:127], a[12:15], v[156:159], v[124:127]
ds_read_b128 a[0:3], v224 offset:49152
v_mul_f32 v237, v85, v85
v_mfma_f32_16x16x32_bf16 v[120:123], a[12:15], v[152:155], v[120:123]
buffer_load_dwordx4 v[188:191], v224, s[20:23], s11 offen offset:1024 sc1
v_mfma_f32_16x16x32_bf16 v[120:123], a[8:11], v[144:147], v[120:123]
ds_read_b128 a[4:7], v224 offset:50176
v_cvt_pk_bf16_f32 v88, v200, v201
v_mfma_f32_16x16x32_bf16 v[128:131], a[16:19], v[144:147], v[128:131]
ds_read_b128 a[8:11], v224 offset:51200
s_waitcnt lgkmcnt(4)
v_mfma_f32_16x16x32_bf16 v[128:131], a[20:23], v[152:155], v[128:131]
buffer_load_dwordx4 a[128:131], v224, s[20:23], s10 offen offset:2048 sc1
v_mfma_f32_16x16x32_bf16 v[132:135], a[20:23], v[156:159], v[132:135]
ds_read_b128 a[12:15], v224 offset:52224
v_mul_f32 v238, v86, v86
v_mfma_f32_16x16x32_bf16 v[132:135], a[16:19], v[148:151], v[132:135]
v_cvt_pk_bf16_f32 v89, v202, v203
v_mul_f32 v239, v87, v87
v_mfma_f32_16x16x32_bf16 v[140:143], a[24:27], v[148:151], v[140:143]
ds_read_b128 a[16:19], v224 offset:53248
s_waitcnt lgkmcnt(4)
v_mfma_f32_16x16x32_bf16 v[140:143], a[28:31], v[156:159], v[140:143]
v_mul_f32 v240, v92, v92
v_fmaak_f32 v236, v228, v236, 0xc0135761
v_mfma_f32_16x16x32_bf16 v[136:139], a[28:31], v[152:155], v[136:139]
ds_read_b128 a[20:23], v224 offset:54272
s_add_u32 m0, s36, 114688
v_mfma_f32_16x16x32_bf16 v[136:139], a[24:27], v[144:147], v[136:139]
s_add_u32 s57, s92, 147456
v_mul_f32 v241, v93, v93
v_mfma_f32_16x16x32_bf16 v[96:99], a[0:3], a[192:195], v[96:99]
v_fmaak_f32 v237, v228, v237, 0xc0135761
s_waitcnt lgkmcnt(3)
v_mfma_f32_16x16x32_bf16 v[96:99], a[4:7], a[208:211], v[96:99]
buffer_load_dwordx4 v226, s[20:23], s57 offen offset:0 sc1 lds
v_mfma_f32_16x16x32_bf16 v[100:103], a[4:7], a[212:215], v[100:103]
ds_read_b128 a[24:27], v224 offset:55296
v_mul_f32 v242, v94, v94
v_mfma_f32_16x16x32_bf16 v[100:103], a[0:3], a[196:199], v[100:103]
v_fmaak_f32 v238, v228, v238, 0xc0135761
v_mul_f32 v243, v95, v95
v_mfma_f32_16x16x32_bf16 v[104:107], a[0:3], a[200:203], v[104:107]
ds_read_b128 a[28:31], v224 offset:56320
v_fmaak_f32 v239, v228, v239, 0xc0135761
v_mfma_f32_16x16x32_bf16 v[104:107], a[4:7], a[216:219], v[104:107]
buffer_load_dwordx4 v226, s[20:23], s57 offen offset:1024 sc1 lds
v_mfma_f32_16x16x32_bf16 v[108:111], a[4:7], a[220:223], v[108:111]
v_fmaak_f32 v240, v228, v240, 0xc0135761
v_mul_f32 v236, v236, v84
v_mfma_f32_16x16x32_bf16 v[108:111], a[0:3], a[204:207], v[108:111]
v_fmaak_f32 v241, v228, v241, 0xc0135761
v_mul_f32 v237, v237, v85
v_mfma_f32_16x16x32_bf16 v[220:223], a[8:11], a[204:207], v[220:223]
ds_read_b128 a[0:3], v224 offset:57344
s_waitcnt lgkmcnt(4)
v_mfma_f32_16x16x32_bf16 v[220:223], a[12:15], a[220:223], v[220:223]
buffer_load_dwordx4 v226, s[20:23], s57 offen offset:2048 sc1 lds
v_mfma_f32_16x16x32_bf16 v[216:219], a[12:15], a[216:219], v[216:219]
v_fmaak_f32 v242, v228, v242, 0xc0135761
v_mul_f32 v238, v238, v86
v_mfma_f32_16x16x32_bf16 v[216:219], a[8:11], a[200:203], v[216:219]
v_fmaak_f32 v243, v228, v243, 0xc0135761
v_mul_f32 v239, v239, v87
v_mfma_f32_16x16x32_bf16 v[212:215], a[8:11], a[196:199], v[212:215]
ds_read_b128 a[4:7], v224 offset:58368
v_mul_f32 v240, v240, v92
v_mfma_f32_16x16x32_bf16 v[212:215], a[12:15], a[212:215], v[212:215]
buffer_load_dwordx4 v226, s[20:23], s57 offen offset:3072 sc1 lds
v_mfma_f32_16x16x32_bf16 v[208:211], a[12:15], a[208:211], v[208:211]
v_exp_f32 v236, v236
v_mfma_f32_16x16x32_bf16 v[208:211], a[8:11], a[192:195], v[208:211]
v_mul_f32 v241, v241, v93
v_mul_f32 v196, v196, v84
v_mfma_f32_16x16x32_bf16 v[96:99], a[16:19], a[224:227], v[96:99]
ds_read_b128 a[8:11], v224 offset:59392
s_waitcnt lgkmcnt(4)
v_mfma_f32_16x16x32_bf16 v[96:99], a[20:23], a[240:243], v[96:99]
v_exp_f32 v237, v237
v_mfma_f32_16x16x32_bf16 v[100:103], a[20:23], a[244:247], v[100:103]
v_mul_f32 v242, v242, v94
v_mul_f32 v197, v197, v85
v_mfma_f32_16x16x32_bf16 v[100:103], a[16:19], a[228:231], v[100:103]
v_exp_f32 v238, v238
v_mfma_f32_16x16x32_bf16 v[104:107], a[16:19], a[232:235], v[104:107]
ds_read_b128 a[12:15], v224 offset:60416
v_mul_f32 v243, v243, v95
v_mfma_f32_16x16x32_bf16 v[104:107], a[20:23], a[248:251], v[104:107]
buffer_load_dwordx4 a[132:135], v224, s[20:23], s11 offen offset:2048 sc1
v_mfma_f32_16x16x32_bf16 v[108:111], a[20:23], a[252:255], v[108:111]
v_exp_f32 v240, v240
v_mfma_f32_16x16x32_bf16 v[108:111], a[16:19], a[236:239], v[108:111]
v_mul_f32 v198, v198, v86
v_mul_f32 v204, v204, v92
v_mfma_f32_16x16x32_bf16 v[220:223], a[24:27], a[236:239], v[220:223]
ds_read_b128 a[16:19], v224 offset:61440
s_waitcnt lgkmcnt(4)
v_mfma_f32_16x16x32_bf16 v[220:223], a[28:31], a[252:255], v[220:223]
buffer_load_dwordx4 a[136:139], v224, s[20:23], s10 offen offset:3072 sc1
v_mfma_f32_16x16x32_bf16 v[216:219], a[28:31], a[248:251], v[216:219]
v_exp_f32 v239, v239
v_mfma_f32_16x16x32_bf16 v[216:219], a[24:27], a[232:235], v[216:219]
v_exp_f32 v241, v241
v_mfma_f32_16x16x32_bf16 v[212:215], a[24:27], a[228:231], v[212:215]
ds_read_b128 a[20:23], v224 offset:62464
v_mul_f32 v199, v199, v87
v_mfma_f32_16x16x32_bf16 v[212:215], a[28:31], a[244:247], v[212:215]
buffer_load_dwordx4 a[140:143], v224, s[20:23], s11 offen offset:3072 sc1
v_mfma_f32_16x16x32_bf16 v[208:211], a[28:31], a[240:243], v[208:211]
v_mul_f32 v205, v205, v93
v_add_f32 v236, 1.0, v236
v_mfma_f32_16x16x32_bf16 v[208:211], a[24:27], a[224:227], v[208:211]
v_exp_f32 v242, v242
v_mfma_f32_16x16x32_bf16 v[96:99], a[0:3], a[32:35], v[96:99]
ds_read_b128 a[24:27], v224 offset:63488
s_waitcnt lgkmcnt(4)
v_mfma_f32_16x16x32_bf16 v[96:99], a[4:7], a[48:51], v[96:99]
s_add_u32 m0, s36, 0
v_add_f32 v237, 1.0, v237
v_mfma_f32_16x16x32_bf16 v[100:103], a[4:7], a[52:55], v[100:103]
s_add_u32 s57, s93, 163840
v_mul_f32 v206, v206, v94
v_mfma_f32_16x16x32_bf16 v[100:103], a[0:3], a[36:39], v[100:103]
v_add_f32 v238, 1.0, v238
s_barrier
v_mfma_f32_16x16x32_bf16 v[104:107], a[0:3], a[40:43], v[104:107]
buffer_load_dwordx4 v226, s[20:23], s57 offen offset:0 sc1 lds
v_mfma_f32_16x16x32_bf16 v[104:107], a[4:7], a[56:59], v[104:107]
ds_read_b128 a[28:31], v224 offset:64512
v_add_f32 v239, 1.0, v239
v_mfma_f32_16x16x32_bf16 v[108:111], a[4:7], a[60:63], v[108:111]
v_exp_f32 v243, v243
v_mfma_f32_16x16x32_bf16 v[108:111], a[0:3], a[44:47], v[108:111]
v_rcp_f32 v236, v236
v_mfma_f32_16x16x32_bf16 v[220:223], a[8:11], a[44:47], v[220:223]
ds_read_b128 a[0:3], v225 offset:0
s_waitcnt lgkmcnt(4)
v_mfma_f32_16x16x32_bf16 v[220:223], a[12:15], a[60:63], v[220:223]
buffer_load_dwordx4 v226, s[20:23], s57 offen offset:1024 sc1 lds
v_mfma_f32_16x16x32_bf16 v[216:219], a[12:15], a[56:59], v[216:219]
v_rcp_f32 v237, v237
v_mfma_f32_16x16x32_bf16 v[216:219], a[8:11], a[40:43], v[216:219]
v_rcp_f32 v238, v238
v_mfma_f32_16x16x32_bf16 v[212:215], a[8:11], a[36:39], v[212:215]
ds_read_b128 a[4:7], v225 offset:1024
v_mul_f32 v207, v207, v95
v_mfma_f32_16x16x32_bf16 v[212:215], a[12:15], a[52:55], v[212:215]
buffer_load_dwordx4 v226, s[20:23], s57 offen offset:2048 sc1 lds
v_mfma_f32_16x16x32_bf16 v[208:211], a[12:15], a[48:51], v[208:211]
v_rcp_f32 v239, v239
v_mfma_f32_16x16x32_bf16 v[208:211], a[8:11], a[32:35], v[208:211]
v_add_f32 v240, 1.0, v240
v_mul_f32 v196, v196, v236
v_mfma_f32_16x16x32_bf16 v[96:99], a[16:19], a[64:67], v[96:99]
ds_read_b128 a[8:11], v225 offset:2048
s_waitcnt lgkmcnt(4)
v_mfma_f32_16x16x32_bf16 v[96:99], a[20:23], a[80:83], v[96:99]
buffer_load_dwordx4 v226, s[20:23], s57 offen offset:3072 sc1 lds
v_mfma_f32_16x16x32_bf16 v[100:103], a[20:23], a[84:87], v[100:103]
v_add_f32 v241, 1.0, v241
v_mul_f32 v197, v197, v237
v_mfma_f32_16x16x32_bf16 v[100:103], a[16:19], a[68:71], v[100:103]
v_add_f32 v242, 1.0, v242
v_mul_f32 v198, v198, v238
v_mfma_f32_16x16x32_bf16 v[104:107], a[16:19], a[72:75], v[104:107]
ds_read_b128 a[12:15], v225 offset:3072
v_add_f32 v243, 1.0, v243
v_mfma_f32_16x16x32_bf16 v[104:107], a[20:23], a[88:91], v[104:107]
s_add_u32 s10, s84, 24576
v_mul_f32 v199, v199, v239
v_mfma_f32_16x16x32_bf16 v[108:111], a[20:23], a[92:95], v[108:111]
buffer_load_dwordx4 a[144:147], v224, s[20:23], s10 offen offset:0 sc1
v_mfma_f32_16x16x32_bf16 v[108:111], a[16:19], a[76:79], v[108:111]
v_rcp_f32 v240, v240
v_mfma_f32_16x16x32_bf16 v[220:223], a[24:27], a[76:79], v[220:223]
ds_read_b128 a[16:19], v225 offset:4096
s_waitcnt lgkmcnt(4)
v_mfma_f32_16x16x32_bf16 v[220:223], a[28:31], a[92:95], v[220:223]
v_rcp_f32 v241, v241
v_mfma_f32_16x16x32_bf16 v[216:219], a[28:31], a[88:91], v[216:219]
v_rcp_f32 v242, v242
v_mfma_f32_16x16x32_bf16 v[216:219], a[24:27], a[72:75], v[216:219]
v_rcp_f32 v243, v243
v_mfma_f32_16x16x32_bf16 v[212:215], a[24:27], a[68:71], v[212:215]
ds_read_b128 a[20:23], v225 offset:5120
v_cvt_pk_bf16_f32 v82, v196, v197
v_mfma_f32_16x16x32_bf16 v[212:215], a[28:31], a[84:87], v[212:215]
s_add_u32 s11, s84, 139264
v_mul_f32 v204, v204, v240
v_mfma_f32_16x16x32_bf16 v[208:211], a[28:31], a[80:83], v[208:211]
buffer_load_dwordx4 a[148:151], v224, s[20:23], s11 offen offset:0 sc1
v_mfma_f32_16x16x32_bf16 v[208:211], a[24:27], a[64:67], v[208:211]
v_cvt_pk_bf16_f32 v83, v198, v199
v_mul_f32 v205, v205, v241
v_mfma_f32_16x16x32_bf16 v[0:3], a[0:3], v[48:51], v[0:3]
ds_read_b128 a[24:27], v225 offset:6144
s_add_u32 s16, s41, 40960
v_mul_f32 v206, v206, v242
s_waitcnt vmcnt(36) lgkmcnt(4)
v_mfma_f32_16x16x32_bf16 v[0:3], a[4:7], v[56:59], v[0:3]
buffer_load_dwordx4 a[152:155], v224, s[20:23], s10 offen offset:1024 sc1
v_mul_f32 v207, v207, v243
v_mfma_f32_16x16x32_bf16 v[4:7], a[4:7], v[60:63], v[4:7]
ds_read_b128 a[28:31], v225 offset:7168
v_permlane32_swap_b32 v80, v82
v_cvt_pk_bf16_f32 v90, v204, v205
v_mfma_f32_16x16x32_bf16 v[4:7], a[0:3], v[52:55], v[4:7]
v_permlane32_swap_b32 v81, v83
v_cvt_pk_bf16_f32 v91, v206, v207
v_mfma_f32_16x16x32_bf16 v[12:15], a[8:11], v[52:55], v[12:15]
ds_read_b128 a[0:3], v225 offset:8192
buffer_store_dwordx4 v[80:83], v227, s[20:23], s16 offen sc1
s_waitcnt lgkmcnt(4)
v_mfma_f32_16x16x32_bf16 v[12:15], a[12:15], v[60:63], v[12:15]
buffer_load_dwordx4 a[156:159], v224, s[20:23], s11 offen offset:1024 sc1
s_add_u32 s59, s41, 270336
v_mfma_f32_16x16x32_bf16 v[8:11], a[12:15], v[56:59], v[8:11]
ds_read_b128 a[4:7], v225 offset:9216
v_permlane32_swap_b32 v88, v90
v_mul_f32 v236, v96, v96
v_mfma_f32_16x16x32_bf16 v[8:11], a[8:11], v[48:51], v[8:11]
v_permlane32_swap_b32 v89, v91
v_mul_f32 v237, v97, v97
v_mfma_f32_16x16x32_bf16 v[16:19], a[16:19], v[48:51], v[16:19]
ds_read_b128 a[8:11], v225 offset:10240
s_add_u32 m0, s36, 16384
v_mul_f32 v238, v98, v98
s_waitcnt lgkmcnt(4)
v_mfma_f32_16x16x32_bf16 v[16:19], a[20:23], v[56:59], v[16:19]
s_add_u32 s57, s93, 180224
buffer_store_dwordx4 v[88:91], v227, s[20:23], s59 offen sc1
v_mfma_f32_16x16x32_bf16 v[20:23], a[20:23], v[60:63], v[20:23]
buffer_load_dwordx4 v226, s[20:23], s57 offen offset:0 sc1 lds
v_mul_f32 v239, v99, v99
v_mul_f32 v240, v104, v104
v_mfma_f32_16x16x32_bf16 v[20:23], a[16:19], v[52:55], v[20:23]
ds_read_b128 a[12:15], v225 offset:11264
v_fmaak_f32 v236, v228, v236, 0xc0135761
v_mul_f32 v241, v105, v105
v_mfma_f32_16x16x32_bf16 v[28:31], a[24:27], v[52:55], v[28:31]
ds_read_b128 a[16:19], v225 offset:12288
v_fmaak_f32 v237, v228, v237, 0xc0135761
v_mul_f32 v242, v106, v106
s_waitcnt lgkmcnt(4)
v_mfma_f32_16x16x32_bf16 v[28:31], a[28:31], v[60:63], v[28:31]
buffer_load_dwordx4 v226, s[20:23], s57 offen offset:1024 sc1 lds
v_fmaak_f32 v238, v228, v238, 0xc0135761
v_mfma_f32_16x16x32_bf16 v[24:27], a[28:31], v[56:59], v[24:27]
ds_read_b128 a[20:23], v225 offset:13312
v_mul_f32 v243, v107, v107
v_fmaak_f32 v239, v228, v239, 0xc0135761
v_fmaak_f32 v240, v228, v240, 0xc0135761
v_mfma_f32_16x16x32_bf16 v[24:27], a[24:27], v[48:51], v[24:27]
v_mul_f32 v236, v236, v96
v_fmaak_f32 v241, v228, v241, 0xc0135761
v_mul_f32 v237, v237, v97
v_mfma_f32_16x16x32_bf16 v[112:115], a[0:3], v[48:51], v[112:115]
ds_read_b128 a[24:27], v225 offset:14336
v_fmaak_f32 v242, v228, v242, 0xc0135761
s_waitcnt lgkmcnt(4)
v_mfma_f32_16x16x32_bf16 v[112:115], a[4:7], v[56:59], v[112:115]
v_mul_f32 v238, v238, v98
v_fmaak_f32 v243, v228, v243, 0xc0135761
s_barrier
v_mfma_f32_16x16x32_bf16 v[116:119], a[4:7], v[60:63], v[116:119]
ds_read_b128 a[28:31], v225 offset:15360
v_mul_f32 v239, v239, v99
v_mul_f32 v240, v240, v104
v_mfma_f32_16x16x32_bf16 v[116:119], a[0:3], v[52:55], v[116:119]
buffer_load_dwordx4 v226, s[20:23], s57 offen offset:2048 sc1 lds
v_mul_f32 v241, v241, v105
v_mfma_f32_16x16x32_bf16 v[124:127], a[8:11], v[52:55], v[124:127]
ds_read_b128 a[0:3], v225 offset:16384
v_mul_f32 v242, v242, v106
s_waitcnt lgkmcnt(4)
v_mfma_f32_16x16x32_bf16 v[124:127], a[12:15], v[60:63], v[124:127]
v_exp_f32 v236, v236
v_mul_f32 v243, v243, v107
v_mfma_f32_16x16x32_bf16 v[120:123], a[12:15], v[56:59], v[120:123]
ds_read_b128 a[4:7], v225 offset:17408
v_exp_f32 v240, v240
v_mfma_f32_16x16x32_bf16 v[120:123], a[8:11], v[48:51], v[120:123]
buffer_load_dwordx4 v226, s[20:23], s57 offen offset:3072 sc1 lds
v_mul_f32 v208, v208, v96
v_mfma_f32_16x16x32_bf16 v[128:131], a[16:19], v[48:51], v[128:131]
ds_read_b128 a[8:11], v225 offset:18432
v_mul_f32 v216, v216, v104
s_waitcnt lgkmcnt(4)
v_mfma_f32_16x16x32_bf16 v[128:131], a[20:23], v[56:59], v[128:131]
v_exp_f32 v237, v237
v_mul_f32 v209, v209, v97
v_mfma_f32_16x16x32_bf16 v[132:135], a[20:23], v[60:63], v[132:135]
ds_read_b128 a[12:15], v225 offset:19456
v_exp_f32 v241, v241
v_mfma_f32_16x16x32_bf16 v[132:135], a[16:19], v[52:55], v[132:135]
buffer_load_dwordx4 a[160:163], v224, s[20:23], s10 offen offset:2048 sc1
v_mul_f32 v217, v217, v105
v_mfma_f32_16x16x32_bf16 v[140:143], a[24:27], v[52:55], v[140:143]
ds_read_b128 a[16:19], v225 offset:20480
s_waitcnt lgkmcnt(4)
v_mfma_f32_16x16x32_bf16 v[140:143], a[28:31], v[60:63], v[140:143]
v_exp_f32 v238, v238
v_mul_f32 v210, v210, v98
v_mfma_f32_16x16x32_bf16 v[136:139], a[28:31], v[56:59], v[136:139]
ds_read_b128 a[20:23], v225 offset:21504
v_exp_f32 v242, v242
v_mfma_f32_16x16x32_bf16 v[136:139], a[24:27], v[48:51], v[136:139]
buffer_load_dwordx4 a[164:167], v224, s[20:23], s11 offen offset:2048 sc1
s_waitcnt vmcnt(44)
v_mfma_f32_16x16x32_bf16 v[0:3], a[0:3], a[96:99], v[0:3]
ds_read_b128 a[24:27], v225 offset:22528
v_mul_f32 v218, v218, v106
s_waitcnt vmcnt(42) lgkmcnt(4)
v_mfma_f32_16x16x32_bf16 v[0:3], a[4:7], a[104:107], v[0:3]
v_exp_f32 v239, v239
v_mul_f32 v211, v211, v99
v_mfma_f32_16x16x32_bf16 v[4:7], a[4:7], a[108:111], v[4:7]
ds_read_b128 a[28:31], v225 offset:23552
v_exp_f32 v243, v243
v_mfma_f32_16x16x32_bf16 v[4:7], a[0:3], a[100:103], v[4:7]
v_add_f32 v236, 1.0, v236
v_mul_f32 v219, v219, v107
v_add_f32 v237, 1.0, v237
v_mfma_f32_16x16x32_bf16 v[12:15], a[8:11], a[100:103], v[12:15]
ds_read_b128 a[0:3], v225 offset:24576
v_add_f32 v240, 1.0, v240
s_waitcnt lgkmcnt(4)
v_mfma_f32_16x16x32_bf16 v[12:15], a[12:15], a[108:111], v[12:15]
buffer_load_dwordx4 a[168:171], v224, s[20:23], s10 offen offset:3072 sc1
v_add_f32 v238, 1.0, v238
v_mfma_f32_16x16x32_bf16 v[8:11], a[12:15], a[104:107], v[8:11]
ds_read_b128 a[4:7], v225 offset:25600
v_add_f32 v241, 1.0, v241
v_add_f32 v239, 1.0, v239
v_mfma_f32_16x16x32_bf16 v[8:11], a[8:11], a[96:99], v[8:11]
v_rcp_f32 v236, v236
v_add_f32 v242, 1.0, v242
v_mfma_f32_16x16x32_bf16 v[16:19], a[16:19], a[96:99], v[16:19]
ds_read_b128 a[8:11], v225 offset:26624
v_add_f32 v243, 1.0, v243
s_waitcnt lgkmcnt(4)
v_mfma_f32_16x16x32_bf16 v[16:19], a[20:23], a[104:107], v[16:19]
buffer_load_dwordx4 a[172:175], v224, s[20:23], s11 offen offset:3072 sc1
v_mfma_f32_16x16x32_bf16 v[20:23], a[20:23], a[108:111], v[20:23]
ds_read_b128 a[12:15], v225 offset:27648
v_rcp_f32 v237, v237
v_mfma_f32_16x16x32_bf16 v[20:23], a[16:19], a[100:103], v[20:23]
v_rcp_f32 v240, v240
v_mfma_f32_16x16x32_bf16 v[28:31], a[24:27], a[100:103], v[28:31]
ds_read_b128 a[16:19], v225 offset:28672
s_add_u32 m0, s36, 32768
s_waitcnt lgkmcnt(4)
v_mfma_f32_16x16x32_bf16 v[28:31], a[28:31], a[108:111], v[28:31]
s_add_u32 s57, s92, 196608
v_rcp_f32 v238, v238
v_mfma_f32_16x16x32_bf16 v[24:27], a[28:31], a[104:107], v[24:27]
buffer_load_dwordx4 v226, s[20:23], s57 offen offset:0 sc1 lds
v_mfma_f32_16x16x32_bf16 v[24:27], a[24:27], a[96:99], v[24:27]
ds_read_b128 a[20:23], v225 offset:29696
v_rcp_f32 v241, v241
v_mfma_f32_16x16x32_bf16 v[112:115], a[0:3], a[96:99], v[112:115]
ds_read_b128 a[24:27], v225 offset:30720
s_waitcnt lgkmcnt(4)
v_mfma_f32_16x16x32_bf16 v[112:115], a[4:7], a[104:107], v[112:115]
buffer_load_dwordx4 v226, s[20:23], s57 offen offset:1024 sc1 lds
s_waitcnt vmcnt(41)
s_barrier
v_mfma_f32_16x16x32_bf16 v[116:119], a[4:7], a[108:111], v[116:119]
ds_read_b128 a[28:31], v225 offset:31744
v_rcp_f32 v239, v239
v_mfma_f32_16x16x32_bf16 v[116:119], a[0:3], a[100:103], v[116:119]
v_rcp_f32 v242, v242
v_mul_f32 v208, v208, v236
v_mfma_f32_16x16x32_bf16 v[124:127], a[8:11], a[100:103], v[124:127]
ds_read_b128 a[0:3], v225 offset:32768
v_mul_f32 v209, v209, v237
s_waitcnt lgkmcnt(4)
v_mfma_f32_16x16x32_bf16 v[124:127], a[12:15], a[108:111], v[124:127]
buffer_load_dwordx4 v226, s[20:23], s57 offen offset:2048 sc1 lds
v_mul_f32 v210, v210, v238
v_mfma_f32_16x16x32_bf16 v[120:123], a[12:15], a[104:107], v[120:123]
ds_read_b128 a[4:7], v225 offset:33792
v_rcp_f32 v243, v243
v_mfma_f32_16x16x32_bf16 v[120:123], a[8:11], a[96:99], v[120:123]
v_mul_f32 v211, v211, v239
v_mul_f32 v216, v216, v240
v_cvt_pk_bf16_f32 v96, v208, v209
v_mfma_f32_16x16x32_bf16 v[128:131], a[16:19], a[96:99], v[128:131]
ds_read_b128 a[8:11], v225 offset:34816
v_mul_f32 v217, v217, v241
s_waitcnt lgkmcnt(4)
v_mfma_f32_16x16x32_bf16 v[128:131], a[20:23], a[104:107], v[128:131]
v_cvt_pk_bf16_f32 v97, v210, v211
v_mul_f32 v218, v218, v242
v_mul_f32 v236, v100, v100
s_waitcnt vmcnt(11)
s_mov_b64 exec, 1
buffer_store_dword v253, off, s[20:23], s45 sc1
s_mov_b64 exec, -1
s_add_u32 s45, s45, 0x4000
v_mfma_f32_16x16x32_bf16 v[132:135], a[20:23], a[108:111], v[132:135]
ds_read_b128 a[12:15], v225 offset:35840
v_mul_f32 v219, v219, v243
v_mul_f32 v237, v101, v101
v_mfma_f32_16x16x32_bf16 v[132:135], a[16:19], a[100:103], v[132:135]
buffer_load_dwordx4 v226, s[20:23], s57 offen offset:3072 sc1 lds
v_cvt_pk_bf16_f32 v104, v216, v217
buffer_load_dword v234, v235, s[20:23], s46 offen sc1
v_mfma_f32_16x16x32_bf16 v[140:143], a[24:27], a[100:103], v[140:143]
ds_read_b128 a[16:19], v225 offset:36864
v_mul_f32 v238, v102, v102
s_waitcnt lgkmcnt(4)
v_mfma_f32_16x16x32_bf16 v[140:143], a[28:31], a[108:111], v[140:143]
v_cvt_pk_bf16_f32 v105, v218, v219
v_mul_f32 v239, v103, v103
v_mul_f32 v240, v108, v108
v_mfma_f32_16x16x32_bf16 v[136:139], a[28:31], a[104:107], v[136:139]
ds_read_b128 a[20:23], v225 offset:37888
v_fmaak_f32 v236, v228, v236, 0xc0135761
v_mul_f32 v241, v109, v109
v_mfma_f32_16x16x32_bf16 v[136:139], a[24:27], a[96:99], v[136:139]
s_add_u32 s10, s85, 28672
v_fmaak_f32 v237, v228, v237, 0xc0135761
v_mul_f32 v242, v110, v110
v_mfma_f32_16x16x32_bf16 v[0:3], a[0:3], a[112:115], v[0:3]
buffer_load_dwordx4 a[176:179], v224, s[20:23], s10 offen offset:0 sc1
s_waitcnt lgkmcnt(3)
v_mfma_f32_16x16x32_bf16 v[0:3], a[4:7], a[120:123], v[0:3]
ds_read_b128 a[24:27], v225 offset:38912
v_fmaak_f32 v238, v228, v238, 0xc0135761
v_mul_f32 v243, v111, v111
v_mfma_f32_16x16x32_bf16 v[4:7], a[4:7], a[124:127], v[4:7]
ds_read_b128 a[28:31], v225 offset:39936
v_fmaak_f32 v239, v228, v239, 0xc0135761
v_fmaak_f32 v240, v228, v240, 0xc0135761
v_mfma_f32_16x16x32_bf16 v[4:7], a[0:3], a[116:119], v[4:7]
s_add_u32 s11, s85, 143360
v_mul_f32 v236, v236, v100
v_fmaak_f32 v241, v228, v241, 0xc0135761
v_mfma_f32_16x16x32_bf16 v[12:15], a[8:11], a[116:119], v[12:15]
buffer_load_dwordx4 a[180:183], v224, s[20:23], s11 offen offset:0 sc1
s_waitcnt lgkmcnt(3)
v_mfma_f32_16x16x32_bf16 v[12:15], a[12:15], a[124:127], v[12:15]
ds_read_b128 a[0:3], v225 offset:40960
v_mul_f32 v237, v237, v101
v_fmaak_f32 v242, v228, v242, 0xc0135761
v_mfma_f32_16x16x32_bf16 v[8:11], a[12:15], a[120:123], v[8:11]
ds_read_b128 a[4:7], v225 offset:41984
v_mul_f32 v238, v238, v102
v_fmaak_f32 v243, v228, v243, 0xc0135761
v_mfma_f32_16x16x32_bf16 v[8:11], a[8:11], a[112:115], v[8:11]
buffer_load_dwordx4 a[184:187], v224, s[20:23], s10 offen offset:1024 sc1
v_mul_f32 v239, v239, v103
v_mfma_f32_16x16x32_bf16 v[16:19], a[16:19], a[112:115], v[16:19]
ds_read_b128 a[8:11], v225 offset:43008
v_mul_f32 v240, v240, v108
s_waitcnt lgkmcnt(4)
v_mfma_f32_16x16x32_bf16 v[16:19], a[20:23], a[120:123], v[16:19]
v_exp_f32 v236, v236
v_mul_f32 v241, v241, v109
v_mfma_f32_16x16x32_bf16 v[20:23], a[20:23], a[124:127], v[20:23]
ds_read_b128 a[12:15], v225 offset:44032
v_mul_f32 v212, v212, v100
v_mul_f32 v242, v242, v110
v_mfma_f32_16x16x32_bf16 v[20:23], a[16:19], a[116:119], v[20:23]
v_exp_f32 v237, v237
v_mul_f32 v243, v243, v111
v_mfma_f32_16x16x32_bf16 v[28:31], a[24:27], a[116:119], v[28:31]
ds_read_b128 a[16:19], v225 offset:45056
v_mul_f32 v213, v213, v101
s_waitcnt lgkmcnt(4)
v_mfma_f32_16x16x32_bf16 v[28:31], a[28:31], a[124:127], v[28:31]
buffer_load_dwordx4 a[188:191], v224, s[20:23], s11 offen offset:1024 sc1
v_mfma_f32_16x16x32_bf16 v[24:27], a[28:31], a[120:123], v[24:27]
ds_read_b128 a[20:23], v225 offset:46080
v_exp_f32 v240, v240
v_mfma_f32_16x16x32_bf16 v[24:27], a[24:27], a[112:115], v[24:27]
v_exp_f32 v238, v238
v_mul_f32 v220, v220, v108
v_mfma_f32_16x16x32_bf16 v[112:115], a[0:3], a[112:115], v[112:115]
ds_read_b128 a[24:27], v225 offset:47104
s_add_u32 m0, s36, 49152
s_waitcnt lgkmcnt(4)
v_mfma_f32_16x16x32_bf16 v[112:115], a[4:7], a[120:123], v[112:115]
s_add_u32 s57, s92, 212992
v_mul_f32 v214, v214, v102
s_barrier
v_mfma_f32_16x16x32_bf16 v[116:119], a[4:7], a[124:127], v[116:119]
buffer_load_dwordx4 v226, s[20:23], s57 offen offset:0 sc1 lds
v_mfma_f32_16x16x32_bf16 v[116:119], a[0:3], a[116:119], v[116:119]
ds_read_b128 a[28:31], v225 offset:48128
v_exp_f32 v241, v241
v_mfma_f32_16x16x32_bf16 v[124:127], a[8:11], a[116:119], v[124:127]
ds_read_b128 a[0:3], v225 offset:49152
v_mul_f32 v221, v221, v109
s_waitcnt lgkmcnt(4)
v_mfma_f32_16x16x32_bf16 v[124:127], a[12:15], a[124:127], v[124:127]
buffer_load_dwordx4 v226, s[20:23], s57 offen offset:1024 sc1 lds
v_mfma_f32_16x16x32_bf16 v[120:123], a[12:15], a[120:123], v[120:123]
ds_read_b128 a[4:7], v225 offset:50176
v_exp_f32 v239, v239
v_mfma_f32_16x16x32_bf16 v[120:123], a[8:11], a[112:115], v[120:123]
v_exp_f32 v242, v242
v_mul_f32 v215, v215, v103
v_mfma_f32_16x16x32_bf16 v[128:131], a[16:19], a[112:115], v[128:131]
ds_read_b128 a[8:11], v225 offset:51200
v_mul_f32 v222, v222, v110
s_waitcnt lgkmcnt(4)
v_mfma_f32_16x16x32_bf16 v[128:131], a[20:23], a[120:123], v[128:131]
buffer_load_dwordx4 v226, s[20:23], s57 offen offset:2048 sc1 lds
v_add_f32 v236, 1.0, v236
v_mfma_f32_16x16x32_bf16 v[132:135], a[20:23], a[124:127], v[132:135]
ds_read_b128 a[12:15], v225 offset:52224
v_exp_f32 v243, v243
v_mfma_f32_16x16x32_bf16 v[132:135], a[16:19], a[116:119], v[132:135]
v_add_f32 v237, 1.0, v237
v_mul_f32 v223, v223, v111
v_add_f32 v238, 1.0, v238
v_mfma_f32_16x16x32_bf16 v[140:143], a[24:27], a[116:119], v[140:143]
ds_read_b128 a[16:19], v225 offset:53248
v_add_f32 v240, 1.0, v240
s_waitcnt lgkmcnt(4)
v_mfma_f32_16x16x32_bf16 v[140:143], a[28:31], a[124:127], v[140:143]
buffer_load_dwordx4 v226, s[20:23], s57 offen offset:3072 sc1 lds
v_add_f32 v239, 1.0, v239
v_mfma_f32_16x16x32_bf16 v[136:139], a[28:31], a[120:123], v[136:139]
ds_read_b128 a[20:23], v225 offset:54272
v_rcp_f32 v236, v236
v_mfma_f32_16x16x32_bf16 v[136:139], a[24:27], a[112:115], v[136:139]
v_rcp_f32 v237, v237
v_add_f32 v241, 1.0, v241
v_mfma_f32_16x16x32_bf16 v[0:3], a[0:3], v[64:67], v[0:3]
ds_read_b128 a[24:27], v225 offset:55296
v_add_f32 v242, 1.0, v242
s_waitcnt lgkmcnt(4)
v_mfma_f32_16x16x32_bf16 v[0:3], a[4:7], v[72:75], v[0:3]
v_rcp_f32 v238, v238
v_add_f32 v243, 1.0, v243
v_mfma_f32_16x16x32_bf16 v[4:7], a[4:7], v[76:79], v[4:7]
ds_read_b128 a[28:31], v225 offset:56320
v_rcp_f32 v239, v239
v_mfma_f32_16x16x32_bf16 v[4:7], a[0:3], v[68:71], v[4:7]
buffer_load_dwordx4 v[160:163], v224, s[20:23], s10 offen offset:2048 sc1
v_mul_f32 v212, v212, v236
s_waitcnt vmcnt(9)
v_cmp_ne_u32 vcc, v253, v234
s_nop 0
s_and_b32 s14, vcc_lo, 0xffff
s_cbranch_scc1 L_poll9
L_poll9_ok:
s_add_u32 s46, s46, 0x4000
v_mfma_f32_16x16x32_bf16 v[12:15], a[8:11], v[68:71], v[12:15]
ds_read_b128 a[0:3], v225 offset:57344
v_mul_f32 v213, v213, v237
s_waitcnt lgkmcnt(4)
v_mfma_f32_16x16x32_bf16 v[12:15], a[12:15], v[76:79], v[12:15]
v_rcp_f32 v240, v240
v_mul_f32 v214, v214, v238
v_mfma_f32_16x16x32_bf16 v[8:11], a[12:15], v[72:75], v[8:11]
ds_read_b128 a[4:7], v225 offset:58368
v_rcp_f32 v241, v241
v_mfma_f32_16x16x32_bf16 v[8:11], a[8:11], v[64:67], v[8:11]
buffer_load_dwordx4 v[164:167], v224, s[20:23], s11 offen offset:2048 sc1
v_mul_f32 v215, v215, v239
v_mfma_f32_16x16x32_bf16 v[16:19], a[16:19], v[64:67], v[16:19]
ds_read_b128 a[8:11], v225 offset:59392
v_cvt_pk_bf16_f32 v98, v212, v213
s_waitcnt lgkmcnt(4)
v_mfma_f32_16x16x32_bf16 v[16:19], a[20:23], v[72:75], v[16:19]
v_rcp_f32 v242, v242
v_cvt_pk_bf16_f32 v99, v214, v215
v_mfma_f32_16x16x32_bf16 v[20:23], a[20:23], v[76:79], v[20:23]
ds_read_b128 a[12:15], v225 offset:60416
v_rcp_f32 v243, v243
v_mfma_f32_16x16x32_bf16 v[20:23], a[16:19], v[68:71], v[20:23]
buffer_load_dwordx4 v[168:171], v224, s[20:23], s10 offen offset:3072 sc1
s_add_u32 s16, s41, 49152
v_mfma_f32_16x16x32_bf16 v[28:31], a[24:27], v[68:71], v[28:31]
ds_read_b128 a[16:19], v225 offset:61440
v_mul_f32 v220, v220, v240
s_waitcnt lgkmcnt(4)
v_mfma_f32_16x16x32_bf16 v[28:31], a[28:31], v[76:79], v[28:31]
v_permlane32_swap_b32 v96, v98
v_mul_f32 v221, v221, v241
v_mfma_f32_16x16x32_bf16 v[24:27], a[28:31], v[72:75], v[24:27]
ds_read_b128 a[20:23], v225 offset:62464
v_permlane32_swap_b32 v97, v99
v_mfma_f32_16x16x32_bf16 v[24:27], a[24:27], v[64:67], v[24:27]
buffer_load_dwordx4 v[172:175], v224, s[20:23], s11 offen offset:3072 sc1
v_mul_f32 v222, v222, v242
v_mfma_f32_16x16x32_bf16 v[112:115], a[0:3], v[64:67], v[112:115]
ds_read_b128 a[24:27], v225 offset:63488
v_mul_f32 v223, v223, v243
s_waitcnt lgkmcnt(4)
v_mfma_f32_16x16x32_bf16 v[112:115], a[4:7], v[72:75], v[112:115]
buffer_store_dwordx4 v[96:99], v227, s[20:23], s16 offen sc1
s_barrier
v_mfma_f32_16x16x32_bf16 v[116:119], a[4:7], v[76:79], v[116:119]
ds_read_b128 a[28:31], v225 offset:64512
v_cvt_pk_bf16_f32 v106, v220, v221
v_cvt_pk_bf16_f32 v107, v222, v223
v_mfma_f32_16x16x32_bf16 v[116:119], a[0:3], v[68:71], v[116:119]
s_add_u32 s59, s41, 278528
v_permlane32_swap_b32 v104, v106
v_mfma_f32_16x16x32_bf16 v[124:127], a[8:11], v[68:71], v[124:127]
ds_read_b128 a[0:3], v224 offset:0
s_add_u32 m0, s36, 65536
s_waitcnt lgkmcnt(4)
v_mfma_f32_16x16x32_bf16 v[124:127], a[12:15], v[76:79], v[124:127]
s_add_u32 s57, s93, 229376
v_permlane32_swap_b32 v105, v107
v_mfma_f32_16x16x32_bf16 v[120:123], a[12:15], v[72:75], v[120:123]
buffer_load_dwordx4 v226, s[20:23], s57 offen offset:0 sc1 lds
v_mfma_f32_16x16x32_bf16 v[120:123], a[8:11], v[64:67], v[120:123]
ds_read_b128 a[4:7], v224 offset:1024
buffer_store_dwordx4 v[104:107], v227, s[20:23], s59 offen sc1
v_mfma_f32_16x16x32_bf16 v[128:131], a[16:19], v[64:67], v[128:131]
ds_read_b128 a[8:11], v224 offset:2048
s_waitcnt lgkmcnt(4)
v_mfma_f32_16x16x32_bf16 v[128:131], a[20:23], v[72:75], v[128:131]
buffer_load_dwordx4 v226, s[20:23], s57 offen offset:1024 sc1 lds
v_mfma_f32_16x16x32_bf16 v[132:135], a[20:23], v[76:79], v[132:135]
ds_read_b128 a[12:15], v224 offset:3072
v_mfma_f32_16x16x32_bf16 v[132:135], a[16:19], v[68:71], v[132:135]
v_mfma_f32_16x16x32_bf16 v[140:143], a[24:27], v[68:71], v[140:143]
ds_read_b128 a[16:19], v224 offset:4096
s_waitcnt lgkmcnt(4)
v_mfma_f32_16x16x32_bf16 v[140:143], a[28:31], v[76:79], v[140:143]
buffer_load_dwordx4 v226, s[20:23], s57 offen offset:2048 sc1 lds
v_mfma_f32_16x16x32_bf16 v[136:139], a[28:31], v[72:75], v[136:139]
ds_read_b128 a[20:23], v224 offset:5120
v_mfma_f32_16x16x32_bf16 v[136:139], a[24:27], v[64:67], v[136:139]
v_mfma_f32_16x16x32_bf16 v[0:3], a[0:3], v[176:179], v[0:3]
ds_read_b128 a[24:27], v224 offset:6144
s_waitcnt lgkmcnt(4)
v_mfma_f32_16x16x32_bf16 v[0:3], a[4:7], v[184:187], v[0:3]
buffer_load_dwordx4 v226, s[20:23], s57 offen offset:3072 sc1 lds
v_mfma_f32_16x16x32_bf16 v[4:7], a[4:7], v[188:191], v[4:7]
ds_read_b128 a[28:31], v224 offset:7168
v_mfma_f32_16x16x32_bf16 v[4:7], a[0:3], v[180:183], v[4:7]
v_mfma_f32_16x16x32_bf16 v[12:15], a[8:11], v[180:183], v[12:15]
ds_read_b128 a[0:3], v224 offset:8192
s_add_u32 m0, s36, 81920
s_waitcnt lgkmcnt(4)
v_mfma_f32_16x16x32_bf16 v[12:15], a[12:15], v[188:191], v[12:15]
s_add_u32 s57, s93, 245760
v_mfma_f32_16x16x32_bf16 v[8:11], a[12:15], v[184:187], v[8:11]
buffer_load_dwordx4 v226, s[20:23], s57 offen offset:0 sc1 lds
v_mfma_f32_16x16x32_bf16 v[8:11], a[8:11], v[176:179], v[8:11]
ds_read_b128 a[4:7], v224 offset:9216
v_mfma_f32_16x16x32_bf16 v[16:19], a[16:19], v[176:179], v[16:19]
ds_read_b128 a[8:11], v224 offset:10240
s_waitcnt lgkmcnt(4)
v_mfma_f32_16x16x32_bf16 v[16:19], a[20:23], v[184:187], v[16:19]
v_mfma_f32_16x16x32_bf16 v[20:23], a[20:23], v[188:191], v[20:23]
ds_read_b128 a[12:15], v224 offset:11264
v_mfma_f32_16x16x32_bf16 v[20:23], a[16:19], v[180:183], v[20:23]
buffer_load_dwordx4 v226, s[20:23], s57 offen offset:1024 sc1 lds
v_mfma_f32_16x16x32_bf16 v[28:31], a[24:27], v[180:183], v[28:31]
ds_read_b128 a[16:19], v224 offset:12288
s_waitcnt lgkmcnt(4)
v_mfma_f32_16x16x32_bf16 v[28:31], a[28:31], v[188:191], v[28:31]
v_mfma_f32_16x16x32_bf16 v[24:27], a[28:31], v[184:187], v[24:27]
ds_read_b128 a[20:23], v224 offset:13312
v_mfma_f32_16x16x32_bf16 v[24:27], a[24:27], v[176:179], v[24:27]
buffer_load_dwordx4 v226, s[20:23], s57 offen offset:2048 sc1 lds
v_mfma_f32_16x16x32_bf16 v[112:115], a[0:3], v[176:179], v[112:115]
ds_read_b128 a[24:27], v224 offset:14336
s_waitcnt lgkmcnt(4)
v_mfma_f32_16x16x32_bf16 v[112:115], a[4:7], v[184:187], v[112:115]
s_barrier
v_mfma_f32_16x16x32_bf16 v[116:119], a[4:7], v[188:191], v[116:119]
ds_read_b128 a[28:31], v224 offset:15360
v_mfma_f32_16x16x32_bf16 v[116:119], a[0:3], v[180:183], v[116:119]
buffer_load_dwordx4 v226, s[20:23], s57 offen offset:3072 sc1 lds
v_mfma_f32_16x16x32_bf16 v[124:127], a[8:11], v[180:183], v[124:127]
ds_read_b128 a[0:3], v224 offset:16384
s_waitcnt lgkmcnt(4)
v_mfma_f32_16x16x32_bf16 v[124:127], a[12:15], v[188:191], v[124:127]
v_mfma_f32_16x16x32_bf16 v[120:123], a[12:15], v[184:187], v[120:123]
ds_read_b128 a[4:7], v224 offset:17408
v_mfma_f32_16x16x32_bf16 v[120:123], a[8:11], v[176:179], v[120:123]
s_add_u32 s10, s84, 32768
v_mfma_f32_16x16x32_bf16 v[128:131], a[16:19], v[176:179], v[128:131]
buffer_load_dwordx4 v[32:35], v224, s[20:23], s10 offen offset:0 sc1
s_waitcnt lgkmcnt(3)
v_mfma_f32_16x16x32_bf16 v[128:131], a[20:23], v[184:187], v[128:131]
ds_read_b128 a[8:11], v224 offset:18432
v_mfma_f32_16x16x32_bf16 v[132:135], a[20:23], v[188:191], v[132:135]
ds_read_b128 a[12:15], v224 offset:19456
v_mfma_f32_16x16x32_bf16 v[132:135], a[16:19], v[180:183], v[132:135]
v_mfma_f32_16x16x32_bf16 v[140:143], a[24:27], v[180:183], v[140:143]
ds_read_b128 a[16:19], v224 offset:20480
s_waitcnt lgkmcnt(4)
v_mfma_f32_16x16x32_bf16 v[140:143], a[28:31], v[188:191], v[140:143]
s_add_u32 s11, s84, 147456
v_mfma_f32_16x16x32_bf16 v[136:139], a[28:31], v[184:187], v[136:139]
buffer_load_dwordx4 v[36:39], v224, s[20:23], s11 offen offset:0 sc1
v_mfma_f32_16x16x32_bf16 v[136:139], a[24:27], v[176:179], v[136:139]
ds_read_b128 a[20:23], v224 offset:21504
v_mfma_f32_16x16x32_bf16 v[0:3], a[0:3], a[128:131], v[0:3]
ds_read_b128 a[24:27], v224 offset:22528
s_waitcnt lgkmcnt(4)
v_mfma_f32_16x16x32_bf16 v[0:3], a[4:7], a[136:139], v[0:3]
buffer_load_dwordx4 v[40:43], v224, s[20:23], s10 offen offset:1024 sc1
v_mfma_f32_16x16x32_bf16 v[4:7], a[4:7], a[140:143], v[4:7]
ds_read_b128 a[28:31], v224 offset:23552
v_mfma_f32_16x16x32_bf16 v[4:7], a[0:3], a[132:135], v[4:7]
v_mfma_f32_16x16x32_bf16 v[12:15], a[8:11], a[132:135], v[12:15]
ds_read_b128 a[0:3], v224 offset:24576
s_waitcnt lgkmcnt(4)
v_mfma_f32_16x16x32_bf16 v[12:15], a[12:15], a[140:143], v[12:15]
buffer_load_dwordx4 v[44:47], v224, s[20:23], s11 offen offset:1024 sc1
v_mfma_f32_16x16x32_bf16 v[8:11], a[12:15], a[136:139], v[8:11]
ds_read_b128 a[4:7], v224 offset:25600
v_mfma_f32_16x16x32_bf16 v[8:11], a[8:11], a[128:131], v[8:11]
s_waitcnt vmcnt(11)
s_mov_b64 exec, 1
buffer_store_dword v253, off, s[20:23], s45 sc1
s_mov_b64 exec, -1
s_add_u32 s45, s45, 0x4000
v_mfma_f32_16x16x32_bf16 v[16:19], a[16:19], a[128:131], v[16:19]
ds_read_b128 a[8:11], v224 offset:26624
s_waitcnt lgkmcnt(4)
v_mfma_f32_16x16x32_bf16 v[16:19], a[20:23], a[136:139], v[16:19]
buffer_load_dwordx4 v[144:147], v224, s[20:23], s10 offen offset:2048 sc1
v_mfma_f32_16x16x32_bf16 v[20:23], a[20:23], a[140:143], v[20:23]
ds_read_b128 a[12:15], v224 offset:27648
v_mfma_f32_16x16x32_bf16 v[20:23], a[16:19], a[132:135], v[20:23]
v_mfma_f32_16x16x32_bf16 v[28:31], a[24:27], a[132:135], v[28:31]
ds_read_b128 a[16:19], v224 offset:28672
s_add_u32 m0, s36, 98304
s_waitcnt lgkmcnt(4)
v_mfma_f32_16x16x32_bf16 v[28:31], a[28:31], a[140:143], v[28:31]
s_add_u32 s57, s92, 262144
v_mfma_f32_16x16x32_bf16 v[24:27], a[28:31], a[136:139], v[24:27]
buffer_load_dwordx4 v226, s[20:23], s57 offen offset:0 sc1 lds
v_mfma_f32_16x16x32_bf16 v[24:27], a[24:27], a[128:131], v[24:27]
ds_read_b128 a[20:23], v224 offset:29696
v_mfma_f32_16x16x32_bf16 v[112:115], a[0:3], a[128:131], v[112:115]
ds_read_b128 a[24:27], v224 offset:30720
s_waitcnt lgkmcnt(4)
v_mfma_f32_16x16x32_bf16 v[112:115], a[4:7], a[136:139], v[112:115]
s_barrier
v_mfma_f32_16x16x32_bf16 v[116:119], a[4:7], a[140:143], v[116:119]
ds_read_b128 a[28:31], v224 offset:31744
v_mfma_f32_16x16x32_bf16 v[116:119], a[0:3], a[132:135], v[116:119]
buffer_load_dwordx4 v226, s[20:23], s57 offen offset:1024 sc1 lds
v_mfma_f32_16x16x32_bf16 v[124:127], a[8:11], a[132:135], v[124:127]
ds_read_b128 a[0:3], v224 offset:32768
s_waitcnt lgkmcnt(4)
v_mfma_f32_16x16x32_bf16 v[124:127], a[12:15], a[140:143], v[124:127]
v_mfma_f32_16x16x32_bf16 v[120:123], a[12:15], a[136:139], v[120:123]
ds_read_b128 a[4:7], v224 offset:33792
v_mfma_f32_16x16x32_bf16 v[120:123], a[8:11], a[128:131], v[120:123]
buffer_load_dwordx4 v226, s[20:23], s57 offen offset:2048 sc1 lds
v_mfma_f32_16x16x32_bf16 v[128:131], a[16:19], a[128:131], v[128:131]
ds_read_b128 a[8:11], v224 offset:34816
s_waitcnt lgkmcnt(4)
v_mfma_f32_16x16x32_bf16 v[128:131], a[20:23], a[136:139], v[128:131]
v_mfma_f32_16x16x32_bf16 v[132:135], a[20:23], a[140:143], v[132:135]
ds_read_b128 a[12:15], v224 offset:35840
v_mfma_f32_16x16x32_bf16 v[132:135], a[16:19], a[132:135], v[132:135]
buffer_load_dwordx4 v226, s[20:23], s57 offen offset:3072 sc1 lds
buffer_load_dword v234, v235, s[20:23], s46 offen sc1
v_mfma_f32_16x16x32_bf16 v[140:143], a[24:27], a[132:135], v[140:143]
ds_read_b128 a[16:19], v224 offset:36864
s_waitcnt lgkmcnt(4)
v_mfma_f32_16x16x32_bf16 v[140:143], a[28:31], a[140:143], v[140:143]
v_mfma_f32_16x16x32_bf16 v[136:139], a[28:31], a[136:139], v[136:139]
ds_read_b128 a[20:23], v224 offset:37888
v_mfma_f32_16x16x32_bf16 v[136:139], a[24:27], a[128:131], v[136:139]
buffer_load_dwordx4 v[148:151], v224, s[20:23], s11 offen offset:2048 sc1
v_mfma_f32_16x16x32_bf16 v[0:3], a[0:3], a[144:147], v[0:3]
ds_read_b128 a[24:27], v224 offset:38912
s_waitcnt lgkmcnt(4)
v_mfma_f32_16x16x32_bf16 v[0:3], a[4:7], a[152:155], v[0:3]
v_mfma_f32_16x16x32_bf16 v[4:7], a[4:7], a[156:159], v[4:7]
ds_read_b128 a[28:31], v224 offset:39936
v_mfma_f32_16x16x32_bf16 v[4:7], a[0:3], a[148:151], v[4:7]
v_mfma_f32_16x16x32_bf16 v[12:15], a[8:11], a[148:151], v[12:15]
ds_read_b128 a[0:3], v224 offset:40960
s_waitcnt lgkmcnt(4)
v_mfma_f32_16x16x32_bf16 v[12:15], a[12:15], a[156:159], v[12:15]
buffer_load_dwordx4 v[152:155], v224, s[20:23], s10 offen offset:3072 sc1
v_mfma_f32_16x16x32_bf16 v[8:11], a[12:15], a[152:155], v[8:11]
ds_read_b128 a[4:7], v224 offset:41984
v_mfma_f32_16x16x32_bf16 v[8:11], a[8:11], a[144:147], v[8:11]
v_mfma_f32_16x16x32_bf16 v[16:19], a[16:19], a[144:147], v[16:19]
ds_read_b128 a[8:11], v224 offset:43008
s_waitcnt lgkmcnt(4)
v_mfma_f32_16x16x32_bf16 v[16:19], a[20:23], a[152:155], v[16:19]
buffer_load_dwordx4 v[156:159], v224, s[20:23], s11 offen offset:3072 sc1
v_mfma_f32_16x16x32_bf16 v[20:23], a[20:23], a[156:159], v[20:23]
ds_read_b128 a[12:15], v224 offset:44032
v_mfma_f32_16x16x32_bf16 v[20:23], a[16:19], a[148:151], v[20:23]
v_mfma_f32_16x16x32_bf16 v[28:31], a[24:27], a[148:151], v[28:31]
ds_read_b128 a[16:19], v224 offset:45056
s_add_u32 m0, s36, 114688
s_waitcnt lgkmcnt(4)
v_mfma_f32_16x16x32_bf16 v[28:31], a[28:31], a[156:159], v[28:31]
s_add_u32 s57, s92, 278528
v_mfma_f32_16x16x32_bf16 v[24:27], a[28:31], a[152:155], v[24:27]
buffer_load_dwordx4 v226, s[20:23], s57 offen offset:0 sc1 lds
v_mfma_f32_16x16x32_bf16 v[24:27], a[24:27], a[144:147], v[24:27]
ds_read_b128 a[20:23], v224 offset:46080
v_mfma_f32_16x16x32_bf16 v[112:115], a[0:3], a[144:147], v[112:115]
ds_read_b128 a[24:27], v224 offset:47104
s_waitcnt lgkmcnt(4)
v_mfma_f32_16x16x32_bf16 v[112:115], a[4:7], a[152:155], v[112:115]
buffer_load_dwordx4 v226, s[20:23], s57 offen offset:1024 sc1 lds
s_barrier
v_mfma_f32_16x16x32_bf16 v[116:119], a[4:7], a[156:159], v[116:119]
ds_read_b128 a[28:31], v224 offset:48128
v_mfma_f32_16x16x32_bf16 v[116:119], a[0:3], a[148:151], v[116:119]
v_mfma_f32_16x16x32_bf16 v[124:127], a[8:11], a[148:151], v[124:127]
ds_read_b128 a[0:3], v224 offset:49152
s_waitcnt lgkmcnt(4)
v_mfma_f32_16x16x32_bf16 v[124:127], a[12:15], a[156:159], v[124:127]
buffer_load_dwordx4 v226, s[20:23], s57 offen offset:2048 sc1 lds
v_mfma_f32_16x16x32_bf16 v[120:123], a[12:15], a[152:155], v[120:123]
ds_read_b128 a[4:7], v224 offset:50176
v_mfma_f32_16x16x32_bf16 v[120:123], a[8:11], a[144:147], v[120:123]
v_mfma_f32_16x16x32_bf16 v[128:131], a[16:19], a[144:147], v[128:131]
ds_read_b128 a[8:11], v224 offset:51200
s_waitcnt lgkmcnt(4)
v_mfma_f32_16x16x32_bf16 v[128:131], a[20:23], a[152:155], v[128:131]
v_mfma_f32_16x16x32_bf16 v[132:135], a[20:23], a[156:159], v[132:135]
ds_read_b128 a[12:15], v224 offset:52224
v_mfma_f32_16x16x32_bf16 v[132:135], a[16:19], a[148:151], v[132:135]
buffer_load_dwordx4 v226, s[20:23], s57 offen offset:3072 sc1 lds
v_mfma_f32_16x16x32_bf16 v[140:143], a[24:27], a[148:151], v[140:143]
ds_read_b128 a[16:19], v224 offset:53248
s_waitcnt lgkmcnt(4)
v_mfma_f32_16x16x32_bf16 v[140:143], a[28:31], a[156:159], v[140:143]
v_mfma_f32_16x16x32_bf16 v[136:139], a[28:31], a[152:155], v[136:139]
ds_read_b128 a[20:23], v224 offset:54272
v_mfma_f32_16x16x32_bf16 v[136:139], a[24:27], a[144:147], v[136:139]
s_add_u32 s10, s85, 36864
v_mfma_f32_16x16x32_bf16 v[0:3], a[0:3], a[160:163], v[0:3]
buffer_load_dwordx4 a[192:195], v224, s[20:23], s10 offen offset:0 sc1
s_waitcnt lgkmcnt(3)
v_mfma_f32_16x16x32_bf16 v[0:3], a[4:7], a[168:171], v[0:3]
ds_read_b128 a[24:27], v224 offset:55296
v_mfma_f32_16x16x32_bf16 v[4:7], a[4:7], a[172:175], v[4:7]
ds_read_b128 a[28:31], v224 offset:56320
v_mfma_f32_16x16x32_bf16 v[4:7], a[0:3], a[164:167], v[4:7]
s_add_u32 s11, s85, 151552
s_waitcnt vmcnt(8)
v_cmp_ne_u32 vcc, v253, v234
s_nop 0
s_and_b32 s14, vcc_lo, 0xffff
s_cbranch_scc1 L_poll10
L_poll10_ok:
s_add_u32 s46, s46, 0x4000
v_mfma_f32_16x16x32_bf16 v[12:15], a[8:11], a[164:167], v[12:15]
buffer_load_dwordx4 a[196:199], v224, s[20:23], s11 offen offset:0 sc1
s_waitcnt lgkmcnt(3)
v_mfma_f32_16x16x32_bf16 v[12:15], a[12:15], a[172:175], v[12:15]
ds_read_b128 a[0:3], v224 offset:57344
v_mfma_f32_16x16x32_bf16 v[8:11], a[12:15], a[168:171], v[8:11]
ds_read_b128 a[4:7], v224 offset:58368
v_mfma_f32_16x16x32_bf16 v[8:11], a[8:11], a[160:163], v[8:11]
buffer_load_dwordx4 a[200:203], v224, s[20:23], s10 offen offset:1024 sc1
v_mfma_f32_16x16x32_bf16 v[16:19], a[16:19], a[160:163], v[16:19]
ds_read_b128 a[8:11], v224 offset:59392
s_waitcnt lgkmcnt(4)
v_mfma_f32_16x16x32_bf16 v[16:19], a[20:23], a[168:171], v[16:19]
v_mfma_f32_16x16x32_bf16 v[20:23], a[20:23], a[172:175], v[20:23]
ds_read_b128 a[12:15], v224 offset:60416
v_mfma_f32_16x16x32_bf16 v[20:23], a[16:19], a[164:167], v[20:23]
v_mfma_f32_16x16x32_bf16 v[28:31], a[24:27], a[164:167], v[28:31]
ds_read_b128 a[16:19], v224 offset:61440
s_waitcnt lgkmcnt(4)
v_mfma_f32_16x16x32_bf16 v[28:31], a[28:31], a[172:175], v[28:31]
buffer_load_dwordx4 a[204:207], v224, s[20:23], s11 offen offset:1024 sc1
L_ct4:
v_mfma_f32_16x16x32_bf16 v[24:27], a[28:31], a[168:171], v[24:27]
ds_read_b128 a[20:23], v224 offset:62464
v_mfma_f32_16x16x32_bf16 v[24:27], a[24:27], a[160:163], v[24:27]
v_mfma_f32_16x16x32_bf16 v[112:115], a[0:3], a[160:163], v[112:115]
ds_read_b128 a[24:27], v224 offset:63488
s_add_u32 m0, s36, 0
s_waitcnt lgkmcnt(4)
v_mfma_f32_16x16x32_bf16 v[112:115], a[4:7], a[168:171], v[112:115]
s_add_u32 s57, s93, 294912
s_barrier
v_mfma_f32_16x16x32_bf16 v[116:119], a[4:7], a[172:175], v[116:119]
buffer_load_dwordx4 v226, s[20:23], s57 offen offset:0 sc1 lds
v_mfma_f32_16x16x32_bf16 v[116:119], a[0:3], a[164:167], v[116:119]
ds_read_b128 a[28:31], v224 offset:64512
v_mfma_f32_16x16x32_bf16 v[124:127], a[8:11], a[164:167], v[124:127]
ds_read_b128 a[0:3], v225 offset:0
s_waitcnt lgkmcnt(4)
v_mfma_f32_16x16x32_bf16 v[124:127], a[12:15], a[172:175], v[124:127]
buffer_load_dwordx4 v226, s[20:23], s57 offen offset:1024 sc1 lds
v_mfma_f32_16x16x32_bf16 v[120:123], a[12:15], a[168:171], v[120:123]
ds_read_b128 a[4:7], v225 offset:1024
v_mfma_f32_16x16x32_bf16 v[120:123], a[8:11], a[160:163], v[120:123]
v_mfma_f32_16x16x32_bf16 v[128:131], a[16:19], a[160:163], v[128:131]
ds_read_b128 a[8:11], v225 offset:2048
s_waitcnt lgkmcnt(4)
v_mfma_f32_16x16x32_bf16 v[128:131], a[20:23], a[168:171], v[128:131]
buffer_load_dwordx4 v226, s[20:23], s57 offen offset:2048 sc1 lds
v_mfma_f32_16x16x32_bf16 v[132:135], a[20:23], a[172:175], v[132:135]
ds_read_b128 a[12:15], v225 offset:3072
v_mfma_f32_16x16x32_bf16 v[132:135], a[16:19], a[164:167], v[132:135]
v_mfma_f32_16x16x32_bf16 v[140:143], a[24:27], a[164:167], v[140:143]
ds_read_b128 a[16:19], v225 offset:4096
s_waitcnt lgkmcnt(4)
v_mfma_f32_16x16x32_bf16 v[140:143], a[28:31], a[172:175], v[140:143]
buffer_load_dwordx4 v226, s[20:23], s57 offen offset:3072 sc1 lds
v_mfma_f32_16x16x32_bf16 v[136:139], a[28:31], a[168:171], v[136:139]
ds_read_b128 a[20:23], v225 offset:5120
v_mfma_f32_16x16x32_bf16 v[136:139], a[24:27], a[160:163], v[136:139]
v_mfma_f32_16x16x32_bf16 v[0:3], a[0:3], a[176:179], v[0:3]
ds_read_b128 a[24:27], v225 offset:6144
s_waitcnt lgkmcnt(4)
v_mfma_f32_16x16x32_bf16 v[0:3], a[4:7], a[184:187], v[0:3]
v_mfma_f32_16x16x32_bf16 v[4:7], a[4:7], a[188:191], v[4:7]
ds_read_b128 a[28:31], v225 offset:7168
v_mfma_f32_16x16x32_bf16 v[4:7], a[0:3], a[180:183], v[4:7]
buffer_load_dwordx4 a[208:211], v224, s[20:23], s10 offen offset:2048 sc1
v_mfma_f32_16x16x32_bf16 v[12:15], a[8:11], a[180:183], v[12:15]
ds_read_b128 a[0:3], v225 offset:8192
s_waitcnt lgkmcnt(4)
v_mfma_f32_16x16x32_bf16 v[12:15], a[12:15], a[188:191], v[12:15]
v_mfma_f32_16x16x32_bf16 v[8:11], a[12:15], a[184:187], v[8:11]
ds_read_b128 a[4:7], v225 offset:9216
v_mfma_f32_16x16x32_bf16 v[8:11], a[8:11], a[176:179], v[8:11]
buffer_load_dwordx4 a[212:215], v224, s[20:23], s11 offen offset:2048 sc1
v_mfma_f32_16x16x32_bf16 v[16:19], a[16:19], a[176:179], v[16:19]
ds_read_b128 a[8:11], v225 offset:10240
s_waitcnt lgkmcnt(4)
v_mfma_f32_16x16x32_bf16 v[16:19], a[20:23], a[184:187], v[16:19]
v_mfma_f32_16x16x32_bf16 v[20:23], a[20:23], a[188:191], v[20:23]
ds_read_b128 a[12:15], v225 offset:11264
v_mfma_f32_16x16x32_bf16 v[20:23], a[16:19], a[180:183], v[20:23]
buffer_load_dwordx4 a[216:219], v224, s[20:23], s10 offen offset:3072 sc1
v_mfma_f32_16x16x32_bf16 v[28:31], a[24:27], a[180:183], v[28:31]
ds_read_b128 a[16:19], v225 offset:12288
s_waitcnt lgkmcnt(4)
v_mfma_f32_16x16x32_bf16 v[28:31], a[28:31], a[188:191], v[28:31]
v_mfma_f32_16x16x32_bf16 v[24:27], a[28:31], a[184:187], v[24:27]
ds_read_b128 a[20:23], v225 offset:13312
v_mfma_f32_16x16x32_bf16 v[24:27], a[24:27], a[176:179], v[24:27]
buffer_load_dwordx4 a[220:223], v224, s[20:23], s11 offen offset:3072 sc1
v_mfma_f32_16x16x32_bf16 v[112:115], a[0:3], a[176:179], v[112:115]
ds_read_b128 a[24:27], v225 offset:14336
s_waitcnt lgkmcnt(4)
v_mfma_f32_16x16x32_bf16 v[112:115], a[4:7], a[184:187], v[112:115]
s_barrier
v_mfma_f32_16x16x32_bf16 v[116:119], a[4:7], a[188:191], v[116:119]
ds_read_b128 a[28:31], v225 offset:15360
v_mfma_f32_16x16x32_bf16 v[116:119], a[0:3], a[180:183], v[116:119]
v_mfma_f32_16x16x32_bf16 v[124:127], a[8:11], a[180:183], v[124:127]
ds_read_b128 a[0:3], v225 offset:16384
s_add_u32 m0, s36, 16384
s_waitcnt lgkmcnt(4)
v_mfma_f32_16x16x32_bf16 v[124:127], a[12:15], a[188:191], v[124:127]
s_add_u32 s57, s93, 311296
v_mfma_f32_16x16x32_bf16 v[120:123], a[12:15], a[184:187], v[120:123]
buffer_load_dwordx4 v226, s[20:23], s57 offen offset:0 sc1 lds
v_mfma_f32_16x16x32_bf16 v[120:123], a[8:11], a[176:179], v[120:123]
ds_read_b128 a[4:7], v225 offset:17408
v_mfma_f32_16x16x32_bf16 v[128:131], a[16:19], a[176:179], v[128:131]
ds_read_b128 a[8:11], v225 offset:18432
s_waitcnt lgkmcnt(4)
v_mfma_f32_16x16x32_bf16 v[128:131], a[20:23], a[184:187], v[128:131]
buffer_load_dwordx4 v226, s[20:23], s57 offen offset:1024 sc1 lds
v_mfma_f32_16x16x32_bf16 v[132:135], a[20:23], a[188:191], v[132:135]
ds_read_b128 a[12:15], v225 offset:19456
v_mfma_f32_16x16x32_bf16 v[132:135], a[16:19], a[180:183], v[132:135]
buffer_load_dword v234, v235, s[20:23], s46 offen sc1
v_mfma_f32_16x16x32_bf16 v[140:143], a[24:27], a[180:183], v[140:143]
ds_read_b128 a[16:19], v225 offset:20480
s_waitcnt lgkmcnt(4)
v_mfma_f32_16x16x32_bf16 v[140:143], a[28:31], a[188:191], v[140:143]
buffer_load_dwordx4 v226, s[20:23], s57 offen offset:2048 sc1 lds
v_mfma_f32_16x16x32_bf16 v[136:139], a[28:31], a[184:187], v[136:139]
ds_read_b128 a[20:23], v225 offset:21504
v_mfma_f32_16x16x32_bf16 v[136:139], a[24:27], a[176:179], v[136:139]
v_mfma_f32_16x16x32_bf16 v[0:3], a[0:3], v[160:163], v[0:3]
ds_read_b128 a[24:27], v225 offset:22528
s_waitcnt lgkmcnt(4)
v_mfma_f32_16x16x32_bf16 v[0:3], a[4:7], v[168:171], v[0:3]
buffer_load_dwordx4 v226, s[20:23], s57 offen offset:3072 sc1 lds
v_mfma_f32_16x16x32_bf16 v[4:7], a[4:7], v[172:175], v[4:7]
ds_read_b128 a[28:31], v225 offset:23552
v_mfma_f32_16x16x32_bf16 v[4:7], a[0:3], v[164:167], v[4:7]
v_mfma_f32_16x16x32_bf16 v[12:15], a[8:11], v[164:167], v[12:15]
ds_read_b128 a[0:3], v225 offset:24576
s_waitcnt lgkmcnt(4)
v_mfma_f32_16x16x32_bf16 v[12:15], a[12:15], v[172:175], v[12:15]
s_add_u32 s10, s40, 40960
v_mfma_f32_16x16x32_bf16 v[8:11], a[12:15], v[168:171], v[8:11]
buffer_load_dwordx4 a[224:227], v224, s[20:23], s10 offen offset:0 sc1
v_mfma_f32_16x16x32_bf16 v[8:11], a[8:11], v[160:163], v[8:11]
ds_read_b128 a[4:7], v225 offset:25600
v_mfma_f32_16x16x32_bf16 v[16:19], a[16:19], v[160:163], v[16:19]
ds_read_b128 a[8:11], v225 offset:26624
s_waitcnt lgkmcnt(4)
v_mfma_f32_16x16x32_bf16 v[16:19], a[20:23], v[168:171], v[16:19]
v_mfma_f32_16x16x32_bf16 v[20:23], a[20:23], v[172:175], v[20:23]
ds_read_b128 a[12:15], v225 offset:27648
v_mfma_f32_16x16x32_bf16 v[20:23], a[16:19], v[164:167], v[20:23]
s_add_u32 s11, s40, 155648
v_mfma_f32_16x16x32_bf16 v[28:31], a[24:27], v[164:167], v[28:31]
buffer_load_dwordx4 a[228:231], v224, s[20:23], s11 offen offset:0 sc1
s_waitcnt lgkmcnt(3)
v_mfma_f32_16x16x32_bf16 v[28:31], a[28:31], v[172:175], v[28:31]
ds_read_b128 a[16:19], v225 offset:28672
v_mfma_f32_16x16x32_bf16 v[24:27], a[28:31], v[168:171], v[24:27]
ds_read_b128 a[20:23], v225 offset:29696
v_mfma_f32_16x16x32_bf16 v[24:27], a[24:27], v[160:163], v[24:27]
buffer_load_dwordx4 a[232:235], v224, s[20:23], s10 offen offset:1024 sc1
v_mfma_f32_16x16x32_bf16 v[112:115], a[0:3], v[160:163], v[112:115]
ds_read_b128 a[24:27], v225 offset:30720
s_waitcnt lgkmcnt(4)
v_mfma_f32_16x16x32_bf16 v[112:115], a[4:7], v[168:171], v[112:115]
s_barrier
v_mfma_f32_16x16x32_bf16 v[116:119], a[4:7], v[172:175], v[116:119]
ds_read_b128 a[28:31], v225 offset:31744
s_add_u32 m0, s36, 32768
v_mfma_f32_16x16x32_bf16 v[116:119], a[0:3], v[164:167], v[116:119]
s_add_u32 s57, s38, 327680
v_mfma_f32_16x16x32_bf16 v[124:127], a[8:11], v[164:167], v[124:127]
buffer_load_dwordx4 v226, s[20:23], s57 offen offset:0 sc1 lds
s_waitcnt lgkmcnt(3)
v_mfma_f32_16x16x32_bf16 v[124:127], a[12:15], v[172:175], v[124:127]
ds_read_b128 a[0:3], v225 offset:32768
v_mfma_f32_16x16x32_bf16 v[120:123], a[12:15], v[168:171], v[120:123]
ds_read_b128 a[4:7], v225 offset:33792
v_mfma_f32_16x16x32_bf16 v[120:123], a[8:11], v[160:163], v[120:123]
buffer_load_dwordx4 v226, s[20:23], s57 offen offset:1024 sc1 lds
v_mfma_f32_16x16x32_bf16 v[128:131], a[16:19], v[160:163], v[128:131]
ds_read_b128 a[8:11], v225 offset:34816
s_waitcnt lgkmcnt(4)
v_mfma_f32_16x16x32_bf16 v[128:131], a[20:23], v[168:171], v[128:131]
v_mfma_f32_16x16x32_bf16 v[132:135], a[20:23], v[172:175], v[132:135]
ds_read_b128 a[12:15], v225 offset:35840
v_mfma_f32_16x16x32_bf16 v[132:135], a[16:19], v[164:167], v[132:135]
v_mfma_f32_16x16x32_bf16 v[140:143], a[24:27], v[164:167], v[140:143]
ds_read_b128 a[16:19], v225 offset:36864
s_waitcnt lgkmcnt(4)
v_mfma_f32_16x16x32_bf16 v[140:143], a[28:31], v[172:175], v[140:143]
buffer_load_dwordx4 v226, s[20:23], s57 offen offset:2048 sc1 lds
v_mfma_f32_16x16x32_bf16 v[136:139], a[28:31], v[168:171], v[136:139]
ds_read_b128 a[20:23], v225 offset:37888
v_mfma_f32_16x16x32_bf16 v[136:139], a[24:27], v[160:163], v[136:139]
v_mfma_f32_16x16x32_bf16 v[0:3], a[0:3], v[32:35], v[0:3]
ds_read_b128 a[24:27], v225 offset:38912
s_waitcnt lgkmcnt(4)
v_mfma_f32_16x16x32_bf16 v[0:3], a[4:7], v[40:43], v[0:3]
buffer_load_dwordx4 v226, s[20:23], s57 offen offset:3072 sc1 lds
v_mfma_f32_16x16x32_bf16 v[4:7], a[4:7], v[44:47], v[4:7]
ds_read_b128 a[28:31], v225 offset:39936
v_mfma_f32_16x16x32_bf16 v[4:7], a[0:3], v[36:39], v[4:7]
s_waitcnt vmcnt(9)
v_cmp_ne_u32 vcc, v253, v234
s_nop 0
s_and_b32 s14, vcc_lo, 0xffff
s_cbranch_scc1 L_poll11
L_poll11_ok:
s_add_u32 s46, s46, 0x4000
v_mfma_f32_16x16x32_bf16 v[12:15], a[8:11], v[36:39], v[12:15]
ds_read_b128 a[0:3], v225 offset:40960
s_waitcnt lgkmcnt(4)
v_mfma_f32_16x16x32_bf16 v[12:15], a[12:15], v[44:47], v[12:15]
buffer_load_dwordx4 a[236:239], v224, s[20:23], s11 offen offset:1024 sc1
v_mfma_f32_16x16x32_bf16 v[8:11], a[12:15], v[40:43], v[8:11]
ds_read_b128 a[4:7], v225 offset:41984
v_mfma_f32_16x16x32_bf16 v[8:11], a[8:11], v[32:35], v[8:11]
v_mfma_f32_16x16x32_bf16 v[16:19], a[16:19], v[32:35], v[16:19]
ds_read_b128 a[8:11], v225 offset:43008
s_waitcnt lgkmcnt(4)
v_mfma_f32_16x16x32_bf16 v[16:19], a[20:23], v[40:43], v[16:19]
buffer_load_dwordx4 a[240:243], v224, s[20:23], s10 offen offset:2048 sc1
v_mfma_f32_16x16x32_bf16 v[20:23], a[20:23], v[44:47], v[20:23]
ds_read_b128 a[12:15], v225 offset:44032
v_mfma_f32_16x16x32_bf16 v[20:23], a[16:19], v[36:39], v[20:23]
v_and_b32 v249, 60, v229
v_mfma_f32_16x16x32_bf16 v[28:31], a[24:27], v[36:39], v[28:31]
v_lshlrev_b32 v249, 5, v249
s_waitcnt lgkmcnt(3)
v_mfma_f32_16x16x32_bf16 v[28:31], a[28:31], v[44:47], v[28:31]
ds_read_b128 a[16:19], v225 offset:45056
s_add_u32 m0, s36, 49152
v_mfma_f32_16x16x32_bf16 v[24:27], a[28:31], v[40:43], v[24:27]
s_add_u32 s57, s38, 344064
v_mfma_f32_16x16x32_bf16 v[24:27], a[24:27], v[32:35], v[24:27]
buffer_load_dwordx4 v226, s[20:23], s57 offen offset:0 sc1 lds
v_mfma_f32_16x16x32_bf16 v[112:115], a[0:3], v[32:35], v[112:115]
ds_read_b128 a[20:23], v225 offset:46080
s_waitcnt lgkmcnt(3)
v_mfma_f32_16x16x32_bf16 v[112:115], a[4:7], v[40:43], v[112:115]
ds_read_b128 a[24:27], v225 offset:47104
s_barrier
v_mfma_f32_16x16x32_bf16 v[116:119], a[4:7], v[44:47], v[116:119]
ds_read_b128 a[28:31], v225 offset:48128
v_mfma_f32_16x16x32_bf16 v[116:119], a[0:3], v[36:39], v[116:119]
buffer_load_dwordx4 v226, s[20:23], s57 offen offset:1024 sc1 lds
v_mfma_f32_16x16x32_bf16 v[124:127], a[8:11], v[36:39], v[124:127]
ds_read_b128 a[0:3], v225 offset:49152
s_waitcnt lgkmcnt(4)
v_mfma_f32_16x16x32_bf16 v[124:127], a[12:15], v[44:47], v[124:127]
v_mfma_f32_16x16x32_bf16 v[120:123], a[12:15], v[40:43], v[120:123]
ds_read_b128 a[4:7], v225 offset:50176
v_mfma_f32_16x16x32_bf16 v[120:123], a[8:11], v[32:35], v[120:123]
buffer_load_dwordx4 v226, s[20:23], s57 offen offset:2048 sc1 lds
v_mfma_f32_16x16x32_bf16 v[128:131], a[16:19], v[32:35], v[128:131]
ds_read_b128 a[8:11], v225 offset:51200
v_lshlrev_b32 v252, 3, v224
s_waitcnt lgkmcnt(4)
v_mfma_f32_16x16x32_bf16 v[128:131], a[20:23], v[40:43], v[128:131]
s_mov_b32 s58, L_ct5-L_body
buffer_load_dword v234, v249, s[20:23], s50 offen sc1
v_mfma_f32_16x16x32_bf16 v[132:135], a[20:23], v[44:47], v[132:135]
buffer_load_dword v252, v252, s[80:83], s58 offen
v_mfma_f32_16x16x32_bf16 v[132:135], a[16:19], v[36:39], v[132:135]
ds_read_b128 a[12:15], v225 offset:52224
v_mfma_f32_16x16x32_bf16 v[140:143], a[24:27], v[36:39], v[140:143]
buffer_load_dwordx4 v226, s[20:23], s57 offen offset:3072 sc1 lds
s_waitcnt lgkmcnt(3)
v_mfma_f32_16x16x32_bf16 v[140:143], a[28:31], v[44:47], v[140:143]
ds_read_b128 a[16:19], v225 offset:53248
v_mfma_f32_16x16x32_bf16 v[136:139], a[28:31], v[40:43], v[136:139]
ds_read_b128 a[20:23], v225 offset:54272
v_mfma_f32_16x16x32_bf16 v[136:139], a[24:27], v[32:35], v[136:139]
buffer_load_dwordx4 a[244:247], v224, s[20:23], s11 offen offset:2048 sc1
v_mfma_f32_16x16x32_bf16 v[0:3], a[0:3], v[144:147], v[0:3]
ds_read_b128 a[24:27], v225 offset:55296
s_waitcnt lgkmcnt(4)
v_mfma_f32_16x16x32_bf16 v[0:3], a[4:7], v[152:155], v[0:3]
v_mfma_f32_16x16x32_bf16 v[4:7], a[4:7], v[156:159], v[4:7]
ds_read_b128 a[28:31], v225 offset:56320
v_mfma_f32_16x16x32_bf16 v[4:7], a[0:3], v[148:151], v[4:7]
v_mfma_f32_16x16x32_bf16 v[12:15], a[8:11], v[148:151], v[12:15]
ds_read_b128 a[0:3], v225 offset:57344
s_waitcnt lgkmcnt(4)
v_mfma_f32_16x16x32_bf16 v[12:15], a[12:15], v[156:159], v[12:15]
buffer_load_dwordx4 a[248:251], v224, s[20:23], s10 offen offset:3072 sc1
v_mfma_f32_16x16x32_bf16 v[8:11], a[12:15], v[152:155], v[8:11]
ds_read_b128 a[4:7], v225 offset:58368
v_mfma_f32_16x16x32_bf16 v[8:11], a[8:11], v[144:147], v[8:11]
v_mfma_f32_16x16x32_bf16 v[16:19], a[16:19], v[144:147], v[16:19]
ds_read_b128 a[8:11], v225 offset:59392
s_waitcnt lgkmcnt(4)
v_mfma_f32_16x16x32_bf16 v[16:19], a[20:23], v[152:155], v[16:19]
buffer_load_dwordx4 a[252:255], v224, s[20:23], s11 offen offset:3072 sc1
v_mfma_f32_16x16x32_bf16 v[20:23], a[20:23], v[156:159], v[20:23]
ds_read_b128 a[12:15], v225 offset:60416
v_mfma_f32_16x16x32_bf16 v[20:23], a[16:19], v[148:151], v[20:23]
v_mfma_f32_16x16x32_bf16 v[28:31], a[24:27], v[148:151], v[28:31]
ds_read_b128 a[16:19], v225 offset:61440
s_add_u32 m0, s36, 65536
s_waitcnt lgkmcnt(4)
v_mfma_f32_16x16x32_bf16 v[28:31], a[28:31], v[156:159], v[28:31]
s_add_u32 s57, s38, 360448
v_mfma_f32_16x16x32_bf16 v[24:27], a[28:31], v[152:155], v[24:27]
buffer_load_dwordx4 v226, s[20:23], s57 offen offset:0 sc1 lds
v_mfma_f32_16x16x32_bf16 v[24:27], a[24:27], v[144:147], v[24:27]
ds_read_b128 a[20:23], v225 offset:62464
v_mfma_f32_16x16x32_bf16 v[112:115], a[0:3], v[144:147], v[112:115]
ds_read_b128 a[24:27], v225 offset:63488
s_waitcnt lgkmcnt(4)
v_mfma_f32_16x16x32_bf16 v[112:115], a[4:7], v[152:155], v[112:115]
buffer_load_dwordx4 v226, s[20:23], s57 offen offset:1024 sc1 lds
s_barrier
v_mfma_f32_16x16x32_bf16 v[116:119], a[4:7], v[156:159], v[116:119]
ds_read_b128 a[28:31], v225 offset:64512
v_mfma_f32_16x16x32_bf16 v[116:119], a[0:3], v[148:151], v[116:119]
v_mfma_f32_16x16x32_bf16 v[124:127], a[8:11], v[148:151], v[124:127]
ds_read_b128 a[0:3], v224 offset:0
s_waitcnt lgkmcnt(4)
v_mfma_f32_16x16x32_bf16 v[124:127], a[12:15], v[156:159], v[124:127]
buffer_load_dwordx4 v226, s[20:23], s57 offen offset:2048 sc1 lds
v_mfma_f32_16x16x32_bf16 v[120:123], a[12:15], v[152:155], v[120:123]
ds_read_b128 a[4:7], v224 offset:1024
v_mfma_f32_16x16x32_bf16 v[120:123], a[8:11], v[144:147], v[120:123]
v_mfma_f32_16x16x32_bf16 v[128:131], a[16:19], v[144:147], v[128:131]
ds_read_b128 a[8:11], v224 offset:2048
s_waitcnt lgkmcnt(4)
v_mfma_f32_16x16x32_bf16 v[128:131], a[20:23], v[152:155], v[128:131]
v_mfma_f32_16x16x32_bf16 v[132:135], a[20:23], v[156:159], v[132:135]
ds_read_b128 a[12:15], v224 offset:3072
v_mfma_f32_16x16x32_bf16 v[132:135], a[16:19], v[148:151], v[132:135]
buffer_load_dwordx4 v226, s[20:23], s57 offen offset:3072 sc1 lds
v_mfma_f32_16x16x32_bf16 v[140:143], a[24:27], v[148:151], v[140:143]
ds_read_b128 a[16:19], v224 offset:4096
s_waitcnt lgkmcnt(4)
v_mfma_f32_16x16x32_bf16 v[140:143], a[28:31], v[156:159], v[140:143]
v_mfma_f32_16x16x32_bf16 v[136:139], a[28:31], v[152:155], v[136:139]
ds_read_b128 a[20:23], v224 offset:5120
v_mfma_f32_16x16x32_bf16 v[136:139], a[24:27], v[144:147], v[136:139]
s_add_u32 s10, s40, 45056
v_mfma_f32_16x16x32_bf16 v[0:3], a[0:3], a[192:195], v[0:3]
buffer_load_dwordx4 a[32:35], v224, s[20:23], s10 offen offset:0 sc1
s_waitcnt lgkmcnt(3)
v_mfma_f32_16x16x32_bf16 v[0:3], a[4:7], a[200:203], v[0:3]
ds_read_b128 a[24:27], v224 offset:6144
s_waitcnt vmcnt(10)
v_cmp_ne_u32 vcc, v253, v234
s_nop 0
s_and_b32 s14, vcc_lo, 0xffff
s_cbranch_scc1 L_poll12
L_poll12_ok:
v_mfma_f32_16x16x32_bf16 v[4:7], a[4:7], a[204:207], v[4:7]
ds_read_b128 a[28:31], v224 offset:7168
v_mfma_f32_16x16x32_bf16 v[4:7], a[0:3], a[196:199], v[4:7]
s_add_u32 s11, s40, 159744
v_mfma_f32_16x16x32_bf16 v[12:15], a[8:11], a[196:199], v[12:15]
buffer_load_dwordx4 a[36:39], v224, s[20:23], s11 offen offset:0 sc1
s_waitcnt lgkmcnt(3)
v_mfma_f32_16x16x32_bf16 v[12:15], a[12:15], a[204:207], v[12:15]
ds_read_b128 a[0:3], v224 offset:8192
v_mfma_f32_16x16x32_bf16 v[8:11], a[12:15], a[200:203], v[8:11]
ds_read_b128 a[4:7], v224 offset:9216
v_mfma_f32_16x16x32_bf16 v[8:11], a[8:11], a[192:195], v[8:11]
buffer_load_dwordx4 a[40:43], v224, s[20:23], s10 offen offset:1024 sc1
v_mfma_f32_16x16x32_bf16 v[16:19], a[16:19], a[192:195], v[16:19]
ds_read_b128 a[8:11], v224 offset:10240
s_waitcnt lgkmcnt(4)
v_mfma_f32_16x16x32_bf16 v[16:19], a[20:23], a[200:203], v[16:19]
v_mfma_f32_16x16x32_bf16 v[20:23], a[20:23], a[204:207], v[20:23]
ds_read_b128 a[12:15], v224 offset:11264
v_mfma_f32_16x16x32_bf16 v[20:23], a[16:19], a[196:199], v[20:23]
v_mfma_f32_16x16x32_bf16 v[28:31], a[24:27], a[196:199], v[28:31]
ds_read_b128 a[16:19], v224 offset:12288
s_waitcnt lgkmcnt(4)
v_mfma_f32_16x16x32_bf16 v[28:31], a[28:31], a[204:207], v[28:31]
buffer_load_dwordx4 a[44:47], v224, s[20:23], s11 offen offset:1024 sc1
v_mfma_f32_16x16x32_bf16 v[24:27], a[28:31], a[200:203], v[24:27]
ds_read_b128 a[20:23], v224 offset:13312
v_mfma_f32_16x16x32_bf16 v[24:27], a[24:27], a[192:195], v[24:27]
v_mfma_f32_16x16x32_bf16 v[112:115], a[0:3], a[192:195], v[112:115]
ds_read_b128 a[24:27], v224 offset:14336
s_waitcnt lgkmcnt(4)
v_mfma_f32_16x16x32_bf16 v[112:115], a[4:7], a[200:203], v[112:115]
buffer_load_dwordx4 a[48:51], v224, s[20:23], s10 offen offset:2048 sc1
s_barrier
v_mfma_f32_16x16x32_bf16 v[116:119], a[4:7], a[204:207], v[116:119]
ds_read_b128 a[28:31], v224 offset:15360
v_mfma_f32_16x16x32_bf16 v[116:119], a[0:3], a[196:199], v[116:119]
v_mfma_f32_16x16x32_bf16 v[124:127], a[8:11], a[196:199], v[124:127]
ds_read_b128 a[0:3], v224 offset:16384
s_waitcnt lgkmcnt(4)
v_mfma_f32_16x16x32_bf16 v[124:127], a[12:15], a[204:207], v[124:127]
buffer_load_dwordx4 a[52:55], v224, s[20:23], s11 offen offset:2048 sc1
v_mfma_f32_16x16x32_bf16 v[120:123], a[12:15], a[200:203], v[120:123]
ds_read_b128 a[4:7], v224 offset:17408
v_mfma_f32_16x16x32_bf16 v[120:123], a[8:11], a[192:195], v[120:123]
v_mfma_f32_16x16x32_bf16 v[128:131], a[16:19], a[192:195], v[128:131]
ds_read_b128 a[8:11], v224 offset:18432
s_waitcnt lgkmcnt(4)
v_mfma_f32_16x16x32_bf16 v[128:131], a[20:23], a[200:203], v[128:131]
buffer_load_dwordx4 a[56:59], v224, s[20:23], s10 offen offset:3072 sc1
v_mfma_f32_16x16x32_bf16 v[132:135], a[20:23], a[204:207], v[132:135]
ds_read_b128 a[12:15], v224 offset:19456
v_mfma_f32_16x16x32_bf16 v[132:135], a[16:19], a[196:199], v[132:135]
v_mfma_f32_16x16x32_bf16 v[140:143], a[24:27], a[196:199], v[140:143]
ds_read_b128 a[16:19], v224 offset:20480
s_waitcnt lgkmcnt(4)
v_mfma_f32_16x16x32_bf16 v[140:143], a[28:31], a[204:207], v[140:143]
buffer_load_dwordx4 a[60:63], v224, s[20:23], s11 offen offset:3072 sc1
v_mfma_f32_16x16x32_bf16 v[136:139], a[28:31], a[200:203], v[136:139]
ds_read_b128 a[20:23], v224 offset:21504
v_mfma_f32_16x16x32_bf16 v[136:139], a[24:27], a[192:195], v[136:139]
v_mfma_f32_16x16x32_bf16 v[0:3], a[0:3], a[208:211], v[0:3]
ds_read_b128 a[24:27], v224 offset:22528
s_waitcnt lgkmcnt(4)
v_mfma_f32_16x16x32_bf16 v[0:3], a[4:7], a[216:219], v[0:3]
v_mfma_f32_16x16x32_bf16 v[4:7], a[4:7], a[220:223], v[4:7]
ds_read_b128 a[28:31], v224 offset:23552
v_mfma_f32_16x16x32_bf16 v[4:7], a[0:3], a[212:215], v[4:7]
s_add_u32 s10, s40, 49152
v_mfma_f32_16x16x32_bf16 v[12:15], a[8:11], a[212:215], v[12:15]
buffer_load_dwordx4 a[64:67], v224, s[20:23], s10 offen offset:0 sc1
s_waitcnt lgkmcnt(3)
v_mfma_f32_16x16x32_bf16 v[12:15], a[12:15], a[220:223], v[12:15]
ds_read_b128 a[0:3], v224 offset:24576
v_mfma_f32_16x16x32_bf16 v[8:11], a[12:15], a[216:219], v[8:11]
ds_read_b128 a[4:7], v224 offset:25600
v_mfma_f32_16x16x32_bf16 v[8:11], a[8:11], a[208:211], v[8:11]
s_add_u32 s11, s40, 163840
v_mfma_f32_16x16x32_bf16 v[16:19], a[16:19], a[208:211], v[16:19]
buffer_load_dwordx4 a[68:71], v224, s[20:23], s11 offen offset:0 sc1
s_waitcnt lgkmcnt(3)
v_mfma_f32_16x16x32_bf16 v[16:19], a[20:23], a[216:219], v[16:19]
ds_read_b128 a[8:11], v224 offset:26624
v_mfma_f32_16x16x32_bf16 v[20:23], a[20:23], a[220:223], v[20:23]
ds_read_b128 a[12:15], v224 offset:27648
v_mfma_f32_16x16x32_bf16 v[20:23], a[16:19], a[212:215], v[20:23]
buffer_load_dwordx4 a[72:75], v224, s[20:23], s10 offen offset:1024 sc1
v_mfma_f32_16x16x32_bf16 v[28:31], a[24:27], a[212:215], v[28:31]
ds_read_b128 a[16:19], v224 offset:28672
s_waitcnt lgkmcnt(4)
v_mfma_f32_16x16x32_bf16 v[28:31], a[28:31], a[220:223], v[28:31]
v_mfma_f32_16x16x32_bf16 v[24:27], a[28:31], a[216:219], v[24:27]
ds_read_b128 a[20:23], v224 offset:29696
v_mfma_f32_16x16x32_bf16 v[24:27], a[24:27], a[208:211], v[24:27]
buffer_load_dwordx4 a[76:79], v224, s[20:23], s11 offen offset:1024 sc1
v_mfma_f32_16x16x32_bf16 v[112:115], a[0:3], a[208:211], v[112:115]
ds_read_b128 a[24:27], v224 offset:30720
s_waitcnt lgkmcnt(4)
v_mfma_f32_16x16x32_bf16 v[112:115], a[4:7], a[216:219], v[112:115]
s_barrier
v_mfma_f32_16x16x32_bf16 v[116:119], a[4:7], a[220:223], v[116:119]
ds_read_b128 a[28:31], v224 offset:31744
v_mfma_f32_16x16x32_bf16 v[116:119], a[0:3], a[212:215], v[116:119]
v_mfma_f32_16x16x32_bf16 v[124:127], a[8:11], a[212:215], v[124:127]
ds_read_b128 a[0:3], v224 offset:32768
s_add_u32 m0, s36, 81920
s_waitcnt lgkmcnt(4)
v_mfma_f32_16x16x32_bf16 v[124:127], a[12:15], a[220:223], v[124:127]
s_add_u32 s57, s38, 376832
v_mfma_f32_16x16x32_bf16 v[120:123], a[12:15], a[216:219], v[120:123]
buffer_load_dwordx4 v226, s[20:23], s57 offen offset:0 sc1 lds
v_mfma_f32_16x16x32_bf16 v[120:123], a[8:11], a[208:211], v[120:123]
ds_read_b128 a[4:7], v224 offset:33792
v_mfma_f32_16x16x32_bf16 v[128:131], a[16:19], a[208:211], v[128:131]
ds_read_b128 a[8:11], v224 offset:34816
s_waitcnt lgkmcnt(4)
v_mfma_f32_16x16x32_bf16 v[128:131], a[20:23], a[216:219], v[128:131]
buffer_load_dwordx4 v226, s[20:23], s57 offen offset:1024 sc1 lds
v_mfma_f32_16x16x32_bf16 v[132:135], a[20:23], a[220:223], v[132:135]
ds_read_b128 a[12:15], v224 offset:35840
v_mfma_f32_16x16x32_bf16 v[132:135], a[16:19], a[212:215], v[132:135]
v_mfma_f32_16x16x32_bf16 v[140:143], a[24:27], a[212:215], v[140:143]
ds_read_b128 a[16:19], v224 offset:36864
s_waitcnt lgkmcnt(4)
v_mfma_f32_16x16x32_bf16 v[140:143], a[28:31], a[220:223], v[140:143]
buffer_load_dwordx4 v226, s[20:23], s57 offen offset:2048 sc1 lds
v_mfma_f32_16x16x32_bf16 v[136:139], a[28:31], a[216:219], v[136:139]
ds_read_b128 a[20:23], v224 offset:37888
v_mfma_f32_16x16x32_bf16 v[136:139], a[24:27], a[208:211], v[136:139]
v_mfma_f32_16x16x32_bf16 v[0:3], a[0:3], a[224:227], v[0:3]
ds_read_b128 a[24:27], v224 offset:38912
s_waitcnt lgkmcnt(4)
v_mfma_f32_16x16x32_bf16 v[0:3], a[4:7], a[232:235], v[0:3]
buffer_load_dwordx4 v226, s[20:23], s57 offen offset:3072 sc1 lds
v_mfma_f32_16x16x32_bf16 v[4:7], a[4:7], a[236:239], v[4:7]
ds_read_b128 a[28:31], v224 offset:39936
v_mfma_f32_16x16x32_bf16 v[4:7], a[0:3], a[228:231], v[4:7]
v_mfma_f32_16x16x32_bf16 v[12:15], a[8:11], a[228:231], v[12:15]
ds_read_b128 a[0:3], v224 offset:40960
s_waitcnt lgkmcnt(4)
v_mfma_f32_16x16x32_bf16 v[12:15], a[12:15], a[236:239], v[12:15]
buffer_load_dwordx4 a[80:83], v224, s[20:23], s10 offen offset:2048 sc1
v_mfma_f32_16x16x32_bf16 v[8:11], a[12:15], a[232:235], v[8:11]
ds_read_b128 a[4:7], v224 offset:41984
v_mfma_f32_16x16x32_bf16 v[8:11], a[8:11], a[224:227], v[8:11]
v_mfma_f32_16x16x32_bf16 v[16:19], a[16:19], a[224:227], v[16:19]
ds_read_b128 a[8:11], v224 offset:43008
s_waitcnt lgkmcnt(4)
v_mfma_f32_16x16x32_bf16 v[16:19], a[20:23], a[232:235], v[16:19]
v_mfma_f32_16x16x32_bf16 v[20:23], a[20:23], a[236:239], v[20:23]
ds_read_b128 a[12:15], v224 offset:44032
v_mfma_f32_16x16x32_bf16 v[20:23], a[16:19], a[228:231], v[20:23]
buffer_load_dwordx4 a[84:87], v224, s[20:23], s11 offen offset:2048 sc1
v_mfma_f32_16x16x32_bf16 v[28:31], a[24:27], a[228:231], v[28:31]
ds_read_b128 a[16:19], v224 offset:45056
s_waitcnt lgkmcnt(4)
v_mfma_f32_16x16x32_bf16 v[28:31], a[28:31], a[236:239], v[28:31]
v_mfma_f32_16x16x32_bf16 v[24:27], a[28:31], a[232:235], v[24:27]
ds_read_b128 a[20:23], v224 offset:46080
v_mfma_f32_16x16x32_bf16 v[24:27], a[24:27], a[224:227], v[24:27]
buffer_load_dwordx4 a[88:91], v224, s[20:23], s10 offen offset:3072 sc1
v_mfma_f32_16x16x32_bf16 v[112:115], a[0:3], a[224:227], v[112:115]
ds_read_b128 a[24:27], v224 offset:47104
s_waitcnt lgkmcnt(4)
v_mfma_f32_16x16x32_bf16 v[112:115], a[4:7], a[232:235], v[112:115]
s_waitcnt vmcnt(26)
s_barrier
v_mfma_f32_16x16x32_bf16 v[116:119], a[4:7], a[236:239], v[116:119]
ds_read_b128 a[28:31], v224 offset:48128
v_mfma_f32_16x16x32_bf16 v[116:119], a[0:3], a[228:231], v[116:119]
buffer_load_dwordx4 a[92:95], v224, s[20:23], s11 offen offset:3072 sc1
v_mfma_f32_16x16x32_bf16 v[124:127], a[8:11], a[228:231], v[124:127]
ds_read_b128 a[0:3], v224 offset:49152
s_waitcnt lgkmcnt(4)
v_mfma_f32_16x16x32_bf16 v[124:127], a[12:15], a[236:239], v[124:127]
v_mfma_f32_16x16x32_bf16 v[120:123], a[12:15], a[232:235], v[120:123]
ds_read_b128 a[4:7], v224 offset:50176
v_mfma_f32_16x16x32_bf16 v[120:123], a[8:11], a[224:227], v[120:123]
s_add_u32 s10, s40, 53248
v_mfma_f32_16x16x32_bf16 v[128:131], a[16:19], a[224:227], v[128:131]
buffer_load_dwordx4 v[80:83], v224, s[20:23], s10 offen offset:0 sc1
s_waitcnt lgkmcnt(3)
v_mfma_f32_16x16x32_bf16 v[128:131], a[20:23], a[232:235], v[128:131]
ds_read_b128 a[8:11], v224 offset:51200
v_mfma_f32_16x16x32_bf16 v[132:135], a[20:23], a[236:239], v[132:135]
ds_read_b128 a[12:15], v224 offset:52224
v_mfma_f32_16x16x32_bf16 v[132:135], a[16:19], a[228:231], v[132:135]
v_mfma_f32_16x16x32_bf16 v[140:143], a[24:27], a[228:231], v[140:143]
ds_read_b128 a[16:19], v224 offset:53248
s_waitcnt lgkmcnt(4)
v_mfma_f32_16x16x32_bf16 v[140:143], a[28:31], a[236:239], v[140:143]
s_add_u32 s11, s40, 167936
v_mfma_f32_16x16x32_bf16 v[136:139], a[28:31], a[232:235], v[136:139]
buffer_load_dwordx4 v[84:87], v224, s[20:23], s11 offen offset:0 sc1
v_mfma_f32_16x16x32_bf16 v[136:139], a[24:27], a[224:227], v[136:139]
ds_read_b128 a[20:23], v224 offset:54272
v_mfma_f32_16x16x32_bf16 v[0:3], a[0:3], a[240:243], v[0:3]
ds_read_b128 a[24:27], v224 offset:55296
s_waitcnt vmcnt(26) lgkmcnt(4)
v_mfma_f32_16x16x32_bf16 v[0:3], a[4:7], a[248:251], v[0:3]
buffer_load_dwordx4 v[88:91], v224, s[20:23], s10 offen offset:1024 sc1
v_mfma_f32_16x16x32_bf16 v[4:7], a[4:7], a[252:255], v[4:7]
ds_read_b128 a[28:31], v224 offset:56320
v_mfma_f32_16x16x32_bf16 v[4:7], a[0:3], a[244:247], v[4:7]
v_mfma_f32_16x16x32_bf16 v[12:15], a[8:11], a[244:247], v[12:15]
ds_read_b128 a[0:3], v224 offset:57344
s_waitcnt lgkmcnt(4)
v_mfma_f32_16x16x32_bf16 v[12:15], a[12:15], a[252:255], v[12:15]
buffer_load_dwordx4 v[92:95], v224, s[20:23], s11 offen offset:1024 sc1
v_mfma_f32_16x16x32_bf16 v[8:11], a[12:15], a[248:251], v[8:11]
ds_read_b128 a[4:7], v224 offset:58368
v_mfma_f32_16x16x32_bf16 v[8:11], a[8:11], a[240:243], v[8:11]
v_mfma_f32_16x16x32_bf16 v[16:19], a[16:19], a[240:243], v[16:19]
ds_read_b128 a[8:11], v224 offset:59392
s_waitcnt lgkmcnt(4)
v_mfma_f32_16x16x32_bf16 v[16:19], a[20:23], a[248:251], v[16:19]
buffer_load_dwordx4 v[192:195], v224, s[20:23], s10 offen offset:2048 sc1
v_mfma_f32_16x16x32_bf16 v[20:23], a[20:23], a[252:255], v[20:23]
ds_read_b128 a[12:15], v224 offset:60416
v_mfma_f32_16x16x32_bf16 v[20:23], a[16:19], a[244:247], v[20:23]
v_mfma_f32_16x16x32_bf16 v[28:31], a[24:27], a[244:247], v[28:31]
ds_read_b128 a[16:19], v224 offset:61440
s_waitcnt lgkmcnt(4)
v_mfma_f32_16x16x32_bf16 v[28:31], a[28:31], a[252:255], v[28:31]
buffer_load_dwordx4 v[196:199], v224, s[20:23], s11 offen offset:2048 sc1
v_mfma_f32_16x16x32_bf16 v[24:27], a[28:31], a[248:251], v[24:27]
ds_read_b128 a[20:23], v224 offset:62464
v_mfma_f32_16x16x32_bf16 v[24:27], a[24:27], a[240:243], v[24:27]
v_mfma_f32_16x16x32_bf16 v[112:115], a[0:3], a[240:243], v[112:115]
ds_read_b128 a[24:27], v224 offset:63488
s_waitcnt lgkmcnt(4)
v_mfma_f32_16x16x32_bf16 v[112:115], a[4:7], a[248:251], v[112:115]
s_waitcnt vmcnt(26)
s_barrier
v_mfma_f32_16x16x32_bf16 v[116:119], a[4:7], a[252:255], v[116:119]
ds_read_b128 a[28:31], v224 offset:64512
v_mfma_f32_16x16x32_bf16 v[116:119], a[0:3], a[244:247], v[116:119]
buffer_load_dwordx4 v[200:203], v224, s[20:23], s10 offen offset:3072 sc1
v_mfma_f32_16x16x32_bf16 v[124:127], a[8:11], a[244:247], v[124:127]
ds_read_b128 a[0:3], v225 offset:0
s_waitcnt lgkmcnt(4)
v_mfma_f32_16x16x32_bf16 v[124:127], a[12:15], a[252:255], v[124:127]
v_mfma_f32_16x16x32_bf16 v[120:123], a[12:15], a[248:251], v[120:123]
ds_read_b128 a[4:7], v225 offset:1024
v_mfma_f32_16x16x32_bf16 v[120:123], a[8:11], a[240:243], v[120:123]
buffer_load_dwordx4 v[204:207], v224, s[20:23], s11 offen offset:3072 sc1
v_mfma_f32_16x16x32_bf16 v[128:131], a[16:19], a[240:243], v[128:131]
ds_read_b128 a[8:11], v225 offset:2048
s_waitcnt lgkmcnt(4)
v_mfma_f32_16x16x32_bf16 v[128:131], a[20:23], a[248:251], v[128:131]
v_mfma_f32_16x16x32_bf16 v[132:135], a[20:23], a[252:255], v[132:135]
ds_read_b128 a[12:15], v225 offset:3072
s_add_u32 m0, s36, 98304
v_mfma_f32_16x16x32_bf16 v[132:135], a[16:19], a[244:247], v[132:135]
s_add_u32 s57, s38, 393216
v_mfma_f32_16x16x32_bf16 v[140:143], a[24:27], a[244:247], v[140:143]
buffer_load_dwordx4 v226, s[20:23], s57 offen offset:0 sc1 lds
s_waitcnt lgkmcnt(3)
v_mfma_f32_16x16x32_bf16 v[140:143], a[28:31], a[252:255], v[140:143]
ds_read_b128 a[16:19], v225 offset:4096
v_mfma_f32_16x16x32_bf16 v[136:139], a[28:31], a[248:251], v[136:139]
ds_read_b128 a[20:23], v225 offset:5120
v_mfma_f32_16x16x32_bf16 v[136:139], a[24:27], a[240:243], v[136:139]
buffer_load_dwordx4 v226, s[20:23], s57 offen offset:1024 sc1 lds
s_waitcnt vmcnt(28)
v_mfma_f32_16x16x32_bf16 v[0:3], a[0:3], a[32:35], v[0:3]
ds_read_b128 a[24:27], v225 offset:6144
s_waitcnt vmcnt(26) lgkmcnt(4)
v_mfma_f32_16x16x32_bf16 v[0:3], a[4:7], a[40:43], v[0:3]
v_mfma_f32_16x16x32_bf16 v[4:7], a[4:7], a[44:47], v[4:7]
ds_read_b128 a[28:31], v225 offset:7168
v_mfma_f32_16x16x32_bf16 v[4:7], a[0:3], a[36:39], v[4:7]
v_mfma_f32_16x16x32_bf16 v[12:15], a[8:11], a[36:39], v[12:15]
ds_read_b128 a[0:3], v225 offset:8192
s_waitcnt lgkmcnt(4)
v_mfma_f32_16x16x32_bf16 v[12:15], a[12:15], a[44:47], v[12:15]
buffer_load_dwordx4 v226, s[20:23], s57 offen offset:2048 sc1 lds
v_mfma_f32_16x16x32_bf16 v[8:11], a[12:15], a[40:43], v[8:11]
ds_read_b128 a[4:7], v225 offset:9216
v_mfma_f32_16x16x32_bf16 v[8:11], a[8:11], a[32:35], v[8:11]
s_waitcnt vmcnt(25)
v_mfma_f32_16x16x32_bf16 v[0:3], a[16:19], a[48:51], v[0:3]
ds_read_b128 a[8:11], v225 offset:10240
s_waitcnt vmcnt(23) lgkmcnt(4)
v_mfma_f32_16x16x32_bf16 v[0:3], a[20:23], a[56:59], v[0:3]
buffer_load_dwordx4 v226, s[20:23], s57 offen offset:3072 sc1 lds
v_mfma_f32_16x16x32_bf16 v[4:7], a[20:23], a[60:63], v[4:7]
ds_read_b128 a[12:15], v225 offset:11264
v_mfma_f32_16x16x32_bf16 v[4:7], a[16:19], a[52:55], v[4:7]
v_mfma_f32_16x16x32_bf16 v[12:15], a[24:27], a[52:55], v[12:15]
ds_read_b128 a[16:19], v225 offset:12288
s_add_u32 m0, s36, 114688
s_waitcnt lgkmcnt(4)
v_mfma_f32_16x16x32_bf16 v[12:15], a[28:31], a[60:63], v[12:15]
s_add_u32 s57, s38, 409600
v_mfma_f32_16x16x32_bf16 v[8:11], a[28:31], a[56:59], v[8:11]
buffer_load_dwordx4 v226, s[20:23], s57 offen offset:0 sc1 lds
v_mfma_f32_16x16x32_bf16 v[8:11], a[24:27], a[48:51], v[8:11]
ds_read_b128 a[20:23], v225 offset:13312
s_waitcnt vmcnt(23)
v_mfma_f32_16x16x32_bf16 v[0:3], a[0:3], a[64:67], v[0:3]
ds_read_b128 a[24:27], v225 offset:14336
s_waitcnt vmcnt(21) lgkmcnt(4)
v_mfma_f32_16x16x32_bf16 v[0:3], a[4:7], a[72:75], v[0:3]
buffer_load_dwordx4 v226, s[20:23], s57 offen offset:1024 sc1 lds
s_waitcnt vmcnt(18)
s_barrier
v_mfma_f32_16x16x32_bf16 v[4:7], a[4:7], a[76:79], v[4:7]
ds_read_b128 a[28:31], v225 offset:15360
v_mfma_f32_16x16x32_bf16 v[4:7], a[0:3], a[68:71], v[4:7]
v_mfma_f32_16x16x32_bf16 v[12:15], a[8:11], a[68:71], v[12:15]
ds_read_b128 a[0:3], v225 offset:16384
s_waitcnt lgkmcnt(4)
v_mfma_f32_16x16x32_bf16 v[12:15], a[12:15], a[76:79], v[12:15]
buffer_load_dwordx4 v226, s[20:23], s57 offen offset:2048 sc1 lds
v_mfma_f32_16x16x32_bf16 v[8:11], a[12:15], a[72:75], v[8:11]
ds_read_b128 a[4:7], v225 offset:17408
v_mfma_f32_16x16x32_bf16 v[8:11], a[8:11], a[64:67], v[8:11]
s_waitcnt vmcnt(17)
v_mfma_f32_16x16x32_bf16 v[0:3], a[16:19], a[80:83], v[0:3]
ds_read_b128 a[8:11], v225 offset:18432
s_waitcnt vmcnt(15) lgkmcnt(4)
v_mfma_f32_16x16x32_bf16 v[0:3], a[20:23], a[88:91], v[0:3]
v_mfma_f32_16x16x32_bf16 v[4:7], a[20:23], a[92:95], v[4:7]
ds_read_b128 a[12:15], v225 offset:19456
v_mfma_f32_16x16x32_bf16 v[4:7], a[16:19], a[84:87], v[4:7]
buffer_load_dwordx4 v226, s[20:23], s57 offen offset:3072 sc1 lds
v_mfma_f32_16x16x32_bf16 v[12:15], a[24:27], a[84:87], v[12:15]
ds_read_b128 a[16:19], v225 offset:20480
s_waitcnt lgkmcnt(4)
v_mfma_f32_16x16x32_bf16 v[12:15], a[28:31], a[92:95], v[12:15]
v_mfma_f32_16x16x32_bf16 v[8:11], a[28:31], a[88:91], v[8:11]
ds_read_b128 a[20:23], v225 offset:21504
s_add_u32 m0, s36, 0
v_mfma_f32_16x16x32_bf16 v[8:11], a[24:27], a[80:83], v[8:11]
s_add_u32 s57, s38, 425984
s_waitcnt vmcnt(14)
v_mfma_f32_16x16x32_bf16 v[0:3], a[0:3], v[80:83], v[0:3]
buffer_load_dwordx4 v226, s[20:23], s57 offen offset:0 sc1 lds
s_waitcnt vmcnt(13) lgkmcnt(3)
v_mfma_f32_16x16x32_bf16 v[0:3], a[4:7], v[88:91], v[0:3]
ds_read_b128 a[24:27], v225 offset:22528
v_mfma_f32_16x16x32_bf16 v[4:7], a[4:7], v[92:95], v[4:7]
ds_read_b128 a[28:31], v225 offset:23552
v_mfma_f32_16x16x32_bf16 v[4:7], a[0:3], v[84:87], v[4:7]
buffer_load_dwordx4 v226, s[20:23], s57 offen offset:1024 sc1 lds
v_mfma_f32_16x16x32_bf16 v[12:15], a[8:11], v[84:87], v[12:15]
ds_read_b128 a[0:3], v225 offset:24576
s_waitcnt lgkmcnt(4)
v_mfma_f32_16x16x32_bf16 v[12:15], a[12:15], v[92:95], v[12:15]
v_mfma_f32_16x16x32_bf16 v[8:11], a[12:15], v[88:91], v[8:11]
ds_read_b128 a[4:7], v225 offset:25600
v_mfma_f32_16x16x32_bf16 v[8:11], a[8:11], v[80:83], v[8:11]
buffer_load_dwordx4 v226, s[20:23], s57 offen offset:2048 sc1 lds
s_waitcnt vmcnt(13)
v_mfma_f32_16x16x32_bf16 v[0:3], a[16:19], v[192:195], v[0:3]
ds_read_b128 a[8:11], v225 offset:26624
s_waitcnt vmcnt(11) lgkmcnt(4)
v_mfma_f32_16x16x32_bf16 v[0:3], a[20:23], v[200:203], v[0:3]
v_mfma_f32_16x16x32_bf16 v[4:7], a[20:23], v[204:207], v[4:7]
ds_read_b128 a[12:15], v225 offset:27648
v_mfma_f32_16x16x32_bf16 v[4:7], a[16:19], v[196:199], v[4:7]
v_mfma_f32_16x16x32_bf16 v[12:15], a[24:27], v[196:199], v[12:15]
ds_read_b128 a[16:19], v225 offset:28672
s_waitcnt lgkmcnt(4)
v_mfma_f32_16x16x32_bf16 v[12:15], a[28:31], v[204:207], v[12:15]
buffer_load_dwordx4 v226, s[20:23], s57 offen offset:3072 sc1 lds
v_mfma_f32_16x16x32_bf16 v[8:11], a[28:31], v[200:203], v[8:11]
ds_read_b128 a[20:23], v225 offset:29696
v_mfma_f32_16x16x32_bf16 v[8:11], a[24:27], v[192:195], v[8:11]
v_mfma_f32_16x16x32_bf16 v[16:19], a[0:3], a[32:35], v[16:19]
ds_read_b128 a[24:27], v225 offset:30720
s_add_u32 m0, s36, 16384
s_waitcnt lgkmcnt(4)
v_mfma_f32_16x16x32_bf16 v[16:19], a[4:7], a[40:43], v[16:19]
s_add_u32 s57, s38, 442368
s_waitcnt vmcnt(8)
s_barrier
v_mfma_f32_16x16x32_bf16 v[20:23], a[4:7], a[44:47], v[20:23]
buffer_load_dwordx4 v226, s[20:23], s57 offen offset:0 sc1 lds
v_mfma_f32_16x16x32_bf16 v[20:23], a[0:3], a[36:39], v[20:23]
ds_read_b128 a[28:31], v225 offset:31744
v_mfma_f32_16x16x32_bf16 v[28:31], a[8:11], a[36:39], v[28:31]
ds_read_b128 a[0:3], v225 offset:32768
s_waitcnt lgkmcnt(4)
v_mfma_f32_16x16x32_bf16 v[28:31], a[12:15], a[44:47], v[28:31]
buffer_load_dwordx4 v226, s[20:23], s57 offen offset:1024 sc1 lds
v_mfma_f32_16x16x32_bf16 v[24:27], a[12:15], a[40:43], v[24:27]
ds_read_b128 a[4:7], v225 offset:33792
v_mfma_f32_16x16x32_bf16 v[24:27], a[8:11], a[32:35], v[24:27]
v_mfma_f32_16x16x32_bf16 v[16:19], a[16:19], a[48:51], v[16:19]
ds_read_b128 a[8:11], v225 offset:34816
v_cvt_pk_bf16_f32 v0, v0, v1
s_waitcnt lgkmcnt(4)
v_mfma_f32_16x16x32_bf16 v[16:19], a[20:23], a[56:59], v[16:19]
buffer_load_dwordx4 v226, s[20:23], s57 offen offset:2048 sc1 lds
v_cvt_pk_bf16_f32 v1, v2, v3
v_mfma_f32_16x16x32_bf16 v[20:23], a[20:23], a[60:63], v[20:23]
ds_read_b128 a[12:15], v225 offset:35840
v_cvt_pk_bf16_f32 v2, v8, v9
v_cvt_pk_bf16_f32 v3, v10, v11
v_mfma_f32_16x16x32_bf16 v[20:23], a[16:19], a[52:55], v[20:23]
s_add_u32 s16, s42, 0
buffer_store_dwordx4 v[0:3], v224, s[20:23], s16 offen sc1
v_mfma_f32_16x16x32_bf16 v[28:31], a[24:27], a[52:55], v[28:31]
ds_read_b128 a[16:19], v225 offset:36864
v_cvt_pk_bf16_f32 v4, v4, v5
s_waitcnt lgkmcnt(4)
v_mfma_f32_16x16x32_bf16 v[28:31], a[28:31], a[60:63], v[28:31]
buffer_load_dwordx4 v226, s[20:23], s57 offen offset:3072 sc1 lds
v_cvt_pk_bf16_f32 v5, v6, v7
v_mfma_f32_16x16x32_bf16 v[24:27], a[28:31], a[56:59], v[24:27]
ds_read_b128 a[20:23], v225 offset:37888
v_cvt_pk_bf16_f32 v6, v12, v13
v_cvt_pk_bf16_f32 v7, v14, v15
v_mfma_f32_16x16x32_bf16 v[24:27], a[24:27], a[48:51], v[24:27]
s_add_u32 s16, s42, 8192
buffer_store_dwordx4 v[4:7], v224, s[20:23], s16 offen sc1
v_mfma_f32_16x16x32_bf16 v[16:19], a[0:3], a[64:67], v[16:19]
ds_read_b128 a[24:27], v225 offset:38912
s_waitcnt lgkmcnt(4)
v_mfma_f32_16x16x32_bf16 v[16:19], a[4:7], a[72:75], v[16:19]
v_mfma_f32_16x16x32_bf16 v[20:23], a[4:7], a[76:79], v[20:23]
ds_read_b128 a[28:31], v225 offset:39936
v_mfma_f32_16x16x32_bf16 v[20:23], a[0:3], a[68:71], v[20:23]
v_mfma_f32_16x16x32_bf16 v[28:31], a[8:11], a[68:71], v[28:31]
ds_read_b128 a[0:3], v225 offset:40960
s_waitcnt lgkmcnt(4)
v_mfma_f32_16x16x32_bf16 v[28:31], a[12:15], a[76:79], v[28:31]
v_mfma_f32_16x16x32_bf16 v[24:27], a[12:15], a[72:75], v[24:27]
ds_read_b128 a[4:7], v225 offset:41984
v_mfma_f32_16x16x32_bf16 v[24:27], a[8:11], a[64:67], v[24:27]
v_mfma_f32_16x16x32_bf16 v[16:19], a[16:19], a[80:83], v[16:19]
ds_read_b128 a[8:11], v225 offset:43008
s_waitcnt lgkmcnt(4)
v_mfma_f32_16x16x32_bf16 v[16:19], a[20:23], a[88:91], v[16:19]
v_mfma_f32_16x16x32_bf16 v[20:23], a[20:23], a[92:95], v[20:23]
ds_read_b128 a[12:15], v225 offset:44032
v_mfma_f32_16x16x32_bf16 v[20:23], a[16:19], a[84:87], v[20:23]
v_mfma_f32_16x16x32_bf16 v[28:31], a[24:27], a[84:87], v[28:31]
ds_read_b128 a[16:19], v225 offset:45056
s_waitcnt lgkmcnt(4)
v_mfma_f32_16x16x32_bf16 v[28:31], a[28:31], a[92:95], v[28:31]
v_mfma_f32_16x16x32_bf16 v[24:27], a[28:31], a[88:91], v[24:27]
ds_read_b128 a[20:23], v225 offset:46080
v_mfma_f32_16x16x32_bf16 v[24:27], a[24:27], a[80:83], v[24:27]
v_mfma_f32_16x16x32_bf16 v[16:19], a[0:3], v[80:83], v[16:19]
ds_read_b128 a[24:27], v225 offset:47104
s_waitcnt lgkmcnt(4)
v_mfma_f32_16x16x32_bf16 v[16:19], a[4:7], v[88:91], v[16:19]
s_waitcnt vmcnt(10)
s_barrier
v_mfma_f32_16x16x32_bf16 v[20:23], a[4:7], v[92:95], v[20:23]
ds_read_b128 a[28:31], v225 offset:48128
v_mfma_f32_16x16x32_bf16 v[20:23], a[0:3], v[84:87], v[20:23]
v_mfma_f32_16x16x32_bf16 v[28:31], a[8:11], v[84:87], v[28:31]
ds_read_b128 a[0:3], v225 offset:49152
s_waitcnt lgkmcnt(4)
v_mfma_f32_16x16x32_bf16 v[28:31], a[12:15], v[92:95], v[28:31]
v_mfma_f32_16x16x32_bf16 v[24:27], a[12:15], v[88:91], v[24:27]
ds_read_b128 a[4:7], v225 offset:50176
v_mfma_f32_16x16x32_bf16 v[24:27], a[8:11], v[80:83], v[24:27]
v_mfma_f32_16x16x32_bf16 v[16:19], a[16:19], v[192:195], v[16:19]
ds_read_b128 a[8:11], v225 offset:51200
s_waitcnt lgkmcnt(4)
v_mfma_f32_16x16x32_bf16 v[16:19], a[20:23], v[200:203], v[16:19]
v_mfma_f32_16x16x32_bf16 v[20:23], a[20:23], v[204:207], v[20:23]
ds_read_b128 a[12:15], v225 offset:52224
v_mfma_f32_16x16x32_bf16 v[20:23], a[16:19], v[196:199], v[20:23]
v_mfma_f32_16x16x32_bf16 v[28:31], a[24:27], v[196:199], v[28:31]
ds_read_b128 a[16:19], v225 offset:53248
s_waitcnt lgkmcnt(4)
v_mfma_f32_16x16x32_bf16 v[28:31], a[28:31], v[204:207], v[28:31]
v_mfma_f32_16x16x32_bf16 v[24:27], a[28:31], v[200:203], v[24:27]
ds_read_b128 a[20:23], v225 offset:54272
v_mfma_f32_16x16x32_bf16 v[24:27], a[24:27], v[192:195], v[24:27]
v_mfma_f32_16x16x32_bf16 v[112:115], a[0:3], a[32:35], v[112:115]
ds_read_b128 a[24:27], v225 offset:55296
s_waitcnt lgkmcnt(4)
v_mfma_f32_16x16x32_bf16 v[112:115], a[4:7], a[40:43], v[112:115]
v_mfma_f32_16x16x32_bf16 v[116:119], a[4:7], a[44:47], v[116:119]
ds_read_b128 a[28:31], v225 offset:56320
v_mfma_f32_16x16x32_bf16 v[116:119], a[0:3], a[36:39], v[116:119]
v_mfma_f32_16x16x32_bf16 v[124:127], a[8:11], a[36:39], v[124:127]
ds_read_b128 a[0:3], v225 offset:57344
s_waitcnt lgkmcnt(4)
v_mfma_f32_16x16x32_bf16 v[124:127], a[12:15], a[44:47], v[124:127]
v_mfma_f32_16x16x32_bf16 v[120:123], a[12:15], a[40:43], v[120:123]
ds_read_b128 a[4:7], v225 offset:58368
v_mfma_f32_16x16x32_bf16 v[120:123], a[8:11], a[32:35], v[120:123]
v_mfma_f32_16x16x32_bf16 v[112:115], a[16:19], a[48:51], v[112:115]
ds_read_b128 a[8:11], v225 offset:59392
v_cvt_pk_bf16_f32 v16, v16, v17
s_waitcnt lgkmcnt(4)
v_mfma_f32_16x16x32_bf16 v[112:115], a[20:23], a[56:59], v[112:115]
v_cvt_pk_bf16_f32 v17, v18, v19
v_cvt_pk_bf16_f32 v18, v24, v25
v_cvt_pk_bf16_f32 v19, v26, v27
v_mfma_f32_16x16x32_bf16 v[116:119], a[20:23], a[60:63], v[116:119]
ds_read_b128 a[12:15], v225 offset:60416
s_add_u32 s16, s42, 1048576
v_mfma_f32_16x16x32_bf16 v[116:119], a[16:19], a[52:55], v[116:119]
buffer_store_dwordx4 v[16:19], v224, s[20:23], s16 offen sc1
v_cvt_pk_bf16_f32 v20, v20, v21
v_mfma_f32_16x16x32_bf16 v[124:127], a[24:27], a[52:55], v[124:127]
ds_read_b128 a[16:19], v225 offset:61440
v_cvt_pk_bf16_f32 v21, v22, v23
s_waitcnt lgkmcnt(4)
v_mfma_f32_16x16x32_bf16 v[124:127], a[28:31], a[60:63], v[124:127]
v_cvt_pk_bf16_f32 v22, v28, v29
v_cvt_pk_bf16_f32 v23, v30, v31
s_add_u32 s16, s42, 1056768
v_mfma_f32_16x16x32_bf16 v[120:123], a[28:31], a[56:59], v[120:123]
ds_read_b128 a[20:23], v225 offset:62464
buffer_store_dwordx4 v[20:23], v224, s[20:23], s16 offen sc1
v_mfma_f32_16x16x32_bf16 v[120:123], a[24:27], a[48:51], v[120:123]
v_mfma_f32_16x16x32_bf16 v[112:115], a[0:3], a[64:67], v[112:115]
ds_read_b128 a[24:27], v225 offset:63488
s_waitcnt lgkmcnt(4)
v_mfma_f32_16x16x32_bf16 v[112:115], a[4:7], a[72:75], v[112:115]
s_waitcnt vmcnt(8)
s_barrier
v_mfma_f32_16x16x32_bf16 v[116:119], a[4:7], a[76:79], v[116:119]
ds_read_b128 a[28:31], v225 offset:64512
v_mfma_f32_16x16x32_bf16 v[116:119], a[0:3], a[68:71], v[116:119]
v_mfma_f32_16x16x32_bf16 v[124:127], a[8:11], a[68:71], v[124:127]
ds_read_b128 a[0:3], v224 offset:0
s_waitcnt lgkmcnt(4)
v_mfma_f32_16x16x32_bf16 v[124:127], a[12:15], a[76:79], v[124:127]
v_mfma_f32_16x16x32_bf16 v[120:123], a[12:15], a[72:75], v[120:123]
ds_read_b128 a[4:7], v224 offset:1024
v_mfma_f32_16x16x32_bf16 v[120:123], a[8:11], a[64:67], v[120:123]
v_mfma_f32_16x16x32_bf16 v[112:115], a[16:19], a[80:83], v[112:115]
ds_read_b128 a[8:11], v224 offset:2048
s_waitcnt lgkmcnt(4)
v_mfma_f32_16x16x32_bf16 v[112:115], a[20:23], a[88:91], v[112:115]
v_mfma_f32_16x16x32_bf16 v[116:119], a[20:23], a[92:95], v[116:119]
ds_read_b128 a[12:15], v224 offset:3072
v_mfma_f32_16x16x32_bf16 v[116:119], a[16:19], a[84:87], v[116:119]
v_mfma_f32_16x16x32_bf16 v[124:127], a[24:27], a[84:87], v[124:127]
ds_read_b128 a[16:19], v224 offset:4096
s_waitcnt lgkmcnt(4)
v_mfma_f32_16x16x32_bf16 v[124:127], a[28:31], a[92:95], v[124:127]
v_mfma_f32_16x16x32_bf16 v[120:123], a[28:31], a[88:91], v[120:123]
ds_read_b128 a[20:23], v224 offset:5120
v_mfma_f32_16x16x32_bf16 v[120:123], a[24:27], a[80:83], v[120:123]
v_mfma_f32_16x16x32_bf16 v[112:115], a[0:3], v[80:83], v[112:115]
ds_read_b128 a[24:27], v224 offset:6144
s_waitcnt lgkmcnt(4)
v_mfma_f32_16x16x32_bf16 v[112:115], a[4:7], v[88:91], v[112:115]
v_mfma_f32_16x16x32_bf16 v[116:119], a[4:7], v[92:95], v[116:119]
ds_read_b128 a[28:31], v224 offset:7168
v_mfma_f32_16x16x32_bf16 v[116:119], a[0:3], v[84:87], v[116:119]
v_mfma_f32_16x16x32_bf16 v[124:127], a[8:11], v[84:87], v[124:127]
ds_read_b128 a[0:3], v224 offset:8192
s_waitcnt lgkmcnt(4)
v_mfma_f32_16x16x32_bf16 v[124:127], a[12:15], v[92:95], v[124:127]
v_mfma_f32_16x16x32_bf16 v[120:123], a[12:15], v[88:91], v[120:123]
ds_read_b128 a[4:7], v224 offset:9216
v_mfma_f32_16x16x32_bf16 v[120:123], a[8:11], v[80:83], v[120:123]
v_mfma_f32_16x16x32_bf16 v[112:115], a[16:19], v[192:195], v[112:115]
ds_read_b128 a[8:11], v224 offset:10240
s_waitcnt lgkmcnt(4)
v_mfma_f32_16x16x32_bf16 v[112:115], a[20:23], v[200:203], v[112:115]
v_mfma_f32_16x16x32_bf16 v[116:119], a[20:23], v[204:207], v[116:119]
ds_read_b128 a[12:15], v224 offset:11264
v_mfma_f32_16x16x32_bf16 v[116:119], a[16:19], v[196:199], v[116:119]
v_mfma_f32_16x16x32_bf16 v[124:127], a[24:27], v[196:199], v[124:127]
ds_read_b128 a[16:19], v224 offset:12288
s_waitcnt lgkmcnt(4)
v_mfma_f32_16x16x32_bf16 v[124:127], a[28:31], v[204:207], v[124:127]
v_mfma_f32_16x16x32_bf16 v[120:123], a[28:31], v[200:203], v[120:123]
ds_read_b128 a[20:23], v224 offset:13312
v_mfma_f32_16x16x32_bf16 v[120:123], a[24:27], v[192:195], v[120:123]
v_mfma_f32_16x16x32_bf16 v[128:131], a[0:3], a[32:35], v[128:131]
ds_read_b128 a[24:27], v224 offset:14336
s_waitcnt lgkmcnt(4)
v_mfma_f32_16x16x32_bf16 v[128:131], a[4:7], a[40:43], v[128:131]
s_waitcnt vmcnt(3)
s_barrier
v_mfma_f32_16x16x32_bf16 v[132:135], a[4:7], a[44:47], v[132:135]
ds_read_b128 a[28:31], v224 offset:15360
v_mfma_f32_16x16x32_bf16 v[132:135], a[0:3], a[36:39], v[132:135]
v_mfma_f32_16x16x32_bf16 v[140:143], a[8:11], a[36:39], v[140:143]
ds_read_b128 a[0:3], v224 offset:16384
s_waitcnt lgkmcnt(4)
v_mfma_f32_16x16x32_bf16 v[140:143], a[12:15], a[44:47], v[140:143]
v_mfma_f32_16x16x32_bf16 v[136:139], a[12:15], a[40:43], v[136:139]
ds_read_b128 a[4:7], v224 offset:17408
v_mfma_f32_16x16x32_bf16 v[136:139], a[8:11], a[32:35], v[136:139]
s_waitcnt vmcnt(0)
v_mfma_f32_16x16x32_bf16 v[128:131], a[16:19], a[48:51], v[128:131]
ds_read_b128 a[8:11], v224 offset:18432
v_cvt_pk_bf16_f32 v112, v112, v113
s_waitcnt lgkmcnt(4)
v_mfma_f32_16x16x32_bf16 v[128:131], a[20:23], a[56:59], v[128:131]
v_cvt_pk_bf16_f32 v113, v114, v115
v_cvt_pk_bf16_f32 v114, v120, v121
v_cvt_pk_bf16_f32 v115, v122, v123
v_mfma_f32_16x16x32_bf16 v[132:135], a[20:23], a[60:63], v[132:135]
ds_read_b128 a[12:15], v224 offset:19456
s_add_u32 s16, s42, 2097152
v_mfma_f32_16x16x32_bf16 v[132:135], a[16:19], a[52:55], v[132:135]
buffer_store_dwordx4 v[112:115], v224, s[20:23], s16 offen sc1
v_cvt_pk_bf16_f32 v116, v116, v117
v_mfma_f32_16x16x32_bf16 v[140:143], a[24:27], a[52:55], v[140:143]
ds_read_b128 a[16:19], v224 offset:20480
v_cvt_pk_bf16_f32 v117, v118, v119
s_waitcnt lgkmcnt(4)
v_mfma_f32_16x16x32_bf16 v[140:143], a[28:31], a[60:63], v[140:143]
v_cvt_pk_bf16_f32 v118, v124, v125
v_cvt_pk_bf16_f32 v119, v126, v127
s_add_u32 s16, s42, 2105344
v_mfma_f32_16x16x32_bf16 v[136:139], a[28:31], a[56:59], v[136:139]
ds_read_b128 a[20:23], v224 offset:21504
buffer_store_dwordx4 v[116:119], v224, s[20:23], s16 offen sc1
v_mfma_f32_16x16x32_bf16 v[136:139], a[24:27], a[48:51], v[136:139]
v_mfma_f32_16x16x32_bf16 v[128:131], a[0:3], a[64:67], v[128:131]
ds_read_b128 a[24:27], v224 offset:22528
s_waitcnt lgkmcnt(4)
v_mfma_f32_16x16x32_bf16 v[128:131], a[4:7], a[72:75], v[128:131]
L_ct5:
v_mfma_f32_16x16x32_bf16 v[132:135], a[4:7], a[76:79], v[132:135]
ds_read_b128 a[28:31], v224 offset:23552
v_mfma_f32_16x16x32_bf16 v[132:135], a[0:3], a[68:71], v[132:135]
v_mfma_f32_16x16x32_bf16 v[140:143], a[8:11], a[68:71], v[140:143]
ds_read_b128 a[0:3], v224 offset:24576
s_waitcnt lgkmcnt(4)
v_mfma_f32_16x16x32_bf16 v[140:143], a[12:15], a[76:79], v[140:143]
v_mfma_f32_16x16x32_bf16 v[136:139], a[12:15], a[72:75], v[136:139]
ds_read_b128 a[4:7], v224 offset:25600
v_mfma_f32_16x16x32_bf16 v[136:139], a[8:11], a[64:67], v[136:139]
v_mfma_f32_16x16x32_bf16 v[128:131], a[16:19], a[80:83], v[128:131]
ds_read_b128 a[8:11], v224 offset:26624
s_waitcnt lgkmcnt(4)
v_mfma_f32_16x16x32_bf16 v[128:131], a[20:23], a[88:91], v[128:131]
v_mfma_f32_16x16x32_bf16 v[132:135], a[20:23], a[92:95], v[132:135]
ds_read_b128 a[12:15], v224 offset:27648
v_mfma_f32_16x16x32_bf16 v[132:135], a[16:19], a[84:87], v[132:135]
v_mfma_f32_16x16x32_bf16 v[140:143], a[24:27], a[84:87], v[140:143]
ds_read_b128 a[16:19], v224 offset:28672
s_waitcnt lgkmcnt(4)
v_mfma_f32_16x16x32_bf16 v[140:143], a[28:31], a[92:95], v[140:143]
v_mfma_f32_16x16x32_bf16 v[136:139], a[28:31], a[88:91], v[136:139]
ds_read_b128 a[20:23], v224 offset:29696
v_mfma_f32_16x16x32_bf16 v[136:139], a[24:27], a[80:83], v[136:139]
v_mfma_f32_16x16x32_bf16 v[128:131], a[0:3], v[80:83], v[128:131]
ds_read_b128 a[24:27], v224 offset:30720
s_waitcnt lgkmcnt(4)
v_mfma_f32_16x16x32_bf16 v[128:131], a[4:7], v[88:91], v[128:131]
v_mfma_f32_16x16x32_bf16 v[132:135], a[4:7], v[92:95], v[132:135]
ds_read_b128 a[28:31], v224 offset:31744
v_mfma_f32_16x16x32_bf16 v[132:135], a[0:3], v[84:87], v[132:135]
v_mfma_f32_16x16x32_bf16 v[140:143], a[8:11], v[84:87], v[140:143]
s_waitcnt lgkmcnt(3)
v_mfma_f32_16x16x32_bf16 v[140:143], a[12:15], v[92:95], v[140:143]
v_mfma_f32_16x16x32_bf16 v[136:139], a[12:15], v[88:91], v[136:139]
v_mfma_f32_16x16x32_bf16 v[136:139], a[8:11], v[80:83], v[136:139]
v_mfma_f32_16x16x32_bf16 v[128:131], a[16:19], v[192:195], v[128:131]
s_waitcnt lgkmcnt(2)
v_mfma_f32_16x16x32_bf16 v[128:131], a[20:23], v[200:203], v[128:131]
v_mfma_f32_16x16x32_bf16 v[132:135], a[20:23], v[204:207], v[132:135]
v_mfma_f32_16x16x32_bf16 v[132:135], a[16:19], v[196:199], v[132:135]
s_waitcnt lgkmcnt(1)
v_mfma_f32_16x16x32_bf16 v[140:143], a[24:27], v[196:199], v[140:143]
s_waitcnt lgkmcnt(0)
v_mfma_f32_16x16x32_bf16 v[140:143], a[28:31], v[204:207], v[140:143]
v_mfma_f32_16x16x32_bf16 v[136:139], a[28:31], v[200:203], v[136:139]
v_mfma_f32_16x16x32_bf16 v[136:139], a[24:27], v[192:195], v[136:139]
v_cvt_pk_bf16_f32 v128, v128, v129
v_cvt_pk_bf16_f32 v129, v130, v131
s_nop 5
v_cvt_pk_bf16_f32 v130, v136, v137
v_cvt_pk_bf16_f32 v131, v138, v139
s_add_u32 s16, s42, 3145728
buffer_store_dwordx4 v[128:131], v224, s[20:23], s16 offen sc1
v_cvt_pk_bf16_f32 v132, v132, v133
v_cvt_pk_bf16_f32 v133, v134, v135
v_cvt_pk_bf16_f32 v134, v140, v141
v_cvt_pk_bf16_f32 v135, v142, v143
s_add_u32 s16, s42, 3153920
buffer_store_dwordx4 v[132:135], v224, s[20:23], s16 offen sc1
s_lshl_b32 s15, s3, 23
s_add_u32 s15, s15, s88
v_lshrrev_b32 v250, 12, v233
v_and_b32 v251, 0x3ff, v233
v_lshl_add_u32 v251, v250, 10, v251
s_add_u32 s50, s50, 0x20000
s_mov_b32 s58, 524288
s_add_u32 s16, s15, 90177536
buffer_load_dwordx4 v[208:211], v251, s[20:23], s16 offen sc1
s_add_u32 s16, s15, 94371840
buffer_load_dwordx4 v[212:215], v251, s[20:23], s16 offen sc1
v_and_b32 v6, 7, v230
v_bfe_u32 v5, v230, 3, 2
v_lshrrev_b32 v7, 5, v230
v_lshl_add_u32 v7, v7, 4, v5
v_lshlrev_b32 v0, 3, v6
v_lshl_add_u32 v0, v7, 7, v0
v_lshlrev_b32 v4, 11, v6
v_lshl_add_u32 v4, v7, 4, v4
v_lshrrev_b32 v1, 6, v230
v_lshlrev_b32 v1, 3, v1
v_lshl_add_u32 v1, v6, 5, v1
v_bfe_u32 v7, v230, 4, 1
v_lshl_add_u32 v1, v7, 2, v1
v_add_u32 v1, 130560, v1
v_lshlrev_b32 v2, 5, v6
v_add_u32 v2, 130560, v2
v_lshlrev_b32 v3, 4, v230
v_add_u32 v3, 131072, v3
ds_read_b128 v[8:11], v3 offset:16384
ds_read_b128 v[12:15], v3 offset:20480
ds_read_b128 v[16:19], v3 offset:24576
ds_read_b128 v[20:23], v3 offset:28672
ds_read_b128 v[24:27], v3 offset:0
ds_read_b128 v[28:31], v3 offset:4096
ds_read_b128 v[32:35], v3 offset:8192
ds_read_b128 v[36:39], v3 offset:12288
s_waitcnt lgkmcnt(0)
s_barrier
v_lshlrev_b32 v72, 16, v8
v_and_b32 v73, 0xffff0000, v8
v_lshlrev_b32 v74, 16, v9
v_and_b32 v75, 0xffff0000, v9
v_lshlrev_b32 v76, 16, v10
v_and_b32 v77, 0xffff0000, v10
v_lshlrev_b32 v78, 16, v11
v_and_b32 v79, 0xffff0000, v11
v_lshlrev_b32 v80, 16, v12
v_and_b32 v81, 0xffff0000, v12
v_lshlrev_b32 v82, 16, v13
v_and_b32 v83, 0xffff0000, v13
v_lshlrev_b32 v84, 16, v14
v_and_b32 v85, 0xffff0000, v14
v_lshlrev_b32 v86, 16, v15
v_and_b32 v87, 0xffff0000, v15
v_lshlrev_b32 v88, 16, v16
v_and_b32 v89, 0xffff0000, v16
v_lshlrev_b32 v90, 16, v17
v_and_b32 v91, 0xffff0000, v17
v_lshlrev_b32 v92, 16, v18
v_and_b32 v93, 0xffff0000, v18
v_lshlrev_b32 v94, 16, v19
v_and_b32 v95, 0xffff0000, v19
v_lshlrev_b32 v96, 16, v20
v_and_b32 v97, 0xffff0000, v20
v_lshlrev_b32 v98, 16, v21
v_and_b32 v99, 0xffff0000, v21
v_lshlrev_b32 v100, 16, v22
v_and_b32 v101, 0xffff0000, v22
v_lshlrev_b32 v102, 16, v23
v_and_b32 v103, 0xffff0000, v23
v_lshlrev_b32 v104, 16, v24
v_and_b32 v105, 0xffff0000, v24
v_lshlrev_b32 v106, 16, v25
v_and_b32 v107, 0xffff0000, v25
v_lshlrev_b32 v108, 16, v26
v_and_b32 v109, 0xffff0000, v26
v_lshlrev_b32 v110, 16, v27
v_and_b32 v111, 0xffff0000, v27
v_lshlrev_b32 v112, 16, v28
v_and_b32 v113, 0xffff0000, v28
v_lshlrev_b32 v114, 16, v29
v_and_b32 v115, 0xffff0000, v29
v_lshlrev_b32 v116, 16, v30
v_and_b32 v117, 0xffff0000, v30
v_lshlrev_b32 v118, 16, v31
v_and_b32 v119, 0xffff0000, v31
v_lshlrev_b32 v120, 16, v32
v_and_b32 v121, 0xffff0000, v32
v_lshlrev_b32 v122, 16, v33
v_and_b32 v123, 0xffff0000, v33
v_lshlrev_b32 v124, 16, v34
v_and_b32 v125, 0xffff0000, v34
v_lshlrev_b32 v126, 16, v35
v_and_b32 v127, 0xffff0000, v35
v_lshlrev_b32 v128, 16, v36
v_and_b32 v129, 0xffff0000, v36
v_lshlrev_b32 v130, 16, v37
v_and_b32 v131, 0xffff0000, v37
v_lshlrev_b32 v132, 16, v38
v_and_b32 v133, 0xffff0000, v38
v_lshlrev_b32 v134, 16, v39
v_and_b32 v135, 0xffff0000, v39
s_branch L_ppoll2_chk
L_ppoll2:
s_add_u32 s16, s15, 90177536
buffer_load_dwordx4 v[208:211], v251, s[20:23], s16 offen sc1
s_add_u32 s16, s15, 94371840
buffer_load_dwordx4 v[212:215], v251, s[20:23], s16 offen sc1
L_ppoll2_chk:
s_waitcnt vmcnt(0)
v_max_u32 v152, v208, v209
v_max3_u32 v152, v152, v210, v211
v_max3_u32 v152, v152, v212, v213
v_max3_u32 v152, v152, v214, v215
v_cmp_eq_u32 vcc, -1, v152
s_sub_u32 s58, s58, 1
s_cbranch_scc1 L_ppoll2_out
s_cbranch_vccnz L_ppoll2
L_ppoll2_out:
s_add_u32 s16, s15, 88080384
buffer_load_dwordx4 v[192:195], v251, s[20:23], s16 offen sc1
s_add_u32 s16, s15, 92274688
buffer_load_dwordx4 v[196:199], v251, s[20:23], s16 offen sc1
s_add_u32 s16, s15, 89128960
buffer_load_dwordx4 v[200:203], v251, s[20:23], s16 offen sc1
s_add_u32 s16, s15, 93323264
buffer_load_dwordx4 v[204:207], v251, s[20:23], s16 offen sc1
s_mov_b32 s58, 524288
s_add_u32 s16, s15, 91226112
buffer_load_dwordx4 v[216:219], v251, s[20:23], s16 offen sc1
s_add_u32 s16, s15, 95420416
buffer_load_dwordx4 v[220:223], v251, s[20:23], s16 offen sc1
v_lshlrev_b32 v40, 16, v208
v_and_b32 v41, 0xffff0000, v208
v_lshlrev_b32 v42, 16, v212
v_and_b32 v43, 0xffff0000, v212
v_lshlrev_b32 v44, 16, v209
v_and_b32 v45, 0xffff0000, v209
v_lshlrev_b32 v46, 16, v213
v_and_b32 v47, 0xffff0000, v213
v_lshlrev_b32 v48, 16, v210
v_and_b32 v49, 0xffff0000, v210
v_lshlrev_b32 v50, 16, v214
v_and_b32 v51, 0xffff0000, v214
v_lshlrev_b32 v52, 16, v211
v_and_b32 v53, 0xffff0000, v211
v_lshlrev_b32 v54, 16, v215
v_and_b32 v55, 0xffff0000, v215
v_pk_add_f32 v[40:41], v[40:41], v[42:43]
v_pk_add_f32 v[44:45], v[44:45], v[46:47]
v_pk_add_f32 v[48:49], v[48:49], v[50:51]
v_pk_add_f32 v[52:53], v[52:53], v[54:55]
v_pk_add_f32 v[88:89], v[88:89], v[40:41]
v_pk_add_f32 v[90:91], v[90:91], v[44:45]
v_pk_add_f32 v[92:93], v[92:93], v[48:49]
v_pk_add_f32 v[94:95], v[94:95], v[52:53]
v_cvt_pk_bf16_f32 v16, v88, v89
v_cvt_pk_bf16_f32 v17, v90, v91
v_cvt_pk_bf16_f32 v18, v92, v93
v_cvt_pk_bf16_f32 v19, v94, v95
v_lshlrev_b32 v88, 16, v16
v_and_b32 v89, 0xffff0000, v16
v_lshlrev_b32 v90, 16, v17
v_and_b32 v91, 0xffff0000, v17
v_lshlrev_b32 v92, 16, v18
v_and_b32 v93, 0xffff0000, v18
v_lshlrev_b32 v94, 16, v19
v_and_b32 v95, 0xffff0000, v19
s_waitcnt vmcnt(2)
v_lshlrev_b32 v40, 16, v192
v_and_b32 v41, 0xffff0000, v192
v_lshlrev_b32 v42, 16, v196
v_and_b32 v43, 0xffff0000, v196
v_lshlrev_b32 v44, 16, v193
v_and_b32 v45, 0xffff0000, v193
v_lshlrev_b32 v46, 16, v197
v_and_b32 v47, 0xffff0000, v197
v_lshlrev_b32 v48, 16, v194
v_and_b32 v49, 0xffff0000, v194
v_lshlrev_b32 v50, 16, v198
v_and_b32 v51, 0xffff0000, v198
v_lshlrev_b32 v52, 16, v195
v_and_b32 v53, 0xffff0000, v195
v_lshlrev_b32 v54, 16, v199
v_and_b32 v55, 0xffff0000, v199
v_pk_add_f32 v[40:41], v[40:41], v[42:43]
v_pk_add_f32 v[44:45], v[44:45], v[46:47]
v_pk_add_f32 v[48:49], v[48:49], v[50:51]
v_pk_add_f32 v[52:53], v[52:53], v[54:55]
v_pk_add_f32 v[72:73], v[72:73], v[40:41]
v_pk_add_f32 v[74:75], v[74:75], v[44:45]
v_pk_add_f32 v[76:77], v[76:77], v[48:49]
v_pk_add_f32 v[78:79], v[78:79], v[52:53]
v_cvt_pk_bf16_f32 v8, v72, v73
v_cvt_pk_bf16_f32 v9, v74, v75
v_cvt_pk_bf16_f32 v10, v76, v77
v_cvt_pk_bf16_f32 v11, v78, v79
v_lshlrev_b32 v72, 16, v8
v_and_b32 v73, 0xffff0000, v8
v_lshlrev_b32 v74, 16, v9
v_and_b32 v75, 0xffff0000, v9
v_lshlrev_b32 v76, 16, v10
v_and_b32 v77, 0xffff0000, v10
v_lshlrev_b32 v78, 16, v11
v_and_b32 v79, 0xffff0000, v11
v_lshlrev_b32 v40, 16, v200
v_and_b32 v41, 0xffff0000, v200
v_lshlrev_b32 v42, 16, v204
v_and_b32 v43, 0xffff0000, v204
v_lshlrev_b32 v44, 16, v201
v_and_b32 v45, 0xffff0000, v201
v_lshlrev_b32 v46, 16, v205
v_and_b32 v47, 0xffff0000, v205
v_lshlrev_b32 v48, 16, v202
v_and_b32 v49, 0xffff0000, v202
v_lshlrev_b32 v50, 16, v206
v_and_b32 v51, 0xffff0000, v206
v_lshlrev_b32 v52, 16, v203
v_and_b32 v53, 0xffff0000, v203
v_lshlrev_b32 v54, 16, v207
v_and_b32 v55, 0xffff0000, v207
v_pk_add_f32 v[40:41], v[40:41], v[42:43]
v_pk_add_f32 v[44:45], v[44:45], v[46:47]
v_pk_add_f32 v[48:49], v[48:49], v[50:51]
v_pk_add_f32 v[52:53], v[52:53], v[54:55]
v_pk_add_f32 v[80:81], v[80:81], v[40:41]
v_pk_add_f32 v[82:83], v[82:83], v[44:45]
v_pk_add_f32 v[84:85], v[84:85], v[48:49]
v_pk_add_f32 v[86:87], v[86:87], v[52:53]
v_cvt_pk_bf16_f32 v12, v80, v81
v_cvt_pk_bf16_f32 v13, v82, v83
v_cvt_pk_bf16_f32 v14, v84, v85
v_cvt_pk_bf16_f32 v15, v86, v87
v_lshlrev_b32 v80, 16, v12
v_and_b32 v81, 0xffff0000, v12
v_lshlrev_b32 v82, 16, v13
v_and_b32 v83, 0xffff0000, v13
v_lshlrev_b32 v84, 16, v14
v_and_b32 v85, 0xffff0000, v14
v_lshlrev_b32 v86, 16, v15
v_and_b32 v87, 0xffff0000, v15
v_pk_mul_f32 v[60:61], v[72:73], v[72:73]
v_pk_mul_f32 v[62:63], v[74:75], v[74:75]
v_pk_add_f32 v[56:57], v[72:73], v[74:75]
v_pk_fma_f32 v[60:61], v[76:77], v[76:77], v[60:61]
v_pk_fma_f32 v[62:63], v[78:79], v[78:79], v[62:63]
v_pk_add_f32 v[58:59], v[76:77], v[78:79]
v_pk_fma_f32 v[60:61], v[80:81], v[80:81], v[60:61]
v_pk_add_f32 v[56:57], v[56:57], v[80:81]
v_pk_fma_f32 v[62:63], v[82:83], v[82:83], v[62:63]
v_pk_add_f32 v[58:59], v[58:59], v[82:83]
v_pk_fma_f32 v[60:61], v[84:85], v[84:85], v[60:61]
v_pk_add_f32 v[56:57], v[56:57], v[84:85]
v_pk_fma_f32 v[62:63], v[86:87], v[86:87], v[62:63]
v_pk_add_f32 v[58:59], v[58:59], v[86:87]
v_pk_fma_f32 v[60:61], v[88:89], v[88:89], v[60:61]
v_pk_add_f32 v[56:57], v[56:57], v[88:89]
v_pk_fma_f32 v[62:63], v[90:91], v[90:91], v[62:63]
v_pk_add_f32 v[58:59], v[58:59], v[90:91]
v_pk_fma_f32 v[60:61], v[92:93], v[92:93], v[60:61]
v_pk_add_f32 v[56:57], v[56:57], v[92:93]
v_pk_fma_f32 v[62:63], v[94:95], v[94:95], v[62:63]
v_pk_add_f32 v[58:59], v[58:59], v[94:95]
s_branch L_ppoll_chk
L_ppoll:
s_add_u32 s16, s15, 91226112
buffer_load_dwordx4 v[216:219], v251, s[20:23], s16 offen sc1
s_add_u32 s16, s15, 95420416
buffer_load_dwordx4 v[220:223], v251, s[20:23], s16 offen sc1
L_ppoll_chk:
s_waitcnt vmcnt(0)
v_max_u32 v152, v216, v217
v_max3_u32 v152, v152, v218, v219
v_max3_u32 v152, v152, v220, v221
v_max3_u32 v152, v152, v222, v223
v_cmp_eq_u32 vcc, -1, v152
s_sub_u32 s58, s58, 1
s_cbranch_scc1 L_ppoll_out
s_cbranch_vccnz L_ppoll
L_ppoll_out:
s_cmp_lg_u32 s3, 0
s_cbranch_scc1 L_final
s_add_u32 m0, s36, 65536
v_lshlrev_b32 v40, 16, v216
v_and_b32 v41, 0xffff0000, v216
v_lshlrev_b32 v42, 16, v220
v_and_b32 v43, 0xffff0000, v220
s_add_u32 s57, s37, 65536
v_lshlrev_b32 v44, 16, v217
v_and_b32 v45, 0xffff0000, v217
v_lshlrev_b32 v46, 16, v221
v_and_b32 v47, 0xffff0000, v221
buffer_load_dwordx4 v226, s[20:23], s57 offen offset:0 sc1 lds
v_lshlrev_b32 v48, 16, v218
v_and_b32 v49, 0xffff0000, v218
v_lshlrev_b32 v50, 16, v222
v_and_b32 v51, 0xffff0000, v222
buffer_load_dwordx4 v226, s[20:23], s57 offen offset:1024 sc1 lds
v_lshlrev_b32 v52, 16, v219
v_and_b32 v53, 0xffff0000, v219
v_lshlrev_b32 v54, 16, v223
v_and_b32 v55, 0xffff0000, v223
buffer_load_dwordx4 v226, s[20:23], s57 offen offset:2048 sc1 lds
v_pk_add_f32 v[40:41], v[40:41], v[42:43]
v_pk_add_f32 v[44:45], v[44:45], v[46:47]
v_pk_add_f32 v[48:49], v[48:49], v[50:51]
v_pk_add_f32 v[52:53], v[52:53], v[54:55]
buffer_load_dwordx4 v226, s[20:23], s57 offen offset:3072 sc1 lds
v_pk_add_f32 v[96:97], v[96:97], v[40:41]
v_pk_add_f32 v[98:99], v[98:99], v[44:45]
v_pk_add_f32 v[100:101], v[100:101], v[48:49]
v_pk_add_f32 v[102:103], v[102:103], v[52:53]
s_add_u32 m0, s36, 81920
v_cvt_pk_bf16_f32 v20, v96, v97
v_cvt_pk_bf16_f32 v21, v98, v99
v_cvt_pk_bf16_f32 v22, v100, v101
v_cvt_pk_bf16_f32 v23, v102, v103
s_add_u32 s57, s37, 81920
v_lshlrev_b32 v96, 16, v20
v_and_b32 v97, 0xffff0000, v20
v_lshlrev_b32 v98, 16, v21
v_and_b32 v99, 0xffff0000, v21
buffer_load_dwordx4 v226, s[20:23], s57 offen offset:0 sc1 lds
v_lshlrev_b32 v100, 16, v22
v_and_b32 v101, 0xffff0000, v22
v_lshlrev_b32 v102, 16, v23
v_and_b32 v103, 0xffff0000, v23
buffer_load_dwordx4 v226, s[20:23], s57 offen offset:1024 sc1 lds
v_pk_fma_f32 v[60:61], v[96:97], v[96:97], v[60:61]
v_pk_add_f32 v[56:57], v[56:57], v[96:97]
v_pk_fma_f32 v[62:63], v[98:99], v[98:99], v[62:63]
v_pk_add_f32 v[58:59], v[58:59], v[98:99]
buffer_load_dwordx4 v226, s[20:23], s57 offen offset:2048 sc1 lds
v_pk_fma_f32 v[60:61], v[100:101], v[100:101], v[60:61]
v_pk_add_f32 v[56:57], v[56:57], v[100:101]
v_pk_fma_f32 v[62:63], v[102:103], v[102:103], v[62:63]
v_pk_add_f32 v[58:59], v[58:59], v[102:103]
buffer_load_dwordx4 v226, s[20:23], s57 offen offset:3072 sc1 lds
v_pk_add_f32 v[136:137], v[56:57], v[58:59]
v_pk_add_f32 v[138:139], v[60:61], v[62:63]
v_add_f32 v136, v136, v137
v_add_f32 v138, v138, v139
s_add_u32 m0, s36, 98304
s_nop 0
v_permlane16_swap_b32 v136, v138
v_add_f32 v136, v136, v138
s_nop 1
v_add_f32_dpp v136, v136, v136 row_ror:8 row_mask:0xf bank_mask:0xf
v_mov_b32 v137, v136
s_add_u32 s57, s37, 98304
s_nop 0
v_permlane32_swap_b32 v136, v137
v_add_f32 v136, v136, v137
ds_write_b32 v1, v136 offset:0
s_waitcnt lgkmcnt(0)
buffer_load_dwordx4 v226, s[20:23], s57 offen offset:0 sc1 lds
s_barrier
ds_read_b128 v[144:147], v2 offset:0
ds_read_b128 v[148:151], v2 offset:16
s_waitcnt lgkmcnt(0)
buffer_load_dwordx4 v226, s[20:23], s57 offen offset:1024 sc1 lds
v_pk_add_f32 v[144:145], v[144:145], v[146:147]
v_pk_add_f32 v[148:149], v[148:149], v[150:151]
v_pk_add_f32 v[144:145], v[144:145], v[148:149]
v_mul_f32 v144, 0x3a800000, v144
buffer_load_dwordx4 v226, s[20:23], s57 offen offset:2048 sc1 lds
v_mul_f32 v145, 0x3a800000, v145
v_fma_f32 v145, -v144, v144, v145
v_max_f32 v145, 0, v145
v_cvt_pk_bf16_f32 v146, v144, v145
buffer_load_dwordx4 v226, s[20:23], s57 offen offset:3072 sc1 lds
v_lshlrev_b32 v144, 16, v146
v_and_b32 v145, 0xffff0000, v146
v_add_f32 v145, 0x3727c5ac, v145
v_cvt_pk_bf16_f32 v145, v145, v145
v_lshlrev_b32 v145, 16, v145
v_sqrt_f32 v145, v145
s_nop 0
v_cvt_pk_bf16_f32 v145, v145, v145
v_lshlrev_b32 v145, 16, v145
v_rcp_f32 v140, v145
s_nop 0
v_mov_b32 v141, v140
v_mul_f32_e64 v142, -v144, v140
v_mov_b32 v143, v142
s_mov_b32 s3, 1
s_mov_b32 s26, 0
s_mov_b32 s101, 0
s_mov_b32 s34, 0
s_mov_b32 s30, 0
s_add_u32 s39, s39, 4194304
s_add_u32 s40, s40, 16777216
s_add_u32 s41, s41, 16777216
s_add_u32 s42, s42, 8388608
s_add_u32 s51, s51, 0x4000
s_add_u32 s52, s52, 0x4000
s_branch L_layer
L_final:
v_lshlrev_b32 v40, 16, v216
v_and_b32 v41, 0xffff0000, v216
v_lshlrev_b32 v42, 16, v220
v_and_b32 v43, 0xffff0000, v220
v_lshlrev_b32 v44, 16, v217
v_and_b32 v45, 0xffff0000, v217
v_lshlrev_b32 v46, 16, v221
v_and_b32 v47, 0xffff0000, v221
v_lshlrev_b32 v48, 16, v218
v_and_b32 v49, 0xffff0000, v218
v_lshlrev_b32 v50, 16, v222
v_and_b32 v51, 0xffff0000, v222
v_lshlrev_b32 v52, 16, v219
v_and_b32 v53, 0xffff0000, v219
v_lshlrev_b32 v54, 16, v223
v_and_b32 v55, 0xffff0000, v223
v_pk_add_f32 v[40:41], v[40:41], v[42:43]
v_pk_add_f32 v[44:45], v[44:45], v[46:47]
v_pk_add_f32 v[48:49], v[48:49], v[50:51]
v_pk_add_f32 v[52:53], v[52:53], v[54:55]
v_pk_add_f32 v[96:97], v[96:97], v[40:41]
v_pk_add_f32 v[98:99], v[98:99], v[44:45]
v_pk_add_f32 v[100:101], v[100:101], v[48:49]
v_pk_add_f32 v[102:103], v[102:103], v[52:53]
v_cvt_pk_bf16_f32 v20, v96, v97
v_cvt_pk_bf16_f32 v21, v98, v99
v_cvt_pk_bf16_f32 v22, v100, v101
v_cvt_pk_bf16_f32 v23, v102, v103
s_or_b32 s16, s2, s17
s_cbranch_scc1 L_noepoch
s_add_u32 s87, s87, 1
v_mov_b32 v234, s87
s_mov_b32 s16, 86056960
s_mov_b64 exec, 1
buffer_store_dword v234, off, s[20:23], s16 sc1
s_mov_b64 exec, -1
L_noepoch:
s_mov_b32 s32, s6
s_mov_b32 s33, s7
s_mov_b32 s34, 0x400000
s_mov_b32 s35, 0x20000
buffer_store_dwordx4 v[8:11], v4, s[32:35], s44 offen offset:0 nt
buffer_store_dwordx4 v[12:15], v4, s[32:35], s44 offen offset:64 nt
buffer_store_dwordx4 v[16:19], v4, s[32:35], s44 offen offset:128 nt
buffer_store_dwordx4 v[20:23], v4, s[32:35], s44 offen offset:192 nt
s_endpgm
L_poll2:
s_mov_b32 s58, 524288
L_poll2_l:
buffer_load_dword v234, v249, s[20:23], s69 offen sc1
s_sub_u32 s58, s58, 1
s_cbranch_scc1 L_poll2_out
s_waitcnt vmcnt(0)
v_cmp_ne_u32 vcc, v253, v234
s_nop 0
s_and_b32 s14, vcc_lo, 0xffff
s_cbranch_scc1 L_poll2_l
L_poll2_out:
s_waitcnt vmcnt(0)
s_branch L_poll2_ok
L_poll3:
s_mov_b32 s58, 524288
L_poll3_l:
buffer_load_dwordx4 v[236:239], v224, s[20:23], s79 offen sc1
s_sub_u32 s58, s58, 1
s_cbranch_scc1 L_poll3_out
s_waitcnt vmcnt(0)
v_xor_b32 v236, v236, v253
v_xor_b32 v237, v237, v253
v_xor_b32 v238, v238, v253
v_xor_b32 v239, v239, v253
v_or3_b32 v234, v236, v237, v238
v_or_b32 v234, v234, v239
v_cmp_ne_u32 vcc, 0, v234
s_nop 0
s_or_b32 s14, vcc_lo, vcc_hi
s_cbranch_scc1 L_poll3_l
L_poll3_out:
s_waitcnt vmcnt(0)
s_branch L_poll3_ok
L_poll4:
s_mov_b32 s58, 524288
L_poll4_l:
buffer_load_dword v234, v235, s[20:23], s52 offen sc1
s_sub_u32 s58, s58, 1
s_cbranch_scc1 L_poll4_out
s_waitcnt vmcnt(0)
v_cmp_ne_u32 vcc, v253, v234
s_nop 0
s_and_b32 s14, vcc_lo, 0xff
s_cbranch_scc1 L_poll4_l
L_poll4_out:
s_waitcnt vmcnt(0)
s_branch L_poll4_ok
L_poll5:
s_mov_b32 s58, 524288
L_poll5_l:
buffer_load_dword v234, v229, s[20:23], s19 offen sc1
s_sub_u32 s58, s58, 1
s_cbranch_scc1 L_poll5_out
s_waitcnt vmcnt(0)
v_cmp_ne_u32 vcc, v253, v234
s_nop 0
s_or_b32 s14, vcc_lo, vcc_hi
s_and_b32 s14, s14, 0xfffffff
s_cbranch_scc1 L_poll5_l
L_poll5_out:
s_waitcnt vmcnt(0)
s_branch L_poll5_ok
L_poll6:
s_mov_b32 s58, 524288
L_poll6_l:
buffer_load_dword v234, v229, s[20:23], s48 offen sc1
s_sub_u32 s58, s58, 1
s_cbranch_scc1 L_poll6_out
s_waitcnt vmcnt(0)
v_cmp_ne_u32 vcc, v253, v234
s_nop 0
s_and_b32 s14, vcc_hi, 0xffffff
s_or_b32 s14, s14, vcc_lo
s_cbranch_scc1 L_poll6_l
L_poll6_out:
s_waitcnt vmcnt(0)
s_branch L_poll6_ok
L_poll7:
s_mov_b32 s58, 524288
L_poll7_l:
buffer_load_dword v234, v235, s[20:23], s46 offen sc1
s_sub_u32 s58, s58, 1
s_cbranch_scc1 L_poll7_out
s_waitcnt vmcnt(0)
v_cmp_ne_u32 vcc, v253, v234
s_nop 0
s_and_b32 s14, vcc_lo, 0xffff
s_cbranch_scc1 L_poll7_l
L_poll7_out:
s_waitcnt vmcnt(0)
s_branch L_poll7_ok
L_poll8:
s_mov_b32 s58, 524288
L_poll8_l:
buffer_load_dword v234, v235, s[20:23], s46 offen sc1
s_sub_u32 s58, s58, 1
s_cbranch_scc1 L_poll8_out
s_waitcnt vmcnt(0)
v_cmp_ne_u32 vcc, v253, v234
s_nop 0
s_and_b32 s14, vcc_lo, 0xffff
s_cbranch_scc1 L_poll8_l
L_poll8_out:
s_waitcnt vmcnt(0)
s_branch L_poll8_ok
L_poll9:
s_mov_b32 s58, 524288
L_poll9_l:
buffer_load_dword v234, v235, s[20:23], s46 offen sc1
s_sub_u32 s58, s58, 1
s_cbranch_scc1 L_poll9_out
s_waitcnt vmcnt(0)
v_cmp_ne_u32 vcc, v253, v234
s_nop 0
s_and_b32 s14, vcc_lo, 0xffff
s_cbranch_scc1 L_poll9_l
L_poll9_out:
s_waitcnt vmcnt(0)
s_branch L_poll9_ok
L_poll10:
s_mov_b32 s58, 524288
L_poll10_l:
buffer_load_dword v234, v235, s[20:23], s46 offen sc1
s_sub_u32 s58, s58, 1
s_cbranch_scc1 L_poll10_out
s_waitcnt vmcnt(0)
v_cmp_ne_u32 vcc, v253, v234
s_nop 0
s_and_b32 s14, vcc_lo, 0xffff
s_cbranch_scc1 L_poll10_l
L_poll10_out:
s_waitcnt vmcnt(0)
s_branch L_poll10_ok
L_poll11:
s_mov_b32 s58, 524288
L_poll11_l:
buffer_load_dword v234, v235, s[20:23], s46 offen sc1
s_sub_u32 s58, s58, 1
s_cbranch_scc1 L_poll11_out
s_waitcnt vmcnt(0)
v_cmp_ne_u32 vcc, v253, v234
s_nop 0
s_and_b32 s14, vcc_lo, 0xffff
s_cbranch_scc1 L_poll11_l
L_poll11_out:
s_waitcnt vmcnt(0)
s_branch L_poll11_ok
L_poll12:
s_mov_b32 s58, 524288
L_poll12_l:
buffer_load_dword v234, v249, s[20:23], s50 offen sc1
s_sub_u32 s58, s58, 1
s_cbranch_scc1 L_poll12_out
s_waitcnt vmcnt(0)
v_cmp_ne_u32 vcc, v253, v234
s_nop 0
s_and_b32 s14, vcc_lo, 0xffff
s_cbranch_scc1 L_poll12_l
L_poll12_out:
s_waitcnt vmcnt(0)
s_branch L_poll12_ok
L_end:
s_endpgm
.section .rodata,"a"
.p2align 6
.amdhsa_kernel interleave_layers__ssm_conv_h3__glu_gated_geglu__prompt_kernel
  .amdhsa_next_free_vgpr 512
  .amdhsa_next_free_sgpr 102
  .amdhsa_accum_offset 256
  .amdhsa_group_segment_fixed_size 0
  .amdhsa_kernarg_size 104
  .amdhsa_user_sgpr_count 2
  .amdhsa_user_sgpr_kernarg_segment_ptr 1
  .amdhsa_system_sgpr_workgroup_id_x 1
  .amdhsa_float_denorm_mode_32 3
.end_amdhsa_kernel
```
